```python
import torch

def _softmax(x, axis=-1):
    return torch.softmax(x, dim=axis)

def _gelu(x):
    return torch.nn.functional.gelu(x, approximate='tanh')

def _silu(x):
    return torch.nn.functional.silu(x)

def _sigmoid(x):
    return torch.sigmoid(x)

def _layernorm(x, axis=-1, eps=1e-05):
    m = x.mean(dim=axis, keepdim=True)
    v = x.var(dim=axis, keepdim=True, unbiased=False)
    return (x - m) / torch.sqrt(v + eps)

def _scatter_add(tgt, idx, src, axis=0):
    return tgt.clone().index_add_(axis, idx, src)

def _segment_sum(src, seg, n):
    out = torch.zeros((n,) + src.shape[1:], dtype=src.dtype)
    return out.index_add_(0, seg, src)

def _pad(x, pw):
    flat = tuple((v for pair in reversed(pw) for v in pair))
    return torch.nn.functional.pad(x, flat)
kernel_name = 'adaLN_cond__mha_block__dense_activation_relu__prompt'

def setup_inputs():

    _w = lambda a: (lambda t: t.to(torch.bfloat16) if t.is_floating_point() else t)(torch.as_tensor(a))

    def _A_setup():
        B, S, D, H = (1, 2048, 640, 32)
        return {'x': _w((lambda *s: torch.randn(*s, dtype=torch.bfloat16) * 0.05)(B, S, D)), 'wqkv': _w((lambda *s: torch.randn(*s, dtype=torch.bfloat16) * 0.05)(D, 3 * D)), 'wo': _w((lambda *s: torch.randn(*s, dtype=torch.bfloat16) * 0.05)(D, D))}
    _A_in = _A_setup()

    def _B_setup():
        B, S, D, Dff = (1, 2048, 640, 1728)
        return {'x': _w((lambda *s: torch.randn(*s, dtype=torch.bfloat16) * 0.05)(B, S, D)), 'w1': _w((lambda *s: torch.randn(*s, dtype=torch.bfloat16) * 0.05)(D, Dff)), 'w2': _w((lambda *s: torch.randn(*s, dtype=torch.bfloat16) * 0.05)(Dff, D))}
    _B_in = _B_setup()
    return {'A_x': _A_in['x'], 'A_wqkv': _A_in['wqkv'], 'A_wo': _A_in['wo'], 'B_x': _B_in['x'], 'B_w1': _B_in['w1'], 'B_w2': _B_in['w2'], 'c': _w((lambda *s: torch.randn(*s, dtype=torch.bfloat16) * 0.1)(1, 640) * 8.0), 'w_mod': _w((lambda *s: torch.randn(*s, dtype=torch.bfloat16) * 0.1)(640, 6 * 640) * 640 ** (-0.5) * 8.0)}

def reference(A_x, A_wqkv, A_wo, B_x, B_w1, B_w2, c, w_mod):

    def _A_ref(x, wqkv, wo):
        B, S, D = x.shape
        H = 32
        Dh = D // H
        qkv = (lambda x, *d: x.permute(*d))((x @ wqkv).reshape(B, S, 3, H, Dh), 2, 0, 3, 1, 4)
        q, k, v = (qkv[0], qkv[1], qkv[2])
        scores = torch.einsum('bhqd,bhkd->bhqk', q, k) * Dh ** (-0.5)
        p = _softmax(scores, axis=-1)
        o = torch.einsum('bhqk,bhkd->bhqd', p, v)
        return (lambda x, *d: x.permute(*d))(o, 0, 2, 1, 3).reshape(B, S, D) @ wo

    def _B_ref(x, w1, w2):
        h = torch.einsum('bsd,df->bsf', x, w1)
        zero = torch.zeros_like(h)
        h = torch.maximum(h, zero)
        return torch.einsum('bsf,fd->bsd', h, w2)
    x = A_x
    mod = (_silu(c) @ w_mod).reshape(c.shape[0], 6, 1, -1)
    sa, ca, ga, sb, cb, gb = (mod[:, 0].clone(), mod[:, 1].clone(), mod[:, 2].clone(), mod[:, 3].clone(), mod[:, 4].clone(), mod[:, 5].clone())
    h = _layernorm(x, axis=-1) * (1 + ca) + sa
    x = x + ga * _A_ref(h, A_wqkv, A_wo)
    h = _layernorm(x, axis=-1) * (1 + cb) + sb
    x = x + gb * _B_ref(h, B_w1, B_w2)
    return x
```

```asm
; @launch grid=(256,1,1) block=(512,1,1) lds=163840
.amdgcn_target "amdgcn-amd-amdhsa--gfx950"
.text
.globl adaLN_cond__mha_block__dense_activation_relu__prompt_kernel
.p2align 8
.type adaLN_cond__mha_block__dense_activation_relu__prompt_kernel,@function
adaLN_cond__mha_block__dense_activation_relu__prompt_kernel:
    s_cmp_ge_u32 s2, 256
    s_cbranch_scc1 L_exit
    s_load_dwordx2 s[16:17], s[0:1], 56
    s_load_dwordx2 s[40:41], s[0:1], 48
    s_load_dwordx2 s[8:9], s[0:1], 0
    s_load_dwordx2 s[4:5], s[0:1], 80
    s_load_dwordx2 s[12:13], s[0:1], 8
    v_lshrrev_b32 v1, 6, v0
    v_and_b32 v0, 63, v0
    v_readfirstlane_b32 s31, v1
    s_and_b32 s60, s2, 7
    s_lshr_b32 s61, s2, 3
    s_cmp_lg_u32 s31, 7
    s_cbranch_scc1 L_pf_5
    s_getpc_b64 s[64:65]
L_pcref:
    s_lshl_b32 s62, s61, 11
    v_lshl_add_u32 v8, v0, 7, s62
    v_min_u32 v8, L_code_end-L_pcref-4, v8
    s_mov_b64 exec, 0xffff
    global_load_dword v95, v8, s[64:65]
    s_mov_b64 exec, -1
L_pf_5:
    v_mov_b32 v8, 0
    v_lshlrev_b32 v9, 2, v0
    v_and_b32 v9, 28, v9
    v_add_u32 v15, 155648, v9
    ds_write_b32 v15, v8
    s_lshr_b32 s52, s60, 1
    s_lshl_b32 s52, s52, 2
    s_and_b32 s62, s61, 3
    s_add_u32 s52, s52, s62
    s_and_b32 s53, s60, 1
    s_lshl_b32 s53, s53, 3
    s_lshr_b32 s57, s61, 2
    s_add_u32 s53, s53, s57
    s_mov_b32 s18, 4915200
    s_mov_b32 s19, 0x20000
    s_mov_b32 s10, 2621440
    s_mov_b32 s11, 0x20000
    s_mov_b32 s14, 2457600
    s_mov_b32 s15, 0x20000
    s_mov_b32 s6, 31195136
    s_mov_b32 s7, 0x20000
    s_mul_i32 s63, s57, 3
    s_add_u32 s63, s63, s62
    s_add_u32 s63, s63, 9
    s_cmp_eq_u32 s62, 0
    s_cmov_b32 s63, s57
    s_lshl_b32 s63, s63, 3
    s_add_u32 s64, s63, s60
    s_or_b32 s63, s2, 6
    s_lshr_b32 s65, s60, 1
    s_cmp_eq_u32 s63, 246
    s_cselect_b32 s63, 231, s63
    s_cselect_b32 s62, 1, s62
    s_sub_u32 s63, s63, 231
    s_lshr_b32 s34, s63, 1
    s_add_u32 s65, s65, s34
    s_add_u32 s65, s65, 64
    s_and_b32 s63, s63, 0xffffffe7
    s_cselect_b32 s65, s64, s65
    s_cmp_lg_u32 s62, 0
    s_cmov_b32 s64, s65
    s_sub_u32 s63, s64, 80
    s_cselect_b32 s63, s64, s63
    s_cselect_b32 s64, 20, 40
    s_cselect_b32 s65, 16, 17
    s_cselect_b32 s59, 0, 20
    s_mul_i32 s67, s63, 3277
    s_lshr_b32 s67, s67, s65
    s_mul_i32 s64, s67, s64
    s_sub_u32 s63, s63, s64
    s_add_u32 s59, s59, s63
    s_cmp_lt_u32 s59, 20
    s_addc_u32 s3, s52, s53
    s_and_b32 s3, s3, 3
    s_cmp_ge_u32 s31, 5
    s_cbranch_scc1 L_L_1
    v_lshrrev_b32 v13, 3, v0
    v_and_b32 v12, 7, v0
    v_and_b32 v10, 2, v13
    v_xor_b32 v9, v12, v10
    v_mul_u32_u24 v8, 7680, v13
    v_lshl_add_u32 v10, v9, 4, v8
    v_xor_b32 v11, 64, v10
    s_mul_i32 s60, s67, 160
    s_lshl_b32 s63, s31, 5
    s_add_u32 s60, s60, s63
    s_mul_i32 s61, s60, 7680
    s_lshl_b32 s62, s59, 7
    s_add_u32 s61, s61, s62
    s_lshl_b32 s62, s31, 12
    s_add_u32 m0, s62, 131072
    s_min_u32 s60, s60, 608
    v_and_b32 v8, 31, v0
    v_add_lshl_u32 v14, v8, s60, 1
    s_lshl_b32 s68, s52, 7
    s_lshl_b32 s60, s53, 3
    s_add_u32 s68, s68, s60
    v_mul_u32_u24 v9, 1280, v12
    v_lshl_add_u32 v9, v13, 4, v9
    s_mul_i32 s69, s68, 1280
    s_lshl_b32 s62, s31, 8
    s_add_u32 s69, s69, s62
    s_cmp_ge_u32 s59, 20
    s_waitcnt lgkmcnt(0)
    global_load_ushort v24, v14, s[40:41]
    s_cbranch_scc1 L_nm_3
    buffer_load_dwordx4 v10, s[16:19], s61 offen lds
    s_add_u32 m0, m0, 1024
    s_add_u32 s61, s61, 61440
    buffer_load_dwordx4 v11, s[16:19], s61 offen lds
    s_add_u32 m0, m0, 1024
    s_add_u32 s61, s61, 61440
    buffer_load_dwordx4 v10, s[16:19], s61 offen lds
    s_add_u32 m0, m0, 1024
    s_add_u32 s61, s61, 61440
    buffer_load_dwordx4 v11, s[16:19], s61 offen lds
L_nm_3:
    buffer_load_dwordx4 v[16:19], v9, s[8:11], s69 offen
    buffer_load_dwordx4 v[20:23], v9, s[8:11], s69 offen offset:128
    s_load_dword s30, s[4:5], 360448
    s_load_dwordx2 s[24:25], s[0:1], 64
    s_load_dwordx2 s[32:33], s[0:1], 16
    s_load_dwordx4 s[36:39], s[0:1], 32
    s_barrier
    v_lshlrev_b32 v1, 4, v0
    s_mov_b32 s58, s2
    s_mov_b32 s66, 16777216
    s_and_b32 s60, s2, 7
    s_lshl_b32 s56, s60, 2
    s_lshr_b32 s54, s2, 6
    s_add_u32 s54, s54, s56
    s_bfe_u32 s60, s2, 0x20003
    s_add_u32 s56, s56, s60
    s_bfe_u32 s55, s2, 0x30003
    s_mov_b32 s26, 2621440
    s_mov_b32 s27, 0x20000
    v_lshrrev_b32 v11, 4, v0
    v_bfe_u32 v88, v0, 2, 2
    v_lshl_add_u32 v10, v11, 3, v88
    v_lshlrev_b32 v10, 7, v10
    v_bfe_u32 v88, v0, 3, 2
    v_xor_b32 v88, s31, v88
    v_lshl_add_u32 v10, v88, 5, v10
    v_and_b32 v88, 3, v0
    v_lshl_add_u32 v10, v88, 3, v10
    v_add_u32 v10, 131072, v10
    v_lshlrev_b32 v11, 4, v11
    v_add_u32 v11, 155712, v11
    s_mul_i32 s70, s67, 15360
    s_lshl_b32 s61, s59, 8
    s_add_u32 s70, s70, s61
    s_lshl_b32 s61, s31, 6
    s_add_u32 s70, s70, s61
    s_add_u32 s70, s70, 1048576
    v_add_lshl_u32 v9, v8, s63, 1
    v_add_u32 v9, 155712, v9
    s_lshl_b32 s60, s31, 2
    s_add_u32 s60, s60, 155648
    v_mov_b32 v14, s60
    v_mov_b32 v8, 1
    s_waitcnt vmcnt(2)
    v_lshlrev_b32 v24, 16, v24
    v_mul_f32 v25, 0xbfb8aa3b, v24
    v_exp_f32 v25, v25
    s_nop 0
    v_add_f32 v25, 1.0, v25
    v_rcp_f32 v25, v25
    s_waitcnt lgkmcnt(0)
    v_mul_f32 v24, v24, v25
    v_cvt_pk_bf16_f32 v2, v24, v24
    s_add_u32 s30, s30, 0x9e3779b9
    s_mov_b32 s28, s30
    s_mov_b32 s29, s30
    s_mov_b64 s[20:21], s[8:9]
    s_mov_b32 s22, 0
    s_mov_b32 s23, 0x20000
    s_cmp_ge_u32 s59, 20
    s_cbranch_scc1 L_nm_4
    ds_write_b16 v9, v2
    ds_write_b32 v14, v8
    s_cmp_ge_u32 s31, 4
    s_cbranch_scc1 L_nm_4
    v_and_b32 v30, 3, v0
    v_lshlrev_b32 v30, 3, v30
    v_bfe_u32 v30, s30, v30, 8
    v_mov_b32 v31, 0xffffff00
    s_mov_b64 exec, 31
L_ls_6:
    ds_read_b32 v9, v15
    s_sub_i32 s66, s66, 1
    s_cmp_lt_i32 s66, 0
    s_cbranch_scc1 L_lsd_7
    s_waitcnt lgkmcnt(0)
    v_cmp_gt_u32 vcc, 1, v9
    s_cbranch_vccnz L_ls_6
L_lsd_7:
    s_waitcnt lgkmcnt(0)
    s_mov_b64 exec, -1
    ds_read_b64_tr_b16 v[48:49], v10 offset:0
    ds_read_b64_tr_b16 v[50:51], v10 offset:512
    ds_read_b128 v[68:71], v11 offset:0
    ds_read_b64_tr_b16 v[52:53], v10 offset:4096
    ds_read_b64_tr_b16 v[54:55], v10 offset:4608
    ds_read_b128 v[72:75], v11 offset:64
    ds_read_b64_tr_b16 v[56:57], v10 offset:8192
    ds_read_b64_tr_b16 v[58:59], v10 offset:8704
    ds_read_b128 v[76:79], v11 offset:128
    ds_read_b64_tr_b16 v[60:61], v10 offset:12288
    ds_read_b64_tr_b16 v[62:63], v10 offset:12800
    ds_read_b128 v[80:83], v11 offset:192
    ds_read_b64_tr_b16 v[64:65], v10 offset:16384
    ds_read_b64_tr_b16 v[66:67], v10 offset:16896
    ds_read_b128 v[84:87], v11 offset:256
    s_waitcnt lgkmcnt(12)
    v_mfma_f32_16x16x32_bf16 v[88:91], v[68:71], v[48:51], 0
    s_waitcnt lgkmcnt(9)
    v_mfma_f32_16x16x32_bf16 v[88:91], v[72:75], v[52:55], v[88:91]
    s_waitcnt lgkmcnt(6)
    v_mfma_f32_16x16x32_bf16 v[88:91], v[76:79], v[56:59], v[88:91]
    s_waitcnt lgkmcnt(3)
    v_mfma_f32_16x16x32_bf16 v[88:91], v[80:83], v[60:63], v[88:91]
    s_waitcnt lgkmcnt(0)
    v_mfma_f32_16x16x32_bf16 v[88:91], v[84:87], v[64:67], v[88:91]
    v_lshlrev_b32 v10, 2, v0
    s_mov_b64 exec, 0xffff
    s_nop 5
    v_add_u32 v88, 0x80, v88
    v_and_or_b32 v88, v88, v31, v30
    buffer_store_dword v88, v10, s[4:7], s70 offen sc1
    s_mov_b64 exec, -1
    v_mov_b32 v8, 2
    ds_write_b32 v14, v8
    s_waitcnt vmcnt(1)
    s_branch L_nm_8
L_nm_4:
    s_waitcnt vmcnt(0)
L_nm_8:
    v_lshlrev_b32 v32, 16, v16
    v_and_b32 v33, 0xffff0000, v16
    v_lshlrev_b32 v34, 16, v17
    v_and_b32 v35, 0xffff0000, v17
    v_lshlrev_b32 v36, 16, v18
    v_and_b32 v37, 0xffff0000, v18
    v_lshlrev_b32 v38, 16, v19
    v_and_b32 v39, 0xffff0000, v19
    v_lshlrev_b32 v40, 16, v20
    v_and_b32 v41, 0xffff0000, v20
    v_lshlrev_b32 v42, 16, v21
    v_and_b32 v43, 0xffff0000, v21
    v_lshlrev_b32 v44, 16, v22
    v_and_b32 v45, 0xffff0000, v22
    v_lshlrev_b32 v46, 16, v23
    v_and_b32 v47, 0xffff0000, v23
    v_add_f32 v26, v32, v33
    v_mul_f32 v27, v32, v32
    v_fmac_f32 v27, v33, v33
    v_add_f32 v26, v26, v34
    v_fmac_f32 v27, v34, v34
    v_add_f32 v26, v26, v35
    v_fmac_f32 v27, v35, v35
    v_add_f32 v26, v26, v36
    v_fmac_f32 v27, v36, v36
    v_add_f32 v26, v26, v37
    v_fmac_f32 v27, v37, v37
    v_add_f32 v26, v26, v38
    v_fmac_f32 v27, v38, v38
    v_add_f32 v26, v26, v39
    v_fmac_f32 v27, v39, v39
    v_add_f32 v26, v26, v40
    v_fmac_f32 v27, v40, v40
    v_add_f32 v26, v26, v41
    v_fmac_f32 v27, v41, v41
    v_add_f32 v26, v26, v42
    v_fmac_f32 v27, v42, v42
    v_add_f32 v26, v26, v43
    v_fmac_f32 v27, v43, v43
    v_add_f32 v26, v26, v44
    v_fmac_f32 v27, v44, v44
    v_add_f32 v26, v26, v45
    v_fmac_f32 v27, v45, v45
    v_add_f32 v26, v26, v46
    v_fmac_f32 v27, v46, v46
    v_add_f32 v26, v26, v47
    v_fmac_f32 v27, v47, v47
    s_nop 0
    v_add_f32_dpp v26, v26, v26 row_ror:8 row_mask:0xf bank_mask:0xf
    v_add_f32_dpp v27, v27, v27 row_ror:8 row_mask:0xf bank_mask:0xf
    v_bfe_u32 v9, v0, 4, 1
    v_lshlrev_b32 v9, 2, v9
    v_permlane16_swap_b32 v26, v27
    v_add_f32 v26, v26, v27
    v_mov_b32 v27, v26
    v_lshl_add_u32 v9, v12, 3, v9
    s_lshl_b32 s61, s31, 6
    s_add_u32 s61, s61, 156160
    v_permlane32_swap_b32 v26, v27
    v_add_f32 v26, v26, v27
    v_add_u32 v9, s61, v9
    ds_write_b32 v9, v26
    v_mov_b32 v8, 3
    ds_write_b32 v14, v8
    s_mov_b64 exec, 31
L_ls_9:
    ds_read_b32 v9, v15
    s_sub_i32 s66, s66, 1
    s_cmp_lt_i32 s66, 0
    s_cbranch_scc1 L_lsd_10
    s_waitcnt lgkmcnt(0)
    v_cmp_gt_u32 vcc, 3, v9
    s_cbranch_vccnz L_ls_9
L_lsd_10:
    s_waitcnt lgkmcnt(0)
    s_mov_b64 exec, -1
    v_lshlrev_b32 v9, 3, v12
    v_add_u32 v9, 156160, v9
    ds_read_b64 v[48:49], v9 offset:0
    ds_read_b64 v[50:51], v9 offset:64
    ds_read_b64 v[52:53], v9 offset:128
    ds_read_b64 v[54:55], v9 offset:192
    ds_read_b64 v[56:57], v9 offset:256
    s_waitcnt lgkmcnt(0)
    v_add_f32 v48, v48, v50
    v_add_f32 v49, v49, v51
    v_add_f32 v48, v48, v52
    v_add_f32 v49, v49, v53
    v_add_f32 v48, v48, v54
    v_add_f32 v49, v49, v55
    v_add_f32 v48, v48, v56
    v_add_f32 v49, v49, v57
    v_mul_f32 v48, 0x3acccccd, v48
    v_mul_f32 v49, 0x3acccccd, v49
    v_fma_f32 v49, -v48, v48, v49
    v_max_f32 v49, 0, v49
    v_add_f32 v49, 0x3727c5ac, v49
    v_rsq_f32 v49, v49
    v_sub_f32 v32, v32, v48
    v_sub_f32 v33, v33, v48
    v_sub_f32 v34, v34, v48
    v_sub_f32 v35, v35, v48
    v_sub_f32 v36, v36, v48
    v_sub_f32 v37, v37, v48
    v_sub_f32 v38, v38, v48
    v_sub_f32 v39, v39, v48
    v_sub_f32 v40, v40, v48
    v_sub_f32 v41, v41, v48
    v_sub_f32 v42, v42, v48
    v_sub_f32 v43, v43, v48
    v_sub_f32 v44, v44, v48
    v_sub_f32 v45, v45, v48
    v_sub_f32 v46, v46, v48
    v_sub_f32 v47, v47, v48
    v_mul_f32 v32, v32, v49
    v_mul_f32 v33, v33, v49
    v_mul_f32 v34, v34, v49
    v_mul_f32 v35, v35, v49
    v_mul_f32 v36, v36, v49
    v_mul_f32 v37, v37, v49
    v_mul_f32 v38, v38, v49
    v_mul_f32 v39, v39, v49
    v_mul_f32 v40, v40, v49
    v_mul_f32 v41, v41, v49
    v_mul_f32 v42, v42, v49
    v_mul_f32 v43, v43, v49
    v_mul_f32 v44, v44, v49
    v_mul_f32 v45, v45, v49
    v_mul_f32 v46, v46, v49
    v_mul_f32 v47, v47, v49
    v_lshrrev_b32 v28, 5, v0
    v_and_b32 v9, 31, v0
    v_mul_u32_u24 v29, 2560, v28
    v_lshl_add_u32 v29, v9, 4, v29
    v_cvt_f32_u32 v28, v28
    s_lshl_b32 s60, s31, 10
    s_add_u32 s60, s60, 156672
    v_add_u32 v9, s60, v1
    v_lshl_add_u32 v10, v13, 5, s60
    s_lshr_b32 s62, s68, 5
    s_mul_i32 s62, s62, 40960
    s_and_b32 s61, s68, 31
    s_lshl_b32 s61, s61, 4
    s_add_u32 s62, s62, s61
    s_lshl_b32 s61, s31, 13
    s_add_u32 s62, s62, s61
    s_add_u32 s62, s62, 2097152
    s_add_u32 s63, s62, 4096
    v_lshlrev_b32 v11, 9, v13
    v_lshl_add_u32 v11, v12, 4, v11
    s_lshl_b32 s61, s31, 9
    s_add_u32 s61, s61, 1048576
    s_add_u32 s60, s61, 15360
    s_add_u32 s64, s61, 30720
    s_add_u32 s65, s61, 46080
    v_add_u32 v30, 20, v15
    v_mov_b32 v31, 0x0c0c0400
    s_cmp_lg_u32 s31, 4
    s_cbranch_scc1 L_nq_11
    s_and_b32 s84, s31, 3
    s_lshr_b32 s85, s31, 2
    s_mul_i32 s87, s52, 163840
    s_add_u32 s87, s87, 2097152
    s_mul_i32 s86, s3, 10
    s_add_u32 s86, s86, s84
    s_lshl_b32 s86, s86, 10
    s_add_u32 s86, s86, s87
    s_add_u32 s87, s87, 40960
    s_add_u32 s42, s86, 0
    s_cmp_ge_u32 s42, s87
    s_cselect_b32 s0, 40960, 0
    s_sub_u32 s42, s42, s0
    s_add_u32 s43, s86, 4096
    s_cmp_ge_u32 s43, s87
    s_cselect_b32 s0, 40960, 0
    s_sub_u32 s43, s43, s0
    s_add_u32 s44, s86, 8192
    s_cmp_ge_u32 s44, s87
    s_cselect_b32 s0, 40960, 0
    s_sub_u32 s44, s44, s0
    s_add_u32 s45, s86, 12288
    s_cmp_ge_u32 s45, s87
    s_cselect_b32 s0, 40960, 0
    s_sub_u32 s45, s45, s0
    s_add_u32 s46, s86, 16384
    s_cmp_ge_u32 s46, s87
    s_cselect_b32 s0, 40960, 0
    s_sub_u32 s46, s46, s0
    s_add_u32 s47, s86, 20480
    s_cmp_ge_u32 s47, s87
    s_cselect_b32 s0, 40960, 0
    s_sub_u32 s47, s47, s0
    s_add_u32 s48, s86, 24576
    s_cmp_ge_u32 s48, s87
    s_cselect_b32 s0, 40960, 0
    s_sub_u32 s48, s48, s0
    s_add_u32 s49, s86, 28672
    s_cmp_ge_u32 s49, s87
    s_cselect_b32 s0, 40960, 0
    s_sub_u32 s49, s49, s0
    s_add_u32 s50, s86, 32768
    s_cmp_ge_u32 s50, s87
    s_cselect_b32 s0, 40960, 0
    s_sub_u32 s50, s50, s0
    s_add_u32 s51, s86, 36864
    s_cmp_ge_u32 s51, s87
    s_cselect_b32 s0, 40960, 0
    s_sub_u32 s51, s51, s0
L_nq_11:
    s_cmp_lt_u32 s59, 20
    s_cbranch_scc1 L_gl_12
    s_mov_b64 exec, 7
L_ls_14:
    ds_read_b32 v8, v30
    s_sub_i32 s66, s66, 1
    s_cmp_lt_i32 s66, 0
    s_cbranch_scc1 L_lsd_15
    s_waitcnt lgkmcnt(0)
    v_cmp_gt_u32 vcc, 1, v8
    s_cbranch_vccnz L_ls_14
L_lsd_15:
    s_waitcnt lgkmcnt(0)
    s_mov_b64 exec, -1
L_gl_12:
    buffer_load_dwordx4 v[48:51], v29, s[4:7], s61 offen sc1
    buffer_load_dwordx4 v[52:55], v29, s[4:7], s60 offen sc1
    buffer_load_dwordx4 v[56:59], v29, s[4:7], s64 offen sc1
    buffer_load_dwordx4 v[60:63], v29, s[4:7], s65 offen sc1
    s_sub_i32 s66, s66, 4
    s_cmp_lt_i32 s66, 0
    s_cbranch_scc1 L_gd_13
    s_waitcnt vmcnt(3)
    v_perm_b32 v64, v49, v48, v31
    v_perm_b32 v65, v51, v50, v31
    v_lshl_or_b32 v64, v65, 16, v64
    v_xor_b32 v66, s30, v64
    v_and_b32 v48, 0xffffff00, v48
    v_and_b32 v49, 0xffffff00, v49
    v_and_b32 v50, 0xffffff00, v50
    v_and_b32 v51, 0xffffff00, v51
    s_waitcnt vmcnt(2)
    v_perm_b32 v64, v53, v52, v31
    v_perm_b32 v65, v55, v54, v31
    v_lshl_or_b32 v64, v65, 16, v64
    v_xor_b32 v67, s30, v64
    v_and_b32 v52, 0xffffff00, v52
    v_and_b32 v53, 0xffffff00, v53
    v_and_b32 v54, 0xffffff00, v54
    v_and_b32 v55, 0xffffff00, v55
    s_waitcnt vmcnt(1)
    v_perm_b32 v64, v57, v56, v31
    v_perm_b32 v65, v59, v58, v31
    v_lshl_or_b32 v64, v65, 16, v64
    v_xor_b32 v68, s30, v64
    v_and_b32 v56, 0xffffff00, v56
    v_and_b32 v57, 0xffffff00, v57
    v_and_b32 v58, 0xffffff00, v58
    v_and_b32 v59, 0xffffff00, v59
    s_waitcnt vmcnt(0)
    v_perm_b32 v64, v61, v60, v31
    v_perm_b32 v65, v63, v62, v31
    v_lshl_or_b32 v64, v65, 16, v64
    v_xor_b32 v69, s30, v64
    v_and_b32 v60, 0xffffff00, v60
    v_and_b32 v61, 0xffffff00, v61
    v_and_b32 v62, 0xffffff00, v62
    v_and_b32 v63, 0xffffff00, v63
    v_or3_b32 v66, v66, v67, v68
    v_or_b32 v66, v66, v69
    v_cmp_ne_u32 vcc, 0, v66
    s_cbranch_vccnz L_gl_12
L_gd_13:
    s_waitcnt vmcnt(0)
    v_add_f32 v48, v48, v52
    v_add_f32 v56, v56, v60
    v_add_f32 v49, v49, v53
    v_add_f32 v57, v57, v61
    v_add_f32 v50, v50, v54
    v_add_f32 v58, v58, v62
    v_add_f32 v51, v51, v55
    v_add_f32 v59, v59, v63
    v_add_f32 v48, v48, v56
    v_add_f32 v49, v49, v57
    v_add_f32 v50, v50, v58
    v_add_f32 v51, v51, v59
    v_cvt_pk_bf16_f32 v52, v48, v49
    v_cvt_pk_bf16_f32 v53, v50, v51
    v_lshlrev_b32 v48, 16, v52
    v_and_b32 v49, 0xffff0000, v52
    v_lshlrev_b32 v50, 16, v53
    v_and_b32 v51, 0xffff0000, v53
    v_add_f32 v48, v48, v28
    v_add_f32 v49, v49, v28
    v_add_f32 v50, v50, v28
    v_add_f32 v51, v51, v28
    v_cvt_pk_bf16_f32 v48, v48, v49
    v_cvt_pk_bf16_f32 v49, v50, v51
    v_lshlrev_b32 v52, 16, v48
    v_and_b32 v53, 0xffff0000, v48
    v_lshlrev_b32 v54, 16, v49
    v_and_b32 v55, 0xffff0000, v49
    ds_write_b128 v9, v[52:55]
    ds_read_b128 v[48:51], v10 offset:0
    ds_read_b128 v[52:55], v10 offset:16
    ds_read_b128 v[56:59], v10 offset:512
    ds_read_b128 v[60:63], v10 offset:528
    ds_read_b128 v[64:67], v10 offset:256
    ds_read_b128 v[68:71], v10 offset:272
    ds_read_b128 v[72:75], v10 offset:768
    ds_read_b128 v[76:79], v10 offset:784
    s_waitcnt lgkmcnt(4)
    v_fma_f32 v32, v32, v56, v48
    v_fma_f32 v33, v33, v57, v49
    v_fma_f32 v34, v34, v58, v50
    v_fma_f32 v35, v35, v59, v51
    v_fma_f32 v36, v36, v60, v52
    v_fma_f32 v37, v37, v61, v53
    v_fma_f32 v38, v38, v62, v54
    v_fma_f32 v39, v39, v63, v55
    v_cvt_pk_bf16_f32 v16, v32, v33
    v_cvt_pk_bf16_f32 v17, v34, v35
    v_cvt_pk_bf16_f32 v18, v36, v37
    v_cvt_pk_bf16_f32 v19, v38, v39
    buffer_store_dwordx4 v[16:19], v11, s[4:7], s62 offen sc1
    s_waitcnt lgkmcnt(0)
    v_fma_f32 v40, v40, v72, v64
    v_fma_f32 v41, v41, v73, v65
    v_fma_f32 v42, v42, v74, v66
    v_fma_f32 v43, v43, v75, v67
    v_fma_f32 v44, v44, v76, v68
    v_fma_f32 v45, v45, v77, v69
    v_fma_f32 v46, v46, v78, v70
    v_fma_f32 v47, v47, v79, v71
    v_cvt_pk_bf16_f32 v20, v40, v41
    v_cvt_pk_bf16_f32 v21, v42, v43
    v_cvt_pk_bf16_f32 v22, v44, v45
    v_cvt_pk_bf16_f32 v23, v46, v47
    buffer_store_dwordx4 v[20:23], v11, s[4:7], s63 offen sc1
    s_cmp_eq_u32 s31, 4
    s_cbranch_scc1 L_nq_11_b
    s_call_b64 s[40:41], L_setup
L_nq_11_b:
    v_mov_b32 v8, 5
    s_lshl_b32 s60, s52, 11
    s_lshl_b32 s61, s53, 2
    s_add_u32 s60, s60, s61
    s_add_u32 s60, s60, 32768
    v_lshlrev_b32 v10, 7, v0
    v_mov_b32 v11, s30
    s_waitcnt vmcnt(0)
    ds_write_b32 v14, v8
    s_cmp_lg_u32 s31, 0
    s_cbranch_scc1 L_join_2
    s_mov_b64 exec, 31
L_ls_16:
    ds_read_b32 v9, v15
    s_sub_i32 s66, s66, 1
    s_cmp_lt_i32 s66, 0
    s_cbranch_scc1 L_lsd_17
    s_waitcnt lgkmcnt(0)
    v_cmp_gt_u32 vcc, 5, v9
    s_cbranch_vccnz L_ls_16
L_lsd_17:
    s_waitcnt lgkmcnt(0)
    s_mov_b64 exec, -1
    s_mov_b64 exec, 0x7fff
    buffer_store_dword v11, v10, s[4:7], s60 offen sc1
    s_mov_b64 exec, -1
    s_branch L_join_2
L_L_1:
    v_lshrrev_b32 v10, 4, v0
    v_and_b32 v11, 15, v0
    v_lshlrev_b32 v14, 1, v10
    v_xor_b32 v11, v11, v14
    v_mul_u32_u24 v10, 3840, v10
    v_lshl_add_u32 v10, v11, 4, v10
    s_lshl_b32 s61, s53, 8
    v_add_u32 v10, s61, v10
    v_xor_b32 v11, 128, v10
    s_sub_u32 s68, s31, 5
    s_mul_i32 s69, s68, 61440
    s_mul_i32 s61, s3, 614400
    s_add_u32 s69, s69, s61
    s_lshl_b32 m0, s68, 12
    s_waitcnt lgkmcnt(0)
    s_load_dword s30, s[4:5], 360448
    s_load_dwordx2 s[24:25], s[0:1], 64
    s_load_dwordx2 s[32:33], s[0:1], 16
    s_load_dwordx4 s[36:39], s[0:1], 32
    s_barrier
    v_lshlrev_b32 v1, 4, v0
    s_mov_b32 s58, s2
    s_mov_b32 s66, 16777216
    s_and_b32 s60, s2, 7
    s_lshl_b32 s56, s60, 2
    s_lshr_b32 s54, s2, 6
    s_add_u32 s54, s54, s56
    s_bfe_u32 s60, s2, 0x20003
    s_add_u32 s56, s56, s60
    s_bfe_u32 s55, s2, 0x30003
    s_mov_b32 s26, 2621440
    s_mov_b32 s27, 0x20000
    s_cmp_eq_u32 s53, 15
    s_cbranch_scc1 L_lc_20
L_la_18:
    buffer_load_dwordx4 v10, s[12:15], s69 offen lds
    s_add_u32 m0, m0, 1024
    s_add_u32 s69, s69, 15360
    buffer_load_dwordx4 v10, s[12:15], s69 offen lds
    s_add_u32 m0, m0, 1024
    s_add_u32 s69, s69, 15360
    buffer_load_dwordx4 v11, s[12:15], s69 offen lds
    s_add_u32 m0, m0, 1024
    s_add_u32 s69, s69, 15360
    buffer_load_dwordx4 v11, s[12:15], s69 offen lds
    s_add_u32 m0, m0, 9216
    s_add_u32 s69, s69, 138240
    s_cmp_ge_u32 s69, 2457600
    s_cselect_b32 s61, 2457600, 0
    s_sub_u32 s69, s69, s61
    s_add_u32 s68, s68, 3
    s_cmp_lt_u32 s68, 3
    s_cbranch_scc1 L_la_18
    s_cmp_ge_u32 s59, 20
    s_cbranch_scc1 L_nh_21
    s_mov_b64 exec, 15
L_ls_22:
    ds_read_b32 v9, v15
    s_sub_i32 s66, s66, 1
    s_cmp_lt_i32 s66, 0
    s_cbranch_scc1 L_lsd_23
    s_waitcnt lgkmcnt(0)
    v_cmp_gt_u32 vcc, 2, v9
    s_cbranch_vccnz L_ls_22
L_lsd_23:
    s_waitcnt lgkmcnt(0)
    s_mov_b64 exec, -1
L_nh_21:
L_lb_19:
    buffer_load_dwordx4 v10, s[12:15], s69 offen lds
    s_add_u32 m0, m0, 1024
    s_add_u32 s69, s69, 15360
    buffer_load_dwordx4 v10, s[12:15], s69 offen lds
    s_add_u32 m0, m0, 1024
    s_add_u32 s69, s69, 15360
    buffer_load_dwordx4 v11, s[12:15], s69 offen lds
    s_add_u32 m0, m0, 1024
    s_add_u32 s69, s69, 15360
    buffer_load_dwordx4 v11, s[12:15], s69 offen lds
    s_add_u32 m0, m0, 9216
    s_add_u32 s69, s69, 138240
    s_cmp_ge_u32 s69, 2457600
    s_cselect_b32 s61, 2457600, 0
    s_sub_u32 s69, s69, s61
    s_add_u32 s68, s68, 3
    s_cmp_lt_u32 s68, 16
    s_cbranch_scc1 L_lb_19
    s_lshl_b32 s60, s31, 2
    s_add_u32 s60, s60, 155648
    v_mov_b32 v14, s60
    v_mov_b32 v8, 1
    s_waitcnt vmcnt(4)
    ds_write_b32 v14, v8
L_lb_19_2:
    buffer_load_dwordx4 v10, s[12:15], s69 offen lds
    s_add_u32 m0, m0, 1024
    s_add_u32 s69, s69, 15360
    buffer_load_dwordx4 v10, s[12:15], s69 offen lds
    s_add_u32 m0, m0, 1024
    s_add_u32 s69, s69, 15360
    buffer_load_dwordx4 v11, s[12:15], s69 offen lds
    s_add_u32 m0, m0, 1024
    s_add_u32 s69, s69, 15360
    buffer_load_dwordx4 v11, s[12:15], s69 offen lds
    s_add_u32 m0, m0, 9216
    s_add_u32 s69, s69, 138240
    s_cmp_ge_u32 s69, 2457600
    s_cselect_b32 s61, 2457600, 0
    s_sub_u32 s69, s69, s61
    s_add_u32 s68, s68, 3
    s_cmp_lt_u32 s68, 38
    s_cbranch_scc1 L_lb_19_2
    s_cmp_eq_u32 s68, 40
    s_cbranch_scc1 L_lc_20
    buffer_load_dwordx4 v[80:83], v10, s[12:15], s69 offen
    s_add_u32 s69, s69, 15360
    buffer_load_dwordx4 v[84:87], v10, s[12:15], s69 offen
    s_add_u32 s69, s69, 15360
    buffer_load_dwordx4 v[88:91], v11, s[12:15], s69 offen
    s_add_u32 s69, s69, 15360
    buffer_load_dwordx4 v[92:95], v11, s[12:15], s69 offen
    s_add_u32 s69, s69, 15360
L_lc_20:
    s_lshl_b32 s60, s31, 2
    s_add_u32 s60, s60, 155648
    v_mov_b32 v14, s60
    v_mov_b32 v8, 2
    s_waitcnt vmcnt(0) lgkmcnt(0)
    ds_write_b32 v14, v8
    s_add_u32 s30, s30, 0x9e3779b9
    s_mov_b32 s28, s30
    s_mov_b32 s29, s30
    s_mov_b64 s[20:21], s[8:9]
    s_mov_b32 s22, 0
    s_mov_b32 s23, 0x20000
    s_and_b32 s84, s31, 3
    s_lshr_b32 s85, s31, 2
    s_mul_i32 s87, s52, 163840
    s_add_u32 s87, s87, 2097152
    s_mul_i32 s86, s3, 10
    s_add_u32 s86, s86, s84
    s_lshl_b32 s86, s86, 10
    s_add_u32 s86, s86, s87
    s_add_u32 s87, s87, 40960
    s_add_u32 s42, s86, 0
    s_cmp_ge_u32 s42, s87
    s_cselect_b32 s0, 40960, 0
    s_sub_u32 s42, s42, s0
    s_add_u32 s43, s86, 4096
    s_cmp_ge_u32 s43, s87
    s_cselect_b32 s0, 40960, 0
    s_sub_u32 s43, s43, s0
    s_add_u32 s44, s86, 8192
    s_cmp_ge_u32 s44, s87
    s_cselect_b32 s0, 40960, 0
    s_sub_u32 s44, s44, s0
    s_add_u32 s45, s86, 12288
    s_cmp_ge_u32 s45, s87
    s_cselect_b32 s0, 40960, 0
    s_sub_u32 s45, s45, s0
    s_add_u32 s46, s86, 16384
    s_cmp_ge_u32 s46, s87
    s_cselect_b32 s0, 40960, 0
    s_sub_u32 s46, s46, s0
    s_add_u32 s47, s86, 20480
    s_cmp_ge_u32 s47, s87
    s_cselect_b32 s0, 40960, 0
    s_sub_u32 s47, s47, s0
    s_add_u32 s48, s86, 24576
    s_cmp_ge_u32 s48, s87
    s_cselect_b32 s0, 40960, 0
    s_sub_u32 s48, s48, s0
    s_add_u32 s49, s86, 28672
    s_cmp_ge_u32 s49, s87
    s_cselect_b32 s0, 40960, 0
    s_sub_u32 s49, s49, s0
    s_add_u32 s50, s86, 32768
    s_cmp_ge_u32 s50, s87
    s_cselect_b32 s0, 40960, 0
    s_sub_u32 s50, s50, s0
    s_add_u32 s51, s86, 36864
    s_cmp_ge_u32 s51, s87
    s_cselect_b32 s0, 40960, 0
    s_sub_u32 s51, s51, s0
L_join_2:
    s_cmp_eq_u32 s53, 15
    s_cbranch_scc1 L_qkvdone_24
    v_add_u32 v15, 20, v15
    s_mov_b32 s1, s68
    v_lshrrev_b32 v13, 4, v0
    v_bfe_u32 v9, v0, 2, 2
    v_lshl_add_u32 v10, v13, 3, v9
    v_lshlrev_b32 v10, 8, v10
    v_bfe_u32 v9, v0, 2, 3
    s_and_b32 s60, s31, 3
    s_lshl_b32 s60, s60, 1
    v_xor_b32 v9, s60, v9
    v_lshl_add_u32 v10, v9, 5, v10
    v_and_b32 v9, 3, v0
    v_lshl_add_u32 v10, v9, 3, v10
    v_xor_b32 v11, 32, v10
    s_mov_b64 exec, 7
L_ls_28:
    ds_read_b32 v9, v15
    s_sub_i32 s66, s66, 1
    s_cmp_lt_i32 s66, 0
    s_cbranch_scc1 L_lsd_29
    s_waitcnt lgkmcnt(0)
    v_cmp_gt_u32 vcc, 2, v9
    s_cbranch_vccnz L_ls_28
L_lsd_29:
    s_waitcnt lgkmcnt(0)
    s_mov_b64 exec, -1
    ds_read_b64_tr_b16 v[96:97], v10 offset:0
    ds_read_b64_tr_b16 v[98:99], v10 offset:1024
    ds_read_b64_tr_b16 v[100:101], v11 offset:0
    ds_read_b64_tr_b16 v[102:103], v11 offset:1024
    ds_read_b64_tr_b16 v[104:105], v10 offset:8192
    ds_read_b64_tr_b16 v[106:107], v10 offset:9216
    ds_read_b64_tr_b16 v[108:109], v11 offset:8192
    ds_read_b64_tr_b16 v[110:111], v11 offset:9216
    ds_read_b64_tr_b16 v[112:113], v10 offset:16384
    ds_read_b64_tr_b16 v[114:115], v10 offset:17408
    ds_read_b64_tr_b16 v[116:117], v11 offset:16384
    ds_read_b64_tr_b16 v[118:119], v11 offset:17408
    ds_read_b64_tr_b16 v[120:121], v10 offset:24576
    ds_read_b64_tr_b16 v[122:123], v10 offset:25600
    ds_read_b64_tr_b16 v[124:125], v11 offset:24576
    ds_read_b64_tr_b16 v[126:127], v11 offset:25600
    ds_read_b64_tr_b16 v[128:129], v10 offset:32768
    ds_read_b64_tr_b16 v[130:131], v10 offset:33792
    ds_read_b64_tr_b16 v[132:133], v11 offset:32768
    ds_read_b64_tr_b16 v[134:135], v11 offset:33792
    ds_read_b64_tr_b16 v[136:137], v10 offset:40960
    ds_read_b64_tr_b16 v[138:139], v10 offset:41984
    ds_read_b64_tr_b16 v[140:141], v11 offset:40960
    ds_read_b64_tr_b16 v[142:143], v11 offset:41984
    ds_read_b64_tr_b16 v[144:145], v10 offset:49152
    ds_read_b64_tr_b16 v[146:147], v10 offset:50176
    ds_read_b64_tr_b16 v[148:149], v11 offset:49152
    ds_read_b64_tr_b16 v[150:151], v11 offset:50176
    ds_read_b64_tr_b16 v[152:153], v10 offset:57344
    ds_read_b64_tr_b16 v[154:155], v10 offset:58368
    ds_read_b64_tr_b16 v[156:157], v11 offset:57344
    ds_read_b64_tr_b16 v[158:159], v11 offset:58368
    v_add_u32 v10, 0x10000, v10
    v_add_u32 v11, 0x10000, v11
    ds_read_b64_tr_b16 v[160:161], v10 offset:0
    ds_read_b64_tr_b16 v[162:163], v10 offset:1024
    ds_read_b64_tr_b16 v[164:165], v11 offset:0
    ds_read_b64_tr_b16 v[166:167], v11 offset:1024
    ds_read_b64_tr_b16 v[168:169], v10 offset:8192
    ds_read_b64_tr_b16 v[170:171], v10 offset:9216
    ds_read_b64_tr_b16 v[172:173], v11 offset:8192
    ds_read_b64_tr_b16 v[174:175], v11 offset:9216
    ds_read_b64_tr_b16 v[176:177], v10 offset:16384
    ds_read_b64_tr_b16 v[178:179], v10 offset:17408
    ds_read_b64_tr_b16 v[180:181], v11 offset:16384
    ds_read_b64_tr_b16 v[182:183], v11 offset:17408
    ds_read_b64_tr_b16 v[184:185], v10 offset:24576
    ds_read_b64_tr_b16 v[186:187], v10 offset:25600
    ds_read_b64_tr_b16 v[188:189], v11 offset:24576
    ds_read_b64_tr_b16 v[190:191], v11 offset:25600
    ds_read_b64_tr_b16 v[192:193], v10 offset:32768
    ds_read_b64_tr_b16 v[194:195], v10 offset:33792
    ds_read_b64_tr_b16 v[196:197], v11 offset:32768
    ds_read_b64_tr_b16 v[198:199], v11 offset:33792
    ds_read_b64_tr_b16 v[200:201], v10 offset:40960
    ds_read_b64_tr_b16 v[202:203], v10 offset:41984
    ds_read_b64_tr_b16 v[204:205], v11 offset:40960
    ds_read_b64_tr_b16 v[206:207], v11 offset:41984
    ds_read_b64_tr_b16 v[208:209], v10 offset:49152
    ds_read_b64_tr_b16 v[210:211], v10 offset:50176
    ds_read_b64_tr_b16 v[212:213], v11 offset:49152
    ds_read_b64_tr_b16 v[214:215], v11 offset:50176
    ds_read_b64_tr_b16 v[216:217], v10 offset:57344
    ds_read_b64_tr_b16 v[218:219], v10 offset:58368
    ds_read_b64_tr_b16 v[220:221], v11 offset:57344
    ds_read_b64_tr_b16 v[222:223], v11 offset:58368
    v_add_u32 v10, 0x10000, v10
    v_add_u32 v11, 0x10000, v11
    ds_read_b64_tr_b16 v[224:225], v10 offset:0
    ds_read_b64_tr_b16 v[226:227], v10 offset:1024
    ds_read_b64_tr_b16 v[228:229], v11 offset:0
    ds_read_b64_tr_b16 v[230:231], v11 offset:1024
    ds_read_b64_tr_b16 v[232:233], v10 offset:8192
    ds_read_b64_tr_b16 v[234:235], v10 offset:9216
    ds_read_b64_tr_b16 v[236:237], v11 offset:8192
    ds_read_b64_tr_b16 v[238:239], v11 offset:9216
    ds_read_b64_tr_b16 v[240:241], v10 offset:16384
    ds_read_b64_tr_b16 v[242:243], v10 offset:17408
    ds_read_b64_tr_b16 v[244:245], v11 offset:16384
    ds_read_b64_tr_b16 v[246:247], v11 offset:17408
    s_lshl_b32 s65, s52, 4
    s_add_u32 s65, s65, s53
    s_lshl_b32 s65, s65, 7
    s_add_u32 s65, s65, 32768
    s_cmp_lg_u32 s31, 7
    s_cbranch_scc1 L_nw_27_p
    s_buffer_load_dwordx16 s[68:83], s[4:7], s65 glc
L_nw_27_p:
    v_and_b32 v12, 15, v0
    v_lshlrev_b32 v14, 9, v13
    v_lshl_add_u32 v14, v12, 4, v14
    s_mul_i32 s60, s85, 81920
    s_sub_u32 s60, 81920, s60
    v_add_u32 v14, s60, v14
    v_add_u32 v15, 40960, v14
    s_lshl_b32 s61, s84, 10
    s_add_u32 m0, s61, 81920
    v_add_u32 v3, 81920, v1
    v_add_u32 v4, 40960, v1
    v_add_u32 v5, 122880, v1
    s_waitcnt lgkmcnt(0)
    s_cmp_lg_u32 s31, 7
    s_cbranch_scc1 L_nw_27_r
    s_cmp_lg_u64 s[68:69], s[28:29]
    s_cbranch_scc1 L_nw_27_q
    s_cmp_lg_u64 s[70:71], s[28:29]
    s_cbranch_scc1 L_nw_27_q
    s_cmp_lg_u64 s[72:73], s[28:29]
    s_cbranch_scc1 L_nw_27_q
    s_cmp_lg_u64 s[74:75], s[28:29]
    s_cbranch_scc1 L_nw_27_q
    s_cmp_lg_u64 s[76:77], s[28:29]
    s_cbranch_scc1 L_nw_27_q
    s_cmp_lg_u64 s[78:79], s[28:29]
    s_cbranch_scc1 L_nw_27_q
    s_cmp_lg_u64 s[80:81], s[28:29]
    s_cbranch_scc1 L_nw_27_q
    s_cmp_lg_u64 s[82:83], s[28:29]
    s_cbranch_scc1 L_nw_27_q
    s_branch L_nw_27_r
L_nw_27_q:
L_sp_30:
    s_buffer_load_dwordx16 s[68:83], s[4:7], s65 glc
    s_sub_i32 s66, s66, 4
    s_cmp_lt_i32 s66, 0
    s_waitcnt lgkmcnt(0)
    s_cbranch_scc1 L_spd_31
    s_cmp_lg_u64 s[68:69], s[28:29]
    s_cbranch_scc1 L_sp_30
    s_cmp_lg_u64 s[70:71], s[28:29]
    s_cbranch_scc1 L_sp_30
    s_cmp_lg_u64 s[72:73], s[28:29]
    s_cbranch_scc1 L_sp_30
    s_cmp_lg_u64 s[74:75], s[28:29]
    s_cbranch_scc1 L_sp_30
    s_cmp_lg_u64 s[76:77], s[28:29]
    s_cbranch_scc1 L_sp_30
    s_cmp_lg_u64 s[78:79], s[28:29]
    s_cbranch_scc1 L_sp_30
    s_cmp_lg_u64 s[80:81], s[28:29]
    s_cbranch_scc1 L_sp_30
    s_cmp_lg_u64 s[82:83], s[28:29]
    s_cbranch_scc1 L_sp_30
L_spd_31:
L_nw_27_r:
    s_barrier
    s_cmp_eq_u32 s85, 0
    s_cbranch_scc1 L_comp_32
    buffer_load_dwordx4 v1, s[4:7], s42 offen sc1 lds
    s_add_u32 m0, m0, 4096
    s_nop 0
    buffer_load_dwordx4 v1, s[4:7], s43 offen sc1 lds
    s_add_u32 m0, m0, 4096
    s_nop 0
    buffer_load_dwordx4 v1, s[4:7], s44 offen sc1 lds
    s_add_u32 m0, m0, 4096
    s_nop 0
    buffer_load_dwordx4 v1, s[4:7], s45 offen sc1 lds
    s_add_u32 m0, m0, 4096
    s_nop 0
    buffer_load_dwordx4 v1, s[4:7], s46 offen sc1 lds
    s_add_u32 m0, m0, 4096
    s_nop 0
    buffer_load_dwordx4 v1, s[4:7], s47 offen sc1 lds
    s_add_u32 m0, m0, 4096
    s_nop 0
    buffer_load_dwordx4 v1, s[4:7], s48 offen sc1 lds
    s_add_u32 m0, m0, 4096
    s_nop 0
    buffer_load_dwordx4 v1, s[4:7], s49 offen sc1 lds
    s_add_u32 m0, m0, 4096
    s_nop 0
    buffer_load_dwordx4 v1, s[4:7], s50 offen sc1 lds
    s_add_u32 m0, m0, 4096
    s_nop 0
    buffer_load_dwordx4 v1, s[4:7], s51 offen sc1 lds
    s_add_u32 m0, m0, 4096
    s_nop 0
    buffer_load_dwordx4 v3, s[4:7], s42 offen sc1 lds
    s_add_u32 m0, m0, 4096
    s_cmp_eq_u32 s31, 4
    s_cbranch_scc1 L_nw_27
    s_cmp_eq_u32 s1, 40
    s_cbranch_scc1 L_nw_27
    s_lshl_b32 s60, s1, 12
    v_add_u32 v8, s60, v1
    ds_write_b128 v8, v[80:83] offset:0
    ds_write_b128 v8, v[84:87] offset:1024
    ds_write_b128 v8, v[88:91] offset:2048
    ds_write_b128 v8, v[92:95] offset:3072
L_nw_27:
    s_waitcnt vmcnt(8)
    s_waitcnt lgkmcnt(0)
    s_barrier
    ds_read_b64_tr_b16 v[248:249], v10 offset:24576
    ds_read_b64_tr_b16 v[250:251], v10 offset:25600
    ds_read_b64_tr_b16 v[252:253], v11 offset:24576
    ds_read_b64_tr_b16 v[254:255], v11 offset:25600
    buffer_load_dwordx4 v3, s[4:7], s43 offen sc1 lds
    s_add_u32 m0, m0, 4096
    s_nop 0
    buffer_load_dwordx4 v3, s[4:7], s44 offen sc1 lds
    s_add_u32 m0, m0, 4096
    s_nop 0
    buffer_load_dwordx4 v3, s[4:7], s45 offen sc1 lds
    s_add_u32 m0, m0, 4096
    s_waitcnt vmcnt(8)
    s_waitcnt lgkmcnt(0)
    s_barrier
    buffer_load_dwordx4 v3, s[4:7], s46 offen sc1 lds
    s_add_u32 m0, m0, 4096
    s_nop 0
    buffer_load_dwordx4 v3, s[4:7], s47 offen sc1 lds
    s_add_u32 m0, m0, 4096
    s_nop 0
    buffer_load_dwordx4 v3, s[4:7], s48 offen sc1 lds
    s_add_u32 m0, m0, 4096
    s_nop 0
    buffer_load_dwordx4 v3, s[4:7], s49 offen sc1 lds
    s_add_u32 m0, m0, 4096
    s_nop 0
    buffer_load_dwordx4 v3, s[4:7], s50 offen sc1 lds
    s_add_u32 m0, m0, 4096
    s_waitcnt vmcnt(8)
    s_waitcnt lgkmcnt(0)
    s_barrier
    buffer_load_dwordx4 v3, s[4:7], s51 offen sc1 lds
    s_sub_u32 m0, m0, 159744
    s_nop 0
    buffer_load_dwordx4 v4, s[4:7], s42 offen sc1 lds
    s_add_u32 m0, m0, 4096
    s_nop 0
    buffer_load_dwordx4 v4, s[4:7], s43 offen sc1 lds
    s_add_u32 m0, m0, 4096
    s_nop 0
    buffer_load_dwordx4 v4, s[4:7], s44 offen sc1 lds
    s_add_u32 m0, m0, 4096
    s_nop 0
    buffer_load_dwordx4 v4, s[4:7], s45 offen sc1 lds
    s_add_u32 m0, m0, 4096
    s_nop 0
    buffer_load_dwordx4 v4, s[4:7], s46 offen sc1 lds
    s_add_u32 m0, m0, 4096
    s_nop 0
    buffer_load_dwordx4 v4, s[4:7], s47 offen sc1 lds
    s_add_u32 m0, m0, 4096
    s_nop 0
    buffer_load_dwordx4 v4, s[4:7], s48 offen sc1 lds
    s_add_u32 m0, m0, 4096
    s_nop 0
    buffer_load_dwordx4 v4, s[4:7], s49 offen sc1 lds
    s_add_u32 m0, m0, 4096
    s_waitcnt vmcnt(8)
    s_waitcnt lgkmcnt(0)
    s_barrier
    buffer_load_dwordx4 v4, s[4:7], s50 offen sc1 lds
    s_add_u32 m0, m0, 4096
    s_nop 0
    buffer_load_dwordx4 v4, s[4:7], s51 offen sc1 lds
    s_add_u32 m0, m0, 4096
    s_nop 0
    buffer_load_dwordx4 v5, s[4:7], s42 offen sc1 lds
    s_add_u32 m0, m0, 4096
    s_nop 0
    buffer_load_dwordx4 v5, s[4:7], s43 offen sc1 lds
    s_add_u32 m0, m0, 4096
    s_nop 0
    buffer_load_dwordx4 v5, s[4:7], s44 offen sc1 lds
    s_add_u32 m0, m0, 4096
    s_nop 0
    buffer_load_dwordx4 v5, s[4:7], s45 offen sc1 lds
    s_add_u32 m0, m0, 4096
    s_nop 0
    buffer_load_dwordx4 v5, s[4:7], s46 offen sc1 lds
    s_add_u32 m0, m0, 4096
    s_nop 0
    buffer_load_dwordx4 v5, s[4:7], s47 offen sc1 lds
    s_add_u32 m0, m0, 4096
    s_nop 0
    buffer_load_dwordx4 v5, s[4:7], s48 offen sc1 lds
    s_add_u32 m0, m0, 4096
    s_nop 0
    buffer_load_dwordx4 v5, s[4:7], s49 offen sc1 lds
    s_add_u32 m0, m0, 4096
    s_nop 0
    buffer_load_dwordx4 v5, s[4:7], s50 offen sc1 lds
    s_add_u32 m0, m0, 4096
    s_nop 0
    buffer_load_dwordx4 v5, s[4:7], s51 offen sc1 lds
    s_add_u32 m0, m0, 4096
    s_call_b64 s[40:41], L_setup
    s_waitcnt vmcnt(5)
L_comp_32:
    s_cmp_ge_u32 s53, 10
    s_cbranch_scc1 L_qkvv_25
    s_mov_b32 s64, 1.0
    s_cmp_lt_u32 s53, 5
    s_cmov_b32 s64, 0x3ea52b5c
    s_mov_b32 s65, s64
    v_and_b32 v8, 1, v13
    v_lshrrev_b32 v9, 1, v13
    v_lshl_or_b32 v8, v8, 1, v9
    v_mul_u32_u24 v8, 32768, v8
    v_lshl_add_u32 v8, v12, 4, v8
    s_lshl_b32 s60, s53, 2
    s_add_u32 s60, s60, s84
    s_mul_i32 s60, s60, 131072
    s_lshl_b32 s61, s52, 10
    s_add_u32 s60, s60, s61
    s_lshl_b32 s61, s85, 14
    s_add_u32 s60, s60, s61
    s_add_u32 s60, s60, 4718592
    s_lshl_b32 s61, s31, 2
    s_add_u32 s61, s61, 158656
    v_mov_b32 v4, s61
    v_mov_b32 v3, 1
    s_barrier
    s_cmp_eq_u32 s85, 0
    s_cbranch_scc0 L_l19_33
    ds_read_b64_tr_b16 v[248:249], v10 offset:24576
    ds_read_b64_tr_b16 v[250:251], v10 offset:25600
    ds_read_b64_tr_b16 v[252:253], v11 offset:24576
    ds_read_b64_tr_b16 v[254:255], v11 offset:25600
L_l19_33:
    ds_read_b128 v[48:51], v14 offset:0
    ds_read_b128 v[52:55], v14 offset:256
    ds_read_b128 v[56:59], v14 offset:2048
    ds_read_b128 v[60:63], v14 offset:2304
    ds_read_b128 v[64:67], v14 offset:4096
    ds_read_b128 v[68:71], v14 offset:4352
    s_waitcnt lgkmcnt(4)
    v_mfma_f32_16x16x32_bf16 v[16:19], v[96:99], v[48:51], 0
    ds_read_b128 v[72:75], v14 offset:6144
    v_mfma_f32_16x16x32_bf16 v[20:23], v[100:103], v[48:51], 0
    ds_read_b128 v[76:79], v14 offset:6400
    v_mfma_f32_16x16x32_bf16 v[24:27], v[96:99], v[52:55], 0
    v_mfma_f32_16x16x32_bf16 v[28:31], v[100:103], v[52:55], 0
    s_waitcnt lgkmcnt(4)
    v_mfma_f32_16x16x32_bf16 v[16:19], v[104:107], v[56:59], v[16:19]
    ds_read_b128 v[48:51], v14 offset:8192
    v_mfma_f32_16x16x32_bf16 v[20:23], v[108:111], v[56:59], v[20:23]
    ds_read_b128 v[52:55], v14 offset:8448
    v_mfma_f32_16x16x32_bf16 v[24:27], v[104:107], v[60:63], v[24:27]
    v_mfma_f32_16x16x32_bf16 v[28:31], v[108:111], v[60:63], v[28:31]
    s_waitcnt lgkmcnt(4)
    v_mfma_f32_16x16x32_bf16 v[16:19], v[112:115], v[64:67], v[16:19]
    ds_read_b128 v[56:59], v14 offset:10240
    v_mfma_f32_16x16x32_bf16 v[20:23], v[116:119], v[64:67], v[20:23]
    ds_read_b128 v[60:63], v14 offset:10496
    v_mfma_f32_16x16x32_bf16 v[24:27], v[112:115], v[68:71], v[24:27]
    v_mfma_f32_16x16x32_bf16 v[28:31], v[116:119], v[68:71], v[28:31]
    s_waitcnt lgkmcnt(4)
    v_mfma_f32_16x16x32_bf16 v[16:19], v[120:123], v[72:75], v[16:19]
    s_cbranch_scc0 L_qb_34
    s_barrier
L_qb_34:
    v_mfma_f32_16x16x32_bf16 v[20:23], v[124:127], v[72:75], v[20:23]
    ds_read_b128 v[64:67], v14 offset:12288
    v_mfma_f32_16x16x32_bf16 v[24:27], v[120:123], v[76:79], v[24:27]
    ds_read_b128 v[68:71], v14 offset:12544
    v_mfma_f32_16x16x32_bf16 v[28:31], v[124:127], v[76:79], v[28:31]
    s_waitcnt lgkmcnt(4)
    v_mfma_f32_16x16x32_bf16 v[16:19], v[128:131], v[48:51], v[16:19]
    ds_read_b128 v[72:75], v14 offset:14336
    v_mfma_f32_16x16x32_bf16 v[20:23], v[132:135], v[48:51], v[20:23]
    ds_read_b128 v[76:79], v14 offset:14592
    v_mfma_f32_16x16x32_bf16 v[24:27], v[128:131], v[52:55], v[24:27]
    v_mfma_f32_16x16x32_bf16 v[28:31], v[132:135], v[52:55], v[28:31]
    s_waitcnt lgkmcnt(4)
    v_mfma_f32_16x16x32_bf16 v[16:19], v[136:139], v[56:59], v[16:19]
    ds_read_b128 v[48:51], v14 offset:16384
    v_mfma_f32_16x16x32_bf16 v[20:23], v[140:143], v[56:59], v[20:23]
    ds_read_b128 v[52:55], v14 offset:16640
    v_mfma_f32_16x16x32_bf16 v[24:27], v[136:139], v[60:63], v[24:27]
    v_mfma_f32_16x16x32_bf16 v[28:31], v[140:143], v[60:63], v[28:31]
    s_waitcnt lgkmcnt(4)
    v_mfma_f32_16x16x32_bf16 v[16:19], v[144:147], v[64:67], v[16:19]
    ds_read_b128 v[56:59], v14 offset:18432
    v_mfma_f32_16x16x32_bf16 v[20:23], v[148:151], v[64:67], v[20:23]
    ds_read_b128 v[60:63], v14 offset:18688
    v_mfma_f32_16x16x32_bf16 v[24:27], v[144:147], v[68:71], v[24:27]
    v_mfma_f32_16x16x32_bf16 v[28:31], v[148:151], v[68:71], v[28:31]
    s_waitcnt lgkmcnt(4)
    v_mfma_f32_16x16x32_bf16 v[16:19], v[152:155], v[72:75], v[16:19]
    ds_read_b128 v[64:67], v14 offset:20480
    v_mfma_f32_16x16x32_bf16 v[20:23], v[156:159], v[72:75], v[20:23]
    ds_read_b128 v[68:71], v14 offset:20736
    v_mfma_f32_16x16x32_bf16 v[24:27], v[152:155], v[76:79], v[24:27]
    v_mfma_f32_16x16x32_bf16 v[28:31], v[156:159], v[76:79], v[28:31]
    s_waitcnt lgkmcnt(4)
    v_mfma_f32_16x16x32_bf16 v[16:19], v[160:163], v[48:51], v[16:19]
    ds_read_b128 v[72:75], v14 offset:22528
    v_mfma_f32_16x16x32_bf16 v[20:23], v[164:167], v[48:51], v[20:23]
    ds_read_b128 v[76:79], v14 offset:22784
    v_mfma_f32_16x16x32_bf16 v[24:27], v[160:163], v[52:55], v[24:27]
    v_mfma_f32_16x16x32_bf16 v[28:31], v[164:167], v[52:55], v[28:31]
    s_waitcnt lgkmcnt(4)
    v_mfma_f32_16x16x32_bf16 v[16:19], v[168:171], v[56:59], v[16:19]
    s_cbranch_scc0 L_qb_35
    s_barrier
L_qb_35:
    v_mfma_f32_16x16x32_bf16 v[20:23], v[172:175], v[56:59], v[20:23]
    ds_read_b128 v[48:51], v14 offset:24576
    v_mfma_f32_16x16x32_bf16 v[24:27], v[168:171], v[60:63], v[24:27]
    ds_read_b128 v[52:55], v14 offset:24832
    v_mfma_f32_16x16x32_bf16 v[28:31], v[172:175], v[60:63], v[28:31]
    s_waitcnt lgkmcnt(4)
    v_mfma_f32_16x16x32_bf16 v[16:19], v[176:179], v[64:67], v[16:19]
    ds_read_b128 v[56:59], v14 offset:26624
    v_mfma_f32_16x16x32_bf16 v[20:23], v[180:183], v[64:67], v[20:23]
    ds_read_b128 v[60:63], v14 offset:26880
    v_mfma_f32_16x16x32_bf16 v[24:27], v[176:179], v[68:71], v[24:27]
    v_mfma_f32_16x16x32_bf16 v[28:31], v[180:183], v[68:71], v[28:31]
    s_waitcnt lgkmcnt(4)
    v_mfma_f32_16x16x32_bf16 v[16:19], v[184:187], v[72:75], v[16:19]
    ds_read_b128 v[64:67], v14 offset:28672
    v_mfma_f32_16x16x32_bf16 v[20:23], v[188:191], v[72:75], v[20:23]
    ds_read_b128 v[68:71], v14 offset:28928
    v_mfma_f32_16x16x32_bf16 v[24:27], v[184:187], v[76:79], v[24:27]
    v_mfma_f32_16x16x32_bf16 v[28:31], v[188:191], v[76:79], v[28:31]
    s_waitcnt lgkmcnt(4)
    v_mfma_f32_16x16x32_bf16 v[16:19], v[192:195], v[48:51], v[16:19]
    ds_read_b128 v[72:75], v14 offset:30720
    v_mfma_f32_16x16x32_bf16 v[20:23], v[196:199], v[48:51], v[20:23]
    ds_read_b128 v[76:79], v14 offset:30976
    v_mfma_f32_16x16x32_bf16 v[24:27], v[192:195], v[52:55], v[24:27]
    v_mfma_f32_16x16x32_bf16 v[28:31], v[196:199], v[52:55], v[28:31]
    s_waitcnt lgkmcnt(4)
    v_mfma_f32_16x16x32_bf16 v[16:19], v[200:203], v[56:59], v[16:19]
    ds_read_b128 v[48:51], v14 offset:32768
    v_mfma_f32_16x16x32_bf16 v[20:23], v[204:207], v[56:59], v[20:23]
    ds_read_b128 v[52:55], v14 offset:33024
    v_mfma_f32_16x16x32_bf16 v[24:27], v[200:203], v[60:63], v[24:27]
    v_mfma_f32_16x16x32_bf16 v[28:31], v[204:207], v[60:63], v[28:31]
    s_waitcnt lgkmcnt(4)
    v_mfma_f32_16x16x32_bf16 v[16:19], v[208:211], v[64:67], v[16:19]
    ds_read_b128 v[56:59], v14 offset:34816
    v_mfma_f32_16x16x32_bf16 v[20:23], v[212:215], v[64:67], v[20:23]
    ds_read_b128 v[60:63], v14 offset:35072
    v_mfma_f32_16x16x32_bf16 v[24:27], v[208:211], v[68:71], v[24:27]
    v_mfma_f32_16x16x32_bf16 v[28:31], v[212:215], v[68:71], v[28:31]
    s_waitcnt lgkmcnt(4)
    v_mfma_f32_16x16x32_bf16 v[16:19], v[216:219], v[72:75], v[16:19]
    ds_read_b128 v[64:67], v14 offset:36864
    v_mfma_f32_16x16x32_bf16 v[20:23], v[220:223], v[72:75], v[20:23]
    ds_read_b128 v[68:71], v14 offset:37120
    v_mfma_f32_16x16x32_bf16 v[24:27], v[216:219], v[76:79], v[24:27]
    v_mfma_f32_16x16x32_bf16 v[28:31], v[220:223], v[76:79], v[28:31]
    s_waitcnt lgkmcnt(4)
    v_mfma_f32_16x16x32_bf16 v[16:19], v[224:227], v[48:51], v[16:19]
    s_cbranch_scc1 L_qb_36
    s_setprio 3
    s_waitcnt vmcnt(0)
    s_barrier
L_qb_36:
    v_mfma_f32_16x16x32_bf16 v[20:23], v[228:231], v[48:51], v[20:23]
    ds_read_b128 v[72:75], v14 offset:38912
    v_mfma_f32_16x16x32_bf16 v[24:27], v[224:227], v[52:55], v[24:27]
    ds_read_b128 v[76:79], v14 offset:39168
    v_mfma_f32_16x16x32_bf16 v[28:31], v[228:231], v[52:55], v[28:31]
    s_waitcnt lgkmcnt(4)
    v_mfma_f32_16x16x32_bf16 v[16:19], v[232:235], v[56:59], v[16:19]
    ds_read_b128 v[48:51], v15 offset:0
    v_mfma_f32_16x16x32_bf16 v[20:23], v[236:239], v[56:59], v[20:23]
    ds_read_b128 v[52:55], v15 offset:256
    v_mfma_f32_16x16x32_bf16 v[24:27], v[232:235], v[60:63], v[24:27]
    v_mfma_f32_16x16x32_bf16 v[28:31], v[236:239], v[60:63], v[28:31]
    s_waitcnt lgkmcnt(4)
    v_mfma_f32_16x16x32_bf16 v[16:19], v[240:243], v[64:67], v[16:19]
    ds_read_b128 v[56:59], v15 offset:2048
    v_mfma_f32_16x16x32_bf16 v[20:23], v[244:247], v[64:67], v[20:23]
    ds_read_b128 v[60:63], v15 offset:2304
    v_mfma_f32_16x16x32_bf16 v[24:27], v[240:243], v[68:71], v[24:27]
    v_mfma_f32_16x16x32_bf16 v[28:31], v[244:247], v[68:71], v[28:31]
    s_waitcnt lgkmcnt(4)
    v_mfma_f32_16x16x32_bf16 v[16:19], v[248:251], v[72:75], v[16:19]
    s_cbranch_scc0 L_qb_37
    s_barrier
L_qb_37:
    v_mfma_f32_16x16x32_bf16 v[20:23], v[252:255], v[72:75], v[20:23]
    ds_read_b128 v[64:67], v15 offset:4096
    v_mfma_f32_16x16x32_bf16 v[24:27], v[248:251], v[76:79], v[24:27]
    ds_read_b128 v[68:71], v15 offset:4352
    v_mfma_f32_16x16x32_bf16 v[28:31], v[252:255], v[76:79], v[28:31]
    s_waitcnt lgkmcnt(4)
    v_mfma_f32_16x16x32_bf16 v[32:35], v[96:99], v[48:51], 0
    ds_read_b128 v[72:75], v15 offset:6144
    v_mfma_f32_16x16x32_bf16 v[36:39], v[100:103], v[48:51], 0
    ds_read_b128 v[76:79], v15 offset:6400
    v_mfma_f32_16x16x32_bf16 v[40:43], v[96:99], v[52:55], 0
    v_mfma_f32_16x16x32_bf16 v[44:47], v[100:103], v[52:55], 0
    s_waitcnt lgkmcnt(4)
    v_mfma_f32_16x16x32_bf16 v[32:35], v[104:107], v[56:59], v[32:35]
    ds_read_b128 v[48:51], v15 offset:8192
    v_mfma_f32_16x16x32_bf16 v[36:39], v[108:111], v[56:59], v[36:39]
    ds_read_b128 v[52:55], v15 offset:8448
    v_mfma_f32_16x16x32_bf16 v[40:43], v[104:107], v[60:63], v[40:43]
    v_mul_f32 v16, s64, v16
    v_mfma_f32_16x16x32_bf16 v[44:47], v[108:111], v[60:63], v[44:47]
    v_mul_f32 v17, s64, v17
    s_waitcnt lgkmcnt(4)
    v_mfma_f32_16x16x32_bf16 v[32:35], v[112:115], v[64:67], v[32:35]
    ds_read_b128 v[56:59], v15 offset:10240
    v_mfma_f32_16x16x32_bf16 v[36:39], v[116:119], v[64:67], v[36:39]
    ds_read_b128 v[60:63], v15 offset:10496
    v_mfma_f32_16x16x32_bf16 v[40:43], v[112:115], v[68:71], v[40:43]
    v_mul_f32 v18, s64, v18
    v_mfma_f32_16x16x32_bf16 v[44:47], v[116:119], v[68:71], v[44:47]
    v_mul_f32 v19, s64, v19
    s_waitcnt lgkmcnt(4)
    v_mfma_f32_16x16x32_bf16 v[32:35], v[120:123], v[72:75], v[32:35]
    ds_read_b128 v[64:67], v15 offset:12288
    v_mfma_f32_16x16x32_bf16 v[36:39], v[124:127], v[72:75], v[36:39]
    ds_read_b128 v[68:71], v15 offset:12544
    v_mfma_f32_16x16x32_bf16 v[40:43], v[120:123], v[76:79], v[40:43]
    v_mul_f32 v20, s64, v20
    v_mfma_f32_16x16x32_bf16 v[44:47], v[124:127], v[76:79], v[44:47]
    v_mul_f32 v21, s64, v21
    s_waitcnt lgkmcnt(4)
    v_mfma_f32_16x16x32_bf16 v[32:35], v[128:131], v[48:51], v[32:35]
    ds_read_b128 v[72:75], v15 offset:14336
    v_mfma_f32_16x16x32_bf16 v[36:39], v[132:135], v[48:51], v[36:39]
    ds_read_b128 v[76:79], v15 offset:14592
    v_mfma_f32_16x16x32_bf16 v[40:43], v[128:131], v[52:55], v[40:43]
    v_mul_f32 v22, s64, v22
    v_mfma_f32_16x16x32_bf16 v[44:47], v[132:135], v[52:55], v[44:47]
    v_mul_f32 v23, s64, v23
    s_waitcnt lgkmcnt(4)
    v_mfma_f32_16x16x32_bf16 v[32:35], v[136:139], v[56:59], v[32:35]
    ds_read_b128 v[48:51], v15 offset:16384
    v_mfma_f32_16x16x32_bf16 v[36:39], v[140:143], v[56:59], v[36:39]
    ds_read_b128 v[52:55], v15 offset:16640
    v_mfma_f32_16x16x32_bf16 v[40:43], v[136:139], v[60:63], v[40:43]
    v_mul_f32 v24, s64, v24
    v_mfma_f32_16x16x32_bf16 v[44:47], v[140:143], v[60:63], v[44:47]
    v_mul_f32 v25, s64, v25
    s_waitcnt lgkmcnt(4)
    v_mfma_f32_16x16x32_bf16 v[32:35], v[144:147], v[64:67], v[32:35]
    ds_read_b128 v[56:59], v15 offset:18432
    v_mfma_f32_16x16x32_bf16 v[36:39], v[148:151], v[64:67], v[36:39]
    ds_read_b128 v[60:63], v15 offset:18688
    v_mfma_f32_16x16x32_bf16 v[40:43], v[144:147], v[68:71], v[40:43]
    v_mul_f32 v26, s64, v26
    v_mfma_f32_16x16x32_bf16 v[44:47], v[148:151], v[68:71], v[44:47]
    v_mul_f32 v27, s64, v27
    s_waitcnt lgkmcnt(4)
    v_mfma_f32_16x16x32_bf16 v[32:35], v[152:155], v[72:75], v[32:35]
    ds_read_b128 v[64:67], v15 offset:20480
    v_mfma_f32_16x16x32_bf16 v[36:39], v[156:159], v[72:75], v[36:39]
    ds_read_b128 v[68:71], v15 offset:20736
    v_mfma_f32_16x16x32_bf16 v[40:43], v[152:155], v[76:79], v[40:43]
    v_mul_f32 v28, s64, v28
    v_mfma_f32_16x16x32_bf16 v[44:47], v[156:159], v[76:79], v[44:47]
    v_mul_f32 v29, s64, v29
    s_waitcnt lgkmcnt(4)
    v_mfma_f32_16x16x32_bf16 v[32:35], v[160:163], v[48:51], v[32:35]
    ds_read_b128 v[72:75], v15 offset:22528
    v_mfma_f32_16x16x32_bf16 v[36:39], v[164:167], v[48:51], v[36:39]
    ds_read_b128 v[76:79], v15 offset:22784
    v_mfma_f32_16x16x32_bf16 v[40:43], v[160:163], v[52:55], v[40:43]
    v_mul_f32 v30, s64, v30
    v_mfma_f32_16x16x32_bf16 v[44:47], v[164:167], v[52:55], v[44:47]
    v_mul_f32 v31, s64, v31
    s_waitcnt lgkmcnt(4)
    v_mfma_f32_16x16x32_bf16 v[32:35], v[168:171], v[56:59], v[32:35]
    ds_read_b128 v[48:51], v15 offset:24576
    v_mfma_f32_16x16x32_bf16 v[36:39], v[172:175], v[56:59], v[36:39]
    ds_read_b128 v[52:55], v15 offset:24832
    v_mfma_f32_16x16x32_bf16 v[40:43], v[168:171], v[60:63], v[40:43]
    v_cvt_pk_bf16_f32 v80, v16, v17
    v_mfma_f32_16x16x32_bf16 v[44:47], v[172:175], v[60:63], v[44:47]
    v_cvt_pk_bf16_f32 v81, v18, v19
    s_waitcnt lgkmcnt(4)
    v_mfma_f32_16x16x32_bf16 v[32:35], v[176:179], v[64:67], v[32:35]
    s_cbranch_scc1 L_qt_38
    ds_write_b32 v4, v3
L_qt_38:
    v_mfma_f32_16x16x32_bf16 v[36:39], v[180:183], v[64:67], v[36:39]
    ds_read_b128 v[56:59], v15 offset:26624
    v_mfma_f32_16x16x32_bf16 v[40:43], v[176:179], v[68:71], v[40:43]
    ds_read_b128 v[60:63], v15 offset:26880
    v_cvt_pk_bf16_f32 v82, v20, v21
    v_mfma_f32_16x16x32_bf16 v[44:47], v[180:183], v[68:71], v[44:47]
    v_cvt_pk_bf16_f32 v83, v22, v23
    s_waitcnt lgkmcnt(4)
    v_mfma_f32_16x16x32_bf16 v[32:35], v[184:187], v[72:75], v[32:35]
    ds_read_b128 v[64:67], v15 offset:28672
    v_mfma_f32_16x16x32_bf16 v[36:39], v[188:191], v[72:75], v[36:39]
    ds_read_b128 v[68:71], v15 offset:28928
    v_mfma_f32_16x16x32_bf16 v[40:43], v[184:187], v[76:79], v[40:43]
    v_cvt_pk_bf16_f32 v84, v24, v25
    v_mfma_f32_16x16x32_bf16 v[44:47], v[188:191], v[76:79], v[44:47]
    v_cvt_pk_bf16_f32 v85, v26, v27
    s_waitcnt lgkmcnt(4)
    v_mfma_f32_16x16x32_bf16 v[32:35], v[192:195], v[48:51], v[32:35]
    ds_read_b128 v[72:75], v15 offset:30720
    v_mfma_f32_16x16x32_bf16 v[36:39], v[196:199], v[48:51], v[36:39]
    ds_read_b128 v[76:79], v15 offset:30976
    v_mfma_f32_16x16x32_bf16 v[40:43], v[192:195], v[52:55], v[40:43]
    v_cvt_pk_bf16_f32 v86, v28, v29
    v_mfma_f32_16x16x32_bf16 v[44:47], v[196:199], v[52:55], v[44:47]
    v_cvt_pk_bf16_f32 v87, v30, v31
    s_waitcnt lgkmcnt(4)
    v_mfma_f32_16x16x32_bf16 v[32:35], v[200:203], v[56:59], v[32:35]
    ds_read_b128 v[48:51], v15 offset:32768
    v_mfma_f32_16x16x32_bf16 v[36:39], v[204:207], v[56:59], v[36:39]
    ds_read_b128 v[52:55], v15 offset:33024
    v_mfma_f32_16x16x32_bf16 v[40:43], v[200:203], v[60:63], v[40:43]
    v_permlane16_swap_b32 v80, v82
    v_mfma_f32_16x16x32_bf16 v[44:47], v[204:207], v[60:63], v[44:47]
    v_permlane16_swap_b32 v81, v83
    s_waitcnt lgkmcnt(4)
    v_mfma_f32_16x16x32_bf16 v[32:35], v[208:211], v[64:67], v[32:35]
    ds_read_b128 v[56:59], v15 offset:34816
    v_mfma_f32_16x16x32_bf16 v[36:39], v[212:215], v[64:67], v[36:39]
    ds_read_b128 v[60:63], v15 offset:35072
    v_mfma_f32_16x16x32_bf16 v[40:43], v[208:211], v[68:71], v[40:43]
    buffer_store_dwordx4 v[80:83], v8, s[4:7], s60 offen offset:0 sc1
    v_mfma_f32_16x16x32_bf16 v[44:47], v[212:215], v[68:71], v[44:47]
    v_permlane16_swap_b32 v84, v86
    s_waitcnt lgkmcnt(4)
    v_mfma_f32_16x16x32_bf16 v[32:35], v[216:219], v[72:75], v[32:35]
    ds_read_b128 v[64:67], v15 offset:36864
    v_mfma_f32_16x16x32_bf16 v[36:39], v[220:223], v[72:75], v[36:39]
    ds_read_b128 v[68:71], v15 offset:37120
    v_mfma_f32_16x16x32_bf16 v[40:43], v[216:219], v[76:79], v[40:43]
    v_permlane16_swap_b32 v85, v87
    v_mfma_f32_16x16x32_bf16 v[44:47], v[220:223], v[76:79], v[44:47]
    buffer_store_dwordx4 v[84:87], v8, s[4:7], s60 offen offset:256 sc1
    s_waitcnt lgkmcnt(4)
    v_mfma_f32_16x16x32_bf16 v[32:35], v[224:227], v[48:51], v[32:35]
    ds_read_b128 v[72:75], v15 offset:38912
    v_mfma_f32_16x16x32_bf16 v[36:39], v[228:231], v[48:51], v[36:39]
    ds_read_b128 v[76:79], v15 offset:39168
    v_mfma_f32_16x16x32_bf16 v[40:43], v[224:227], v[52:55], v[40:43]
    v_mfma_f32_16x16x32_bf16 v[44:47], v[228:231], v[52:55], v[44:47]
    s_waitcnt lgkmcnt(4)
    v_mfma_f32_16x16x32_bf16 v[32:35], v[232:235], v[56:59], v[32:35]
    v_mfma_f32_16x16x32_bf16 v[36:39], v[236:239], v[56:59], v[36:39]
    v_mfma_f32_16x16x32_bf16 v[40:43], v[232:235], v[60:63], v[40:43]
    v_mfma_f32_16x16x32_bf16 v[44:47], v[236:239], v[60:63], v[44:47]
    s_waitcnt lgkmcnt(2)
    v_mfma_f32_16x16x32_bf16 v[32:35], v[240:243], v[64:67], v[32:35]
    s_cbranch_scc0 L_qb_39
    s_barrier
L_qb_39:
    v_mfma_f32_16x16x32_bf16 v[36:39], v[244:247], v[64:67], v[36:39]
    v_mfma_f32_16x16x32_bf16 v[40:43], v[240:243], v[68:71], v[40:43]
    v_mfma_f32_16x16x32_bf16 v[44:47], v[244:247], v[68:71], v[44:47]
    s_waitcnt lgkmcnt(0)
    v_mfma_f32_16x16x32_bf16 v[32:35], v[248:251], v[72:75], v[32:35]
    v_mfma_f32_16x16x32_bf16 v[36:39], v[252:255], v[72:75], v[36:39]
    v_mfma_f32_16x16x32_bf16 v[40:43], v[248:251], v[76:79], v[40:43]
    v_mfma_f32_16x16x32_bf16 v[44:47], v[252:255], v[76:79], v[44:47]
    s_nop 4
    v_mul_f32 v32, s64, v32
    v_mul_f32 v33, s65, v33
    v_mul_f32 v34, s64, v34
    v_mul_f32 v35, s65, v35
    v_mul_f32 v36, s64, v36
    v_mul_f32 v37, s65, v37
    v_mul_f32 v38, s64, v38
    v_mul_f32 v39, s65, v39
    v_mul_f32 v40, s64, v40
    v_mul_f32 v41, s65, v41
    v_mul_f32 v42, s64, v42
    v_mul_f32 v43, s65, v43
    v_mul_f32 v44, s64, v44
    v_mul_f32 v45, s65, v45
    v_mul_f32 v46, s64, v46
    v_mul_f32 v47, s65, v47
    v_cvt_pk_bf16_f32 v88, v32, v33
    v_cvt_pk_bf16_f32 v89, v34, v35
    v_cvt_pk_bf16_f32 v90, v36, v37
    v_cvt_pk_bf16_f32 v91, v38, v39
    v_cvt_pk_bf16_f32 v92, v40, v41
    v_cvt_pk_bf16_f32 v93, v42, v43
    v_cvt_pk_bf16_f32 v94, v44, v45
    v_cvt_pk_bf16_f32 v95, v46, v47
    v_permlane16_swap_b32 v88, v90
    v_permlane16_swap_b32 v89, v91
    buffer_store_dwordx4 v[88:91], v8, s[4:7], s60 offen offset:512 sc1
    v_permlane16_swap_b32 v92, v94
    v_permlane16_swap_b32 v93, v95
    buffer_store_dwordx4 v[92:95], v8, s[4:7], s60 offen offset:768 sc1
    s_branch L_qkvpub_26
L_qkvv_25:
    s_sub_u32 s60, s53, 10
    s_lshl_b32 s60, s60, 2
    s_add_u32 s60, s60, s84
    s_lshl_b32 s60, s60, 5
    s_mov_b32 s61, 81600
    v_add_u32 v6, s60, v12
    v_mul_u32_u24 v7, 3277, v6
    v_lshrrev_b32 v7, 16, v7
    v_mul_u32_u24 v7, s61, v7
    v_lshl_add_u32 v8, v6, 4, v7
    v_mul_u32_u24 v7, 320, v13
    v_add_u32 v8, v8, v7
    s_add_u32 s60, s60, 16
    v_add_u32 v6, s60, v12
    v_mul_u32_u24 v7, 3277, v6
    v_lshrrev_b32 v7, 16, v7
    v_mul_u32_u24 v7, s61, v7
    v_lshl_add_u32 v9, v6, 4, v7
    v_mul_u32_u24 v7, 320, v13
    v_add_u32 v9, v9, v7
    s_add_u32 s60, s60, 16
    s_lshl_b32 s60, s85, 4
    s_add_u32 s60, s60, s52
    s_mul_i32 s60, s60, 2560
    s_add_u32 s60, s60, 11010048
    s_lshl_b32 s61, s31, 2
    s_add_u32 s61, s61, 158656
    v_mov_b32 v4, s61
    v_mov_b32 v3, 1
    s_barrier
    s_cmp_eq_u32 s85, 0
    s_cbranch_scc0 L_l19_40
    ds_read_b64_tr_b16 v[248:249], v10 offset:24576
    ds_read_b64_tr_b16 v[250:251], v10 offset:25600
    ds_read_b64_tr_b16 v[252:253], v11 offset:24576
    ds_read_b64_tr_b16 v[254:255], v11 offset:25600
L_l19_40:
    ds_read_b128 v[48:51], v14 offset:0
    ds_read_b128 v[52:55], v14 offset:256
    ds_read_b128 v[56:59], v14 offset:2048
    ds_read_b128 v[60:63], v14 offset:2304
    ds_read_b128 v[64:67], v14 offset:4096
    ds_read_b128 v[68:71], v14 offset:4352
    s_waitcnt lgkmcnt(4)
    v_mfma_f32_16x16x32_bf16 v[16:19], v[48:51], v[96:99], 0
    ds_read_b128 v[72:75], v14 offset:6144
    v_mfma_f32_16x16x32_bf16 v[20:23], v[48:51], v[100:103], 0
    ds_read_b128 v[76:79], v14 offset:6400
    v_mfma_f32_16x16x32_bf16 v[24:27], v[52:55], v[96:99], 0
    v_mfma_f32_16x16x32_bf16 v[28:31], v[52:55], v[100:103], 0
    s_waitcnt lgkmcnt(4)
    v_mfma_f32_16x16x32_bf16 v[16:19], v[56:59], v[104:107], v[16:19]
    ds_read_b128 v[48:51], v14 offset:8192
    v_mfma_f32_16x16x32_bf16 v[20:23], v[56:59], v[108:111], v[20:23]
    ds_read_b128 v[52:55], v14 offset:8448
    v_mfma_f32_16x16x32_bf16 v[24:27], v[60:63], v[104:107], v[24:27]
    v_mfma_f32_16x16x32_bf16 v[28:31], v[60:63], v[108:111], v[28:31]
    s_waitcnt lgkmcnt(4)
    v_mfma_f32_16x16x32_bf16 v[16:19], v[64:67], v[112:115], v[16:19]
    ds_read_b128 v[56:59], v14 offset:10240
    v_mfma_f32_16x16x32_bf16 v[20:23], v[64:67], v[116:119], v[20:23]
    ds_read_b128 v[60:63], v14 offset:10496
    v_mfma_f32_16x16x32_bf16 v[24:27], v[68:71], v[112:115], v[24:27]
    v_mfma_f32_16x16x32_bf16 v[28:31], v[68:71], v[116:119], v[28:31]
    s_waitcnt lgkmcnt(4)
    v_mfma_f32_16x16x32_bf16 v[16:19], v[72:75], v[120:123], v[16:19]
    s_cbranch_scc0 L_qb_41
    s_barrier
L_qb_41:
    v_mfma_f32_16x16x32_bf16 v[20:23], v[72:75], v[124:127], v[20:23]
    ds_read_b128 v[64:67], v14 offset:12288
    v_mfma_f32_16x16x32_bf16 v[24:27], v[76:79], v[120:123], v[24:27]
    ds_read_b128 v[68:71], v14 offset:12544
    v_mfma_f32_16x16x32_bf16 v[28:31], v[76:79], v[124:127], v[28:31]
    s_waitcnt lgkmcnt(4)
    v_mfma_f32_16x16x32_bf16 v[16:19], v[48:51], v[128:131], v[16:19]
    ds_read_b128 v[72:75], v14 offset:14336
    v_mfma_f32_16x16x32_bf16 v[20:23], v[48:51], v[132:135], v[20:23]
    ds_read_b128 v[76:79], v14 offset:14592
    v_mfma_f32_16x16x32_bf16 v[24:27], v[52:55], v[128:131], v[24:27]
    v_mfma_f32_16x16x32_bf16 v[28:31], v[52:55], v[132:135], v[28:31]
    s_waitcnt lgkmcnt(4)
    v_mfma_f32_16x16x32_bf16 v[16:19], v[56:59], v[136:139], v[16:19]
    ds_read_b128 v[48:51], v14 offset:16384
    v_mfma_f32_16x16x32_bf16 v[20:23], v[56:59], v[140:143], v[20:23]
    ds_read_b128 v[52:55], v14 offset:16640
    v_mfma_f32_16x16x32_bf16 v[24:27], v[60:63], v[136:139], v[24:27]
    v_mfma_f32_16x16x32_bf16 v[28:31], v[60:63], v[140:143], v[28:31]
    s_waitcnt lgkmcnt(4)
    v_mfma_f32_16x16x32_bf16 v[16:19], v[64:67], v[144:147], v[16:19]
    ds_read_b128 v[56:59], v14 offset:18432
    v_mfma_f32_16x16x32_bf16 v[20:23], v[64:67], v[148:151], v[20:23]
    ds_read_b128 v[60:63], v14 offset:18688
    v_mfma_f32_16x16x32_bf16 v[24:27], v[68:71], v[144:147], v[24:27]
    v_mfma_f32_16x16x32_bf16 v[28:31], v[68:71], v[148:151], v[28:31]
    s_waitcnt lgkmcnt(4)
    v_mfma_f32_16x16x32_bf16 v[16:19], v[72:75], v[152:155], v[16:19]
    ds_read_b128 v[64:67], v14 offset:20480
    v_mfma_f32_16x16x32_bf16 v[20:23], v[72:75], v[156:159], v[20:23]
    ds_read_b128 v[68:71], v14 offset:20736
    v_mfma_f32_16x16x32_bf16 v[24:27], v[76:79], v[152:155], v[24:27]
    v_mfma_f32_16x16x32_bf16 v[28:31], v[76:79], v[156:159], v[28:31]
    s_waitcnt lgkmcnt(4)
    v_mfma_f32_16x16x32_bf16 v[16:19], v[48:51], v[160:163], v[16:19]
    ds_read_b128 v[72:75], v14 offset:22528
    v_mfma_f32_16x16x32_bf16 v[20:23], v[48:51], v[164:167], v[20:23]
    ds_read_b128 v[76:79], v14 offset:22784
    v_mfma_f32_16x16x32_bf16 v[24:27], v[52:55], v[160:163], v[24:27]
    v_mfma_f32_16x16x32_bf16 v[28:31], v[52:55], v[164:167], v[28:31]
    s_waitcnt lgkmcnt(4)
    v_mfma_f32_16x16x32_bf16 v[16:19], v[56:59], v[168:171], v[16:19]
    s_cbranch_scc0 L_qb_42
    s_barrier
L_qb_42:
    v_mfma_f32_16x16x32_bf16 v[20:23], v[56:59], v[172:175], v[20:23]
    ds_read_b128 v[48:51], v14 offset:24576
    v_mfma_f32_16x16x32_bf16 v[24:27], v[60:63], v[168:171], v[24:27]
    ds_read_b128 v[52:55], v14 offset:24832
    v_mfma_f32_16x16x32_bf16 v[28:31], v[60:63], v[172:175], v[28:31]
    s_waitcnt lgkmcnt(4)
    v_mfma_f32_16x16x32_bf16 v[16:19], v[64:67], v[176:179], v[16:19]
    ds_read_b128 v[56:59], v14 offset:26624
    v_mfma_f32_16x16x32_bf16 v[20:23], v[64:67], v[180:183], v[20:23]
    ds_read_b128 v[60:63], v14 offset:26880
    v_mfma_f32_16x16x32_bf16 v[24:27], v[68:71], v[176:179], v[24:27]
    v_mfma_f32_16x16x32_bf16 v[28:31], v[68:71], v[180:183], v[28:31]
    s_waitcnt lgkmcnt(4)
    v_mfma_f32_16x16x32_bf16 v[16:19], v[72:75], v[184:187], v[16:19]
    ds_read_b128 v[64:67], v14 offset:28672
    v_mfma_f32_16x16x32_bf16 v[20:23], v[72:75], v[188:191], v[20:23]
    ds_read_b128 v[68:71], v14 offset:28928
    v_mfma_f32_16x16x32_bf16 v[24:27], v[76:79], v[184:187], v[24:27]
    v_mfma_f32_16x16x32_bf16 v[28:31], v[76:79], v[188:191], v[28:31]
    s_waitcnt lgkmcnt(4)
    v_mfma_f32_16x16x32_bf16 v[16:19], v[48:51], v[192:195], v[16:19]
    ds_read_b128 v[72:75], v14 offset:30720
    v_mfma_f32_16x16x32_bf16 v[20:23], v[48:51], v[196:199], v[20:23]
    ds_read_b128 v[76:79], v14 offset:30976
    v_mfma_f32_16x16x32_bf16 v[24:27], v[52:55], v[192:195], v[24:27]
    v_mfma_f32_16x16x32_bf16 v[28:31], v[52:55], v[196:199], v[28:31]
    s_waitcnt lgkmcnt(4)
    v_mfma_f32_16x16x32_bf16 v[16:19], v[56:59], v[200:203], v[16:19]
    ds_read_b128 v[48:51], v14 offset:32768
    v_mfma_f32_16x16x32_bf16 v[20:23], v[56:59], v[204:207], v[20:23]
    ds_read_b128 v[52:55], v14 offset:33024
    v_mfma_f32_16x16x32_bf16 v[24:27], v[60:63], v[200:203], v[24:27]
    v_mfma_f32_16x16x32_bf16 v[28:31], v[60:63], v[204:207], v[28:31]
    s_waitcnt lgkmcnt(4)
    v_mfma_f32_16x16x32_bf16 v[16:19], v[64:67], v[208:211], v[16:19]
    ds_read_b128 v[56:59], v14 offset:34816
    v_mfma_f32_16x16x32_bf16 v[20:23], v[64:67], v[212:215], v[20:23]
    ds_read_b128 v[60:63], v14 offset:35072
    v_mfma_f32_16x16x32_bf16 v[24:27], v[68:71], v[208:211], v[24:27]
    v_mfma_f32_16x16x32_bf16 v[28:31], v[68:71], v[212:215], v[28:31]
    s_waitcnt lgkmcnt(4)
    v_mfma_f32_16x16x32_bf16 v[16:19], v[72:75], v[216:219], v[16:19]
    ds_read_b128 v[64:67], v14 offset:36864
    v_mfma_f32_16x16x32_bf16 v[20:23], v[72:75], v[220:223], v[20:23]
    ds_read_b128 v[68:71], v14 offset:37120
    v_mfma_f32_16x16x32_bf16 v[24:27], v[76:79], v[216:219], v[24:27]
    v_mfma_f32_16x16x32_bf16 v[28:31], v[76:79], v[220:223], v[28:31]
    s_waitcnt lgkmcnt(4)
    v_mfma_f32_16x16x32_bf16 v[16:19], v[48:51], v[224:227], v[16:19]
    s_cbranch_scc1 L_qb_43
    s_setprio 3
    s_waitcnt vmcnt(0)
    s_barrier
L_qb_43:
    v_mfma_f32_16x16x32_bf16 v[20:23], v[48:51], v[228:231], v[20:23]
    ds_read_b128 v[72:75], v14 offset:38912
    v_mfma_f32_16x16x32_bf16 v[24:27], v[52:55], v[224:227], v[24:27]
    ds_read_b128 v[76:79], v14 offset:39168
    v_mfma_f32_16x16x32_bf16 v[28:31], v[52:55], v[228:231], v[28:31]
    s_waitcnt lgkmcnt(4)
    v_mfma_f32_16x16x32_bf16 v[16:19], v[56:59], v[232:235], v[16:19]
    ds_read_b128 v[48:51], v15 offset:0
    v_mfma_f32_16x16x32_bf16 v[20:23], v[56:59], v[236:239], v[20:23]
    ds_read_b128 v[52:55], v15 offset:256
    v_mfma_f32_16x16x32_bf16 v[24:27], v[60:63], v[232:235], v[24:27]
    v_mfma_f32_16x16x32_bf16 v[28:31], v[60:63], v[236:239], v[28:31]
    s_waitcnt lgkmcnt(4)
    v_mfma_f32_16x16x32_bf16 v[16:19], v[64:67], v[240:243], v[16:19]
    ds_read_b128 v[56:59], v15 offset:2048
    v_mfma_f32_16x16x32_bf16 v[20:23], v[64:67], v[244:247], v[20:23]
    ds_read_b128 v[60:63], v15 offset:2304
    v_mfma_f32_16x16x32_bf16 v[24:27], v[68:71], v[240:243], v[24:27]
    v_mfma_f32_16x16x32_bf16 v[28:31], v[68:71], v[244:247], v[28:31]
    s_waitcnt lgkmcnt(4)
    v_mfma_f32_16x16x32_bf16 v[16:19], v[72:75], v[248:251], v[16:19]
    s_cbranch_scc0 L_qb_44
    s_barrier
L_qb_44:
    v_mfma_f32_16x16x32_bf16 v[20:23], v[72:75], v[252:255], v[20:23]
    ds_read_b128 v[64:67], v15 offset:4096
    v_mfma_f32_16x16x32_bf16 v[24:27], v[76:79], v[248:251], v[24:27]
    ds_read_b128 v[68:71], v15 offset:4352
    v_mfma_f32_16x16x32_bf16 v[28:31], v[76:79], v[252:255], v[28:31]
    s_waitcnt lgkmcnt(4)
    v_mfma_f32_16x16x32_bf16 v[32:35], v[48:51], v[96:99], 0
    ds_read_b128 v[72:75], v15 offset:6144
    v_mfma_f32_16x16x32_bf16 v[36:39], v[48:51], v[100:103], 0
    ds_read_b128 v[76:79], v15 offset:6400
    v_mfma_f32_16x16x32_bf16 v[40:43], v[52:55], v[96:99], 0
    v_mfma_f32_16x16x32_bf16 v[44:47], v[52:55], v[100:103], 0
    s_waitcnt lgkmcnt(4)
    v_mfma_f32_16x16x32_bf16 v[32:35], v[56:59], v[104:107], v[32:35]
    ds_read_b128 v[48:51], v15 offset:8192
    v_mfma_f32_16x16x32_bf16 v[36:39], v[56:59], v[108:111], v[36:39]
    ds_read_b128 v[52:55], v15 offset:8448
    v_mfma_f32_16x16x32_bf16 v[40:43], v[60:63], v[104:107], v[40:43]
    v_cvt_pk_bf16_f32 v80, v16, v17
    v_mfma_f32_16x16x32_bf16 v[44:47], v[60:63], v[108:111], v[44:47]
    v_cvt_pk_bf16_f32 v81, v18, v19
    s_waitcnt lgkmcnt(4)
    v_mfma_f32_16x16x32_bf16 v[32:35], v[64:67], v[112:115], v[32:35]
    ds_read_b128 v[56:59], v15 offset:10240
    v_mfma_f32_16x16x32_bf16 v[36:39], v[64:67], v[116:119], v[36:39]
    ds_read_b128 v[60:63], v15 offset:10496
    v_mfma_f32_16x16x32_bf16 v[40:43], v[68:71], v[112:115], v[40:43]
    v_cvt_pk_bf16_f32 v82, v24, v25
    v_mfma_f32_16x16x32_bf16 v[44:47], v[68:71], v[116:119], v[44:47]
    v_cvt_pk_bf16_f32 v83, v26, v27
    s_waitcnt lgkmcnt(4)
    v_mfma_f32_16x16x32_bf16 v[32:35], v[72:75], v[120:123], v[32:35]
    ds_read_b128 v[64:67], v15 offset:12288
    v_mfma_f32_16x16x32_bf16 v[36:39], v[72:75], v[124:127], v[36:39]
    ds_read_b128 v[68:71], v15 offset:12544
    v_mfma_f32_16x16x32_bf16 v[40:43], v[76:79], v[120:123], v[40:43]
    buffer_store_dwordx4 v[80:83], v8, s[4:7], s60 offen offset:0 sc1
    v_mfma_f32_16x16x32_bf16 v[44:47], v[76:79], v[124:127], v[44:47]
    v_cvt_pk_bf16_f32 v84, v20, v21
    s_waitcnt lgkmcnt(4)
    v_mfma_f32_16x16x32_bf16 v[32:35], v[48:51], v[128:131], v[32:35]
    ds_read_b128 v[72:75], v15 offset:14336
    v_mfma_f32_16x16x32_bf16 v[36:39], v[48:51], v[132:135], v[36:39]
    ds_read_b128 v[76:79], v15 offset:14592
    v_mfma_f32_16x16x32_bf16 v[40:43], v[52:55], v[128:131], v[40:43]
    v_cvt_pk_bf16_f32 v85, v22, v23
    v_mfma_f32_16x16x32_bf16 v[44:47], v[52:55], v[132:135], v[44:47]
    v_cvt_pk_bf16_f32 v86, v28, v29
    s_waitcnt lgkmcnt(4)
    v_mfma_f32_16x16x32_bf16 v[32:35], v[56:59], v[136:139], v[32:35]
    ds_read_b128 v[48:51], v15 offset:16384
    v_mfma_f32_16x16x32_bf16 v[36:39], v[56:59], v[140:143], v[36:39]
    ds_read_b128 v[52:55], v15 offset:16640
    v_mfma_f32_16x16x32_bf16 v[40:43], v[60:63], v[136:139], v[40:43]
    v_cvt_pk_bf16_f32 v87, v30, v31
    v_mfma_f32_16x16x32_bf16 v[44:47], v[60:63], v[140:143], v[44:47]
    buffer_store_dwordx4 v[84:87], v9, s[4:7], s60 offen offset:0 sc1
    s_waitcnt lgkmcnt(4)
    v_mfma_f32_16x16x32_bf16 v[32:35], v[64:67], v[144:147], v[32:35]
    ds_read_b128 v[56:59], v15 offset:18432
    v_mfma_f32_16x16x32_bf16 v[36:39], v[64:67], v[148:151], v[36:39]
    ds_read_b128 v[60:63], v15 offset:18688
    v_mfma_f32_16x16x32_bf16 v[40:43], v[68:71], v[144:147], v[40:43]
    v_mfma_f32_16x16x32_bf16 v[44:47], v[68:71], v[148:151], v[44:47]
    s_waitcnt lgkmcnt(4)
    v_mfma_f32_16x16x32_bf16 v[32:35], v[72:75], v[152:155], v[32:35]
    ds_read_b128 v[64:67], v15 offset:20480
    v_mfma_f32_16x16x32_bf16 v[36:39], v[72:75], v[156:159], v[36:39]
    ds_read_b128 v[68:71], v15 offset:20736
    v_mfma_f32_16x16x32_bf16 v[40:43], v[76:79], v[152:155], v[40:43]
    v_mfma_f32_16x16x32_bf16 v[44:47], v[76:79], v[156:159], v[44:47]
    s_waitcnt lgkmcnt(4)
    v_mfma_f32_16x16x32_bf16 v[32:35], v[48:51], v[160:163], v[32:35]
    ds_read_b128 v[72:75], v15 offset:22528
    v_mfma_f32_16x16x32_bf16 v[36:39], v[48:51], v[164:167], v[36:39]
    ds_read_b128 v[76:79], v15 offset:22784
    v_mfma_f32_16x16x32_bf16 v[40:43], v[52:55], v[160:163], v[40:43]
    v_mfma_f32_16x16x32_bf16 v[44:47], v[52:55], v[164:167], v[44:47]
    s_waitcnt lgkmcnt(4)
    v_mfma_f32_16x16x32_bf16 v[32:35], v[56:59], v[168:171], v[32:35]
    ds_read_b128 v[48:51], v15 offset:24576
    v_mfma_f32_16x16x32_bf16 v[36:39], v[56:59], v[172:175], v[36:39]
    ds_read_b128 v[52:55], v15 offset:24832
    v_mfma_f32_16x16x32_bf16 v[40:43], v[60:63], v[168:171], v[40:43]
    v_mfma_f32_16x16x32_bf16 v[44:47], v[60:63], v[172:175], v[44:47]
    s_waitcnt lgkmcnt(4)
    v_mfma_f32_16x16x32_bf16 v[32:35], v[64:67], v[176:179], v[32:35]
    s_cbranch_scc1 L_qt_45
    ds_write_b32 v4, v3
L_qt_45:
    v_mfma_f32_16x16x32_bf16 v[36:39], v[64:67], v[180:183], v[36:39]
    ds_read_b128 v[56:59], v15 offset:26624
    v_mfma_f32_16x16x32_bf16 v[40:43], v[68:71], v[176:179], v[40:43]
    ds_read_b128 v[60:63], v15 offset:26880
    v_mfma_f32_16x16x32_bf16 v[44:47], v[68:71], v[180:183], v[44:47]
    s_waitcnt lgkmcnt(4)
    v_mfma_f32_16x16x32_bf16 v[32:35], v[72:75], v[184:187], v[32:35]
    ds_read_b128 v[64:67], v15 offset:28672
    v_mfma_f32_16x16x32_bf16 v[36:39], v[72:75], v[188:191], v[36:39]
    ds_read_b128 v[68:71], v15 offset:28928
    v_mfma_f32_16x16x32_bf16 v[40:43], v[76:79], v[184:187], v[40:43]
    v_mfma_f32_16x16x32_bf16 v[44:47], v[76:79], v[188:191], v[44:47]
    s_waitcnt lgkmcnt(4)
    v_mfma_f32_16x16x32_bf16 v[32:35], v[48:51], v[192:195], v[32:35]
    ds_read_b128 v[72:75], v15 offset:30720
    v_mfma_f32_16x16x32_bf16 v[36:39], v[48:51], v[196:199], v[36:39]
    ds_read_b128 v[76:79], v15 offset:30976
    v_mfma_f32_16x16x32_bf16 v[40:43], v[52:55], v[192:195], v[40:43]
    v_mfma_f32_16x16x32_bf16 v[44:47], v[52:55], v[196:199], v[44:47]
    s_waitcnt lgkmcnt(4)
    v_mfma_f32_16x16x32_bf16 v[32:35], v[56:59], v[200:203], v[32:35]
    ds_read_b128 v[48:51], v15 offset:32768
    v_mfma_f32_16x16x32_bf16 v[36:39], v[56:59], v[204:207], v[36:39]
    ds_read_b128 v[52:55], v15 offset:33024
    v_mfma_f32_16x16x32_bf16 v[40:43], v[60:63], v[200:203], v[40:43]
    v_mfma_f32_16x16x32_bf16 v[44:47], v[60:63], v[204:207], v[44:47]
    s_waitcnt lgkmcnt(4)
    v_mfma_f32_16x16x32_bf16 v[32:35], v[64:67], v[208:211], v[32:35]
    ds_read_b128 v[56:59], v15 offset:34816
    v_mfma_f32_16x16x32_bf16 v[36:39], v[64:67], v[212:215], v[36:39]
    ds_read_b128 v[60:63], v15 offset:35072
    v_mfma_f32_16x16x32_bf16 v[40:43], v[68:71], v[208:211], v[40:43]
    v_mfma_f32_16x16x32_bf16 v[44:47], v[68:71], v[212:215], v[44:47]
    s_waitcnt lgkmcnt(4)
    v_mfma_f32_16x16x32_bf16 v[32:35], v[72:75], v[216:219], v[32:35]
    ds_read_b128 v[64:67], v15 offset:36864
    v_mfma_f32_16x16x32_bf16 v[36:39], v[72:75], v[220:223], v[36:39]
    ds_read_b128 v[68:71], v15 offset:37120
    v_mfma_f32_16x16x32_bf16 v[40:43], v[76:79], v[216:219], v[40:43]
    v_mfma_f32_16x16x32_bf16 v[44:47], v[76:79], v[220:223], v[44:47]
    s_waitcnt lgkmcnt(4)
    v_mfma_f32_16x16x32_bf16 v[32:35], v[48:51], v[224:227], v[32:35]
    ds_read_b128 v[72:75], v15 offset:38912
    v_mfma_f32_16x16x32_bf16 v[36:39], v[48:51], v[228:231], v[36:39]
    ds_read_b128 v[76:79], v15 offset:39168
    v_mfma_f32_16x16x32_bf16 v[40:43], v[52:55], v[224:227], v[40:43]
    v_mfma_f32_16x16x32_bf16 v[44:47], v[52:55], v[228:231], v[44:47]
    s_waitcnt lgkmcnt(4)
    v_mfma_f32_16x16x32_bf16 v[32:35], v[56:59], v[232:235], v[32:35]
    v_mfma_f32_16x16x32_bf16 v[36:39], v[56:59], v[236:239], v[36:39]
    v_mfma_f32_16x16x32_bf16 v[40:43], v[60:63], v[232:235], v[40:43]
    v_mfma_f32_16x16x32_bf16 v[44:47], v[60:63], v[236:239], v[44:47]
    s_waitcnt lgkmcnt(2)
    v_mfma_f32_16x16x32_bf16 v[32:35], v[64:67], v[240:243], v[32:35]
    s_cbranch_scc0 L_qb_46
    s_barrier
L_qb_46:
    v_mfma_f32_16x16x32_bf16 v[36:39], v[64:67], v[244:247], v[36:39]
    v_mfma_f32_16x16x32_bf16 v[40:43], v[68:71], v[240:243], v[40:43]
    v_mfma_f32_16x16x32_bf16 v[44:47], v[68:71], v[244:247], v[44:47]
    s_waitcnt lgkmcnt(0)
    v_mfma_f32_16x16x32_bf16 v[32:35], v[72:75], v[248:251], v[32:35]
    v_mfma_f32_16x16x32_bf16 v[36:39], v[72:75], v[252:255], v[36:39]
    v_mfma_f32_16x16x32_bf16 v[40:43], v[76:79], v[248:251], v[40:43]
    v_mfma_f32_16x16x32_bf16 v[44:47], v[76:79], v[252:255], v[44:47]
    s_nop 4
    v_cvt_pk_bf16_f32 v88, v32, v33
    v_cvt_pk_bf16_f32 v89, v34, v35
    v_cvt_pk_bf16_f32 v90, v40, v41
    v_cvt_pk_bf16_f32 v91, v42, v43
    buffer_store_dwordx4 v[88:91], v8, s[4:7], s60 offen offset:1280 sc1
    v_cvt_pk_bf16_f32 v92, v36, v37
    v_cvt_pk_bf16_f32 v93, v38, v39
    v_cvt_pk_bf16_f32 v94, v44, v45
    v_cvt_pk_bf16_f32 v95, v46, v47
    buffer_store_dwordx4 v[92:95], v9, s[4:7], s60 offen offset:1280 sc1
    s_branch L_qkvpub_26
L_qkvdone_24:
    s_barrier
    s_call_b64 s[40:41], L_setup
    s_cmp_lt_u32 s31, 4
    s_cbranch_scc1 L_qkvpub_26
    s_barrier
L_qkvpub_26:
    s_lshl_b32 s60, s31, 2
    s_add_u32 s60, s60, 158656
    v_mov_b32 v10, s60
    v_and_b32 v11, 7, v0
    v_lshlrev_b32 v11, 2, v11
    v_add_u32 v11, 158656, v11
    s_mul_i32 s60, s53, 52
    s_lshr_b32 s60, s60, 8
    s_mul_i32 s61, s60, 5
    s_sub_u32 s61, s53, s61
    s_mul_i32 s62, s61, 1639
    s_add_u32 s63, s62, 1626
    s_lshr_b32 s62, s62, 8
    s_lshr_b32 s63, s63, 8
    v_add_u32 v60, s62, v0
    v_min_u32 v60, s63, v60
    v_mul_u32_u24 v61, 20, v60
    v_lshrrev_b32 v61, 7, v61
    v_sub_u32 v61, s61, v61
    v_mul_u32_u24 v60, 384, v60
    v_lshl_add_u32 v60, v61, 6, v60
    v_mov_b32 v61, s30
    s_lshl_b32 s65, s60, 7
    s_lshl_b32 s61, s52, 2
    s_add_u32 s65, s65, s61
    s_lshl_b32 s61, s85, 15
    s_add_u32 s65, s65, s61
    s_add_u32 s65, s65, 65536
    v_and_b32 v53, 31, v0
    v_lshrrev_b32 v55, 5, v0
    v_mul_u32_u24 v48, 32768, v55
    v_lshl_add_u32 v48, v53, 4, v48
    v_mul_u32_u24 v139, 320, v55
    v_lshl_add_u32 v139, v53, 4, v139
    s_cmp_eq_u32 s85, 1
    s_cbranch_scc1 L_attB_47
    v_mov_b32 v8, 0
    ds_write_b32 v11, v8
    s_waitcnt vmcnt(0) lgkmcnt(0)
    s_barrier
    s_cmp_lg_u32 s31, 0
    s_cbranch_scc1 L_pubd_49
    s_cmp_eq_u32 s53, 15
    s_cbranch_scc1 L_pubd_49
    s_mov_b64 exec, 0xff
    buffer_store_dword v61, v60, s[4:7], s65 offen sc1
    s_mov_b64 exec, -1
    s_cmp_lg_u32 s53, 14
    s_cbranch_scc1 L_pubd_49
    s_lshl_b32 s60, s52, 11
    s_add_u32 s60, s60, 34688
    s_mov_b64 exec, 1
    v_mov_b32 v8, s30
    buffer_store_dword v8, off, s[4:7], s60 sc1
    s_mov_b64 exec, -1
L_pubd_49:
    v_lshrrev_b32 v50, 4, v0
    v_bfe_u32 v51, v0, 2, 2
    v_and_b32 v52, 3, v0
    s_lshl_b32 s60, s31, 6
    s_add_u32 s60, s60, 57344
    v_and_b32 v53, 31, v0
    v_lshl_add_u32 v238, v53, 1, s60
    s_cmp_lg_u32 s51, 0
    s_cbranch_scc1 L_kn_51
    v_bfe_u32 v53, v0, 4, 1
    v_lshrrev_b32 v54, 5, v0
    v_lshl_add_u32 v240, v50, 3, v51
    v_lshl_add_u32 v53, v53, 3, v51
    v_mul_u32_u24 v54, 80, v54
    v_add3_u32 v241, v53, v54, 64
    v_lshl_add_u32 v52, v52, 3, s2
    v_mul_u32_u24 v240, 128, v240
    v_add_u32 v240, v240, v52
    v_mul_u32_u24 v241, 128, v241
    v_add_u32 v241, v241, v52
    s_branch L_ke_50
L_kn_51:
    s_cmp_lg_u32 s51, 1
    s_cbranch_scc1 L_kn_52
    v_bfe_u32 v53, v0, 4, 1
    v_lshrrev_b32 v54, 5, v0
    v_lshl_add_u32 v53, v53, 2, v51
    v_mad_u32_u24 v240, v54, 20, v53
    v_mad_u32_u24 v241, v50, 40, v51
    v_add_u32 v241, 16, v241
    v_lshl_add_u32 v52, v52, 4, s2
    v_mul_u32_u24 v240, 160, v240
    v_add_u32 v240, v240, v52
    v_mul_u32_u24 v241, 160, v241
    v_add_u32 v241, v241, v52
    s_branch L_ke_50
L_kn_52:
    v_lshl_add_u32 v240, v50, 2, v51
    v_lshl_add_u32 v52, v52, 4, s2
    v_mul_u32_u24 v240, 160, v240
    v_add_u32 v240, v240, v52
L_ke_50:
    v_and_b32 v12, 15, v0
    v_lshrrev_b32 v13, 4, v0
    v_lshlrev_b32 v143, 7, v0
    s_lshl_b32 s60, s31, 6
    s_add_u32 s60, s60, 160
    v_add_u32 v142, s60, v0
    s_lshl_b32 s64, s56, 1
    s_add_u32 s64, s64, 0
    s_lshl_b32 s64, s64, 1
    s_and_b32 s61, s84, 1
    s_add_u32 s64, s64, s61
    s_lshl_b32 s64, s64, 4
    s_lshr_b32 s61, s84, 1
    s_lshl_b32 s61, s61, 6
    v_mul_u32_u24 v15, 1280, v12
    v_lshl_add_u32 v14, v13, 4, v15
    v_lshl_add_u32 v15, v13, 3, v15
    v_add_u32 v14, s61, v14
    s_mul_i32 s64, s64, 1280
    s_mul_i32 s60, s57, 160
    s_add_u32 s64, s64, s60
    v_and_b32 v50, 3, v0
    v_lshrrev_b32 v51, 4, v142
    v_mad_u32_u24 v51, v50, 40, v51
    v_add_lshl_u32 v148, v51, 20, 7
    s_lshr_b32 s60, s86, 1
    v_mad_u32_u24 v50, v50, 27, s60
    s_add_u32 s60, s57, 108
    v_lshl_add_u32 v51, v0, 3, s60
    v_cmp_gt_u32 vcc, 18, v0
    v_lshlrev_b32 v50, 7, v50
    v_lshlrev_b32 v51, 7, v51
    v_cndmask_b32 v50, v50, v51, vcc
    v_add_u32 v149, 131072, v50
    v_and_b32 v54, 0x23, v0
    v_and_b32 v53, 4, v0
    v_lshl_or_b32 v54, v53, 2, v54
    v_bfe_u32 v53, v0, 3, 2
    v_lshl_or_b32 v54, v53, 2, v54
    s_and_b32 s61, s54, 1
    s_lshl_b32 s61, s61, 3
    s_add_u32 s60, s61, s80
    s_add_u32 s60, s60, 4096
    v_lshl_add_u32 v138, v54, 4, s60
    v_and_b32 v54, 31, v54
    v_lshl_add_u32 v137, v55, 11, s80
    v_lshl_add_u32 v137, v54, 4, v137
    s_add_u32 s60, s80, 6144
    v_add_u32 v139, s60, v139
    v_mov_b32 v136, 0xdddddddd
    v_mov_b32 v128, 0
    s_mov_b32 exec_lo, 285212672
    s_mov_b32 exec_hi, 285212672
    v_mov_b32 v128, 0x3f803f80
    s_mov_b64 exec, -1
    v_mov_b32 v129, v128
    v_mov_b32 v130, v128
    v_mov_b32 v131, v129
    v_mov_b32 v132, v128
    v_mov_b32 v133, v129
    v_mov_b32 v134, v128
    v_mov_b32 v135, v129
    v_mov_b32 v80, 0
    v_mov_b32 v81, 0
    v_mov_b32 v82, 0
    v_mov_b32 v83, 0
    v_mov_b32 v84, 0
    v_mov_b32 v85, 0
    v_mov_b32 v86, 0
    v_mov_b32 v87, 0
    v_mov_b32 v88, 0
    v_mov_b32 v89, 0
    v_mov_b32 v90, 0
    v_mov_b32 v91, 0
    v_mov_b32 v92, 0
    v_mov_b32 v93, 0
    v_mov_b32 v94, 0
    v_mov_b32 v95, 0
    v_mov_b32 v96, 0
    v_mov_b32 v97, 0
    v_mov_b32 v98, 0
    v_mov_b32 v99, 0
    v_mov_b32 v100, 0
    v_mov_b32 v101, 0
    v_mov_b32 v102, 0
    v_mov_b32 v103, 0
    v_mov_b32 v104, 0
    v_mov_b32 v105, 0
    v_mov_b32 v106, 0
    v_mov_b32 v107, 0
    v_mov_b32 v108, 0
    v_mov_b32 v109, 0
    v_mov_b32 v110, 0
    v_mov_b32 v111, 0
    s_cmp_lg_u32 s31, 3
    s_cbranch_scc1 L_fp_54
L_gs_55:
    ds_read_b32 v9, v11
    s_sub_i32 s66, s66, 1
    s_cmp_lt_i32 s66, 0
    s_waitcnt lgkmcnt(0)
    s_cbranch_scc1 L_gsd_56
    v_cmp_gt_u32 vcc, 1, v9
    s_nop 0
    s_and_b32 vcc_lo, vcc_lo, 0x80
    s_cbranch_scc1 L_gs_55
L_gsd_56:
    s_cmp_lg_u32 s53, 15
    s_cbranch_scc1 L_nwk_57
    s_lshl_b32 s60, s52, 11
    s_add_u32 s60, s60, 34688
    s_mov_b32 exec_lo, 1
    s_mov_b32 exec_hi, 0
L_poll_58:
    buffer_load_dword v58, v1, s[4:7], s60 offen sc1
    s_sub_i32 s66, s66, 4
    s_cmp_lt_i32 s66, 0
    s_cbranch_scc1 L_pdone_59
    s_waitcnt vmcnt(0)
    v_xor_b32 v58, s30, v58
    v_cmp_ne_u32 vcc, 0, v58
    s_cbranch_vccnz L_poll_58
L_pdone_59:
    s_waitcnt vmcnt(0)
    s_mov_b64 exec, -1
L_nwk_57:
    v_and_b32 v56, s81, v0
    v_and_b32 v57, 17, v56
    v_lshlrev_b32 v56, 2, v56
    v_lshlrev_b32 v57, 2, v57
    s_mov_b32 exec_lo, 4294967295
    s_mov_b32 exec_hi, 4294967295
L_poll_60:
    buffer_load_dword v58, v56, s[4:7], s82 offen sc1
    buffer_load_dword v59, v57, s[4:7], s83 offen sc1
    s_sub_i32 s66, s66, 4
    s_cmp_lt_i32 s66, 0
    s_cbranch_scc1 L_pdone_61
    s_waitcnt vmcnt(0)
    v_xor_b32 v58, s30, v58
    v_xor_b32 v59, s30, v59
    v_or_b32 v58, v58, v59
    v_cmp_ne_u32 vcc, 0, v58
    s_cbranch_vccnz L_poll_60
L_pdone_61:
    s_waitcnt vmcnt(0)
    s_mov_b64 exec, -1
    v_mov_b32 v8, 1
    ds_write_b32 v10, v8
L_fp_54:
L_gs_62:
    ds_read_b32 v9, v11
    s_sub_i32 s66, s66, 1
    s_cmp_lt_i32 s66, 0
    s_waitcnt lgkmcnt(0)
    s_cbranch_scc1 L_gsd_63
    v_cmp_gt_u32 vcc, 1, v9
    s_nop 0
    s_and_b32 vcc_lo, vcc_lo, 8
    s_cbranch_scc1 L_gs_62
L_gsd_63:
    s_setprio 3
    s_mul_i32 s62, s74, 0
    s_add_u32 m0, s71, 67584
    s_add_u32 s62, s62, s68
    buffer_load_dwordx4 v1, s[4:7], s62 offen offset:0 sc1 lds
    buffer_load_dwordx4 v1, s[4:7], s62 offen offset:1024 sc1 lds
    s_mul_i32 s62, s74, 0
    s_add_u32 m0, s72, 67584
    s_add_u32 s62, s62, s69
    buffer_load_dwordx4 v1, s[4:7], s62 offen offset:0 sc1 lds
    buffer_load_dwordx4 v1, s[4:7], s62 offen offset:1024 sc1 lds
    s_mul_i32 s62, s74, 0
    s_add_u32 m0, s73, 67584
    s_add_u32 s62, s62, s70
    buffer_load_dwordx4 v1, s[4:7], s62 offen offset:0 sc1 lds
    buffer_load_dwordx4 v1, s[4:7], s62 offen offset:1024 sc1 lds
    buffer_load_dwordx4 v[112:115], v48, s[4:7], s78 offen sc1
    buffer_load_dwordx4 v[116:119], v48, s[4:7], s78 offen offset:512 sc1
    buffer_load_dwordx2 v[120:121], v1, s[4:7], s79 offen sc1
    s_mul_i32 s62, s74, 1
    s_add_u32 m0, s71, 45056
    s_add_u32 s62, s62, s68
    buffer_load_dwordx4 v1, s[4:7], s62 offen offset:0 sc1 lds
    buffer_load_dwordx4 v1, s[4:7], s62 offen offset:1024 sc1 lds
    s_mul_i32 s62, s74, 1
    s_add_u32 m0, s72, 45056
    s_add_u32 s62, s62, s69
    buffer_load_dwordx4 v1, s[4:7], s62 offen offset:0 sc1 lds
    buffer_load_dwordx4 v1, s[4:7], s62 offen offset:1024 sc1 lds
    s_mul_i32 s62, s74, 1
    s_add_u32 m0, s73, 45056
    s_add_u32 s62, s62, s70
    buffer_load_dwordx4 v1, s[4:7], s62 offen offset:0 sc1 lds
    buffer_load_dwordx4 v1, s[4:7], s62 offen offset:1024 sc1 lds
    s_waitcnt vmcnt(9)
    v_mov_b32 v8, 2
    ds_write_b32 v10, v8
L_gs_64:
    ds_read_b32 v9, v11
    s_sub_i32 s66, s66, 1
    s_cmp_lt_i32 s66, 0
    s_waitcnt lgkmcnt(0)
    s_cbranch_scc1 L_gsd_65
    v_cmp_gt_u32 vcc, 2, v9
    s_nop 0
    s_and_b32 vcc_lo, vcc_lo, 0x0f
    s_cbranch_scc1 L_gs_64
L_gsd_65:
    s_waitcnt vmcnt(6)
    v_add_u32 v137, 45056, v137
    v_add_u32 v138, 45056, v138
    v_add_u32 v139, 45056, v139
    ds_read_b64 v[122:123], v138 offset:22528
    ds_read_b128 v[124:127], v137 offset:22528
    s_waitcnt lgkmcnt(1)
    v_mfma_f32_32x32x4_2b_bf16 v[16:47], v[122:123], v[120:121], 0 cbsz:1 abid:0
    s_waitcnt lgkmcnt(0)
    s_nop 15
    s_nop 0
    v_mfma_f32_32x32x16_bf16 v[16:31], v[124:127], v[112:115], v[16:31]
    v_mfma_f32_32x32x16_bf16 v[32:47], v[124:127], v[116:119], v[32:47]
    s_nop 10
    v_exp_f32 v16, v16
    v_exp_f32 v17, v17
    v_exp_f32 v18, v18
    s_mov_b64 exec, s[76:77]
    ds_read_b128 v[128:131], v139 offset:22528
    ds_read_b128 v[132:135], v139 offset:23168
    s_mov_b64 exec, -1
    v_exp_f32 v19, v19
    v_exp_f32 v20, v20
    v_exp_f32 v21, v21
    v_exp_f32 v22, v22
    v_mfma_f32_32x32x4_2b_bf16 v[48:79], v[122:123], v[120:121], 0 cbsz:1 abid:1
    ds_read_b128 v[124:127], v137 offset:23040
    ds_read_b64 v[122:123], v138 offset:23552
    v_exp_f32 v23, v23
    s_mul_i32 s62, s74, 2
    s_add_u32 m0, s71, 22528
    s_add_u32 s62, s62, s68
    buffer_load_dwordx4 v1, s[4:7], s62 offen offset:0 sc1 lds
    buffer_load_dwordx4 v1, s[4:7], s62 offen offset:1024 sc1 lds
    v_exp_f32 v24, v24
    v_exp_f32 v25, v25
    v_exp_f32 v26, v26
    s_mul_i32 s62, s74, 2
    s_add_u32 m0, s72, 22528
    s_add_u32 s62, s62, s69
    buffer_load_dwordx4 v1, s[4:7], s62 offen offset:0 sc1 lds
    buffer_load_dwordx4 v1, s[4:7], s62 offen offset:1024 sc1 lds
    v_exp_f32 v27, v27
    v_exp_f32 v28, v28
    v_exp_f32 v29, v29
    s_mul_i32 s62, s74, 2
    s_add_u32 m0, s73, 22528
    s_add_u32 s62, s62, s70
    buffer_load_dwordx4 v1, s[4:7], s62 offen offset:0 sc1 lds
    buffer_load_dwordx4 v1, s[4:7], s62 offen offset:1024 sc1 lds
    v_exp_f32 v30, v30
    v_exp_f32 v31, v31
    v_exp_f32 v32, v32
    s_waitcnt lgkmcnt(0)
    v_smfmac_f32_32x32x32_bf16 v[80:95], v[128:131], v[16:23], v136
    v_exp_f32 v33, v33
    v_exp_f32 v34, v34
    v_exp_f32 v35, v35
    v_smfmac_f32_32x32x32_bf16 v[80:95], v[132:135], v[24:31], v136
    v_exp_f32 v36, v36
    v_exp_f32 v37, v37
    v_exp_f32 v38, v38
    v_exp_f32 v39, v39
    v_mfma_f32_32x32x16_bf16 v[48:63], v[124:127], v[112:115], v[48:63]
    v_exp_f32 v40, v40
    v_exp_f32 v41, v41
    v_exp_f32 v42, v42
    v_exp_f32 v43, v43
    v_mfma_f32_32x32x16_bf16 v[64:79], v[124:127], v[116:119], v[64:79]
    v_exp_f32 v44, v44
    v_exp_f32 v45, v45
    v_exp_f32 v46, v46
    v_exp_f32 v47, v47
    s_setprio 0
    v_smfmac_f32_32x32x32_bf16 v[96:111], v[128:131], v[32:39], v136
    s_nop 0
    v_exp_f32 v48, v48
    v_exp_f32 v49, v49
    v_exp_f32 v50, v50
    v_smfmac_f32_32x32x32_bf16 v[96:111], v[132:135], v[40:47], v136
    s_mov_b64 exec, s[76:77]
    ds_read_b128 v[128:131], v139 offset:23808
    ds_read_b128 v[132:135], v139 offset:24448
    s_mov_b64 exec, -1
    v_exp_f32 v51, v51
    v_exp_f32 v52, v52
    v_exp_f32 v53, v53
    v_exp_f32 v54, v54
    v_mfma_f32_32x32x4_2b_bf16 v[16:47], v[122:123], v[120:121], 0 cbsz:1 abid:0
    ds_read_b128 v[124:127], v137 offset:23552
    v_exp_f32 v55, v55
    v_exp_f32 v56, v56
    v_exp_f32 v57, v57
    v_exp_f32 v58, v58
    v_exp_f32 v59, v59
    v_exp_f32 v60, v60
    v_exp_f32 v61, v61
    v_exp_f32 v62, v62
    v_exp_f32 v63, v63
    v_exp_f32 v64, v64
    s_waitcnt lgkmcnt(0)
    v_smfmac_f32_32x32x32_bf16 v[80:95], v[128:131], v[48:55], v136
    v_exp_f32 v65, v65
    s_waitcnt vmcnt(6)
    v_mov_b32 v8, 4
    ds_write_b32 v10, v8
    v_exp_f32 v66, v66
    v_exp_f32 v67, v67
    v_smfmac_f32_32x32x32_bf16 v[80:95], v[132:135], v[56:63], v136
    v_exp_f32 v68, v68
    v_exp_f32 v69, v69
    v_exp_f32 v70, v70
    v_exp_f32 v71, v71
    v_mfma_f32_32x32x16_bf16 v[16:31], v[124:127], v[112:115], v[16:31]
    v_exp_f32 v72, v72
    ds_read_b32 v9, v11
    v_exp_f32 v73, v73
    v_exp_f32 v74, v74
    v_exp_f32 v75, v75
    v_mfma_f32_32x32x16_bf16 v[32:47], v[124:127], v[116:119], v[32:47]
    v_exp_f32 v76, v76
    v_exp_f32 v77, v77
    v_exp_f32 v78, v78
    v_exp_f32 v79, v79
    s_waitcnt lgkmcnt(0)
    v_cmp_gt_u32 vcc, 4, v9
    s_nop 0
    s_and_b32 vcc_lo, vcc_lo, 0x0f
    s_cbranch_scc1 L_ck_66
L_cko_67:
    v_smfmac_f32_32x32x32_bf16 v[96:111], v[128:131], v[64:71], v136
    v_exp_f32 v16, v16
    v_exp_f32 v17, v17
    v_exp_f32 v18, v18
    v_smfmac_f32_32x32x32_bf16 v[96:111], v[132:135], v[72:79], v136
    s_mov_b64 exec, s[76:77]
    ds_read_b128 v[128:131], v139 offset:25088
    ds_read_b128 v[132:135], v139 offset:25728
    s_mov_b64 exec, -1
    v_exp_f32 v19, v19
    v_exp_f32 v20, v20
    v_exp_f32 v21, v21
    v_exp_f32 v22, v22
    v_mfma_f32_32x32x4_2b_bf16 v[48:79], v[122:123], v[120:121], 0 cbsz:1 abid:1
    ds_read_b128 v[124:127], v137 offset:24064
    ds_read_b64 v[122:123], v138 offset:0
    v_exp_f32 v23, v23
    v_exp_f32 v24, v24
    v_exp_f32 v25, v25
    v_exp_f32 v26, v26
    v_exp_f32 v27, v27
    v_exp_f32 v28, v28
    v_exp_f32 v29, v29
    v_exp_f32 v30, v30
    v_exp_f32 v31, v31
    v_exp_f32 v32, v32
    s_waitcnt lgkmcnt(0)
    v_smfmac_f32_32x32x32_bf16 v[80:95], v[128:131], v[16:23], v136
    v_exp_f32 v33, v33
    s_waitcnt vmcnt(0)
    v_mov_b32 v8, 5
    ds_write_b32 v10, v8
    v_exp_f32 v34, v34
    v_exp_f32 v35, v35
    v_smfmac_f32_32x32x32_bf16 v[80:95], v[132:135], v[24:31], v136
    v_exp_f32 v36, v36
    v_exp_f32 v37, v37
    v_exp_f32 v38, v38
    v_exp_f32 v39, v39
    v_mfma_f32_32x32x16_bf16 v[48:63], v[124:127], v[112:115], v[48:63]
    v_exp_f32 v40, v40
    v_exp_f32 v41, v41
    v_exp_f32 v42, v42
    v_exp_f32 v43, v43
    v_mfma_f32_32x32x16_bf16 v[64:79], v[124:127], v[116:119], v[64:79]
    v_exp_f32 v44, v44
    v_exp_f32 v45, v45
    v_exp_f32 v46, v46
    v_exp_f32 v47, v47
    v_smfmac_f32_32x32x32_bf16 v[96:111], v[128:131], v[32:39], v136
    s_nop 1
    v_exp_f32 v48, v48
    v_exp_f32 v49, v49
    v_exp_f32 v50, v50
    v_smfmac_f32_32x32x32_bf16 v[96:111], v[132:135], v[40:47], v136
    s_mov_b64 exec, s[76:77]
    ds_read_b128 v[128:131], v139 offset:26368
    ds_read_b128 v[132:135], v139 offset:27008
    s_mov_b64 exec, -1
    v_exp_f32 v51, v51
    v_exp_f32 v52, v52
    v_exp_f32 v53, v53
    v_exp_f32 v54, v54
    v_mfma_f32_32x32x4_2b_bf16 v[16:47], v[122:123], v[120:121], 0 cbsz:1 abid:0
    ds_read_b128 v[124:127], v137 offset:0
    v_exp_f32 v55, v55
    v_exp_f32 v56, v56
    v_exp_f32 v57, v57
    v_exp_f32 v58, v58
    v_exp_f32 v59, v59
    v_exp_f32 v60, v60
    v_exp_f32 v61, v61
    v_exp_f32 v62, v62
    v_exp_f32 v63, v63
    v_exp_f32 v64, v64
    s_waitcnt lgkmcnt(0)
    v_smfmac_f32_32x32x32_bf16 v[80:95], v[128:131], v[48:55], v136
    v_exp_f32 v65, v65
    v_exp_f32 v66, v66
    v_exp_f32 v67, v67
    v_smfmac_f32_32x32x32_bf16 v[80:95], v[132:135], v[56:63], v136
    v_exp_f32 v68, v68
    v_exp_f32 v69, v69
    v_exp_f32 v70, v70
    v_exp_f32 v71, v71
    v_mfma_f32_32x32x16_bf16 v[16:31], v[124:127], v[112:115], v[16:31]
    v_exp_f32 v72, v72
    v_exp_f32 v73, v73
    v_exp_f32 v74, v74
    v_exp_f32 v75, v75
    v_mfma_f32_32x32x16_bf16 v[32:47], v[124:127], v[116:119], v[32:47]
    v_exp_f32 v76, v76
    v_exp_f32 v77, v77
    v_exp_f32 v78, v78
    v_exp_f32 v79, v79
    v_smfmac_f32_32x32x32_bf16 v[96:111], v[128:131], v[64:71], v136
    s_nop 1
    v_exp_f32 v16, v16
    v_exp_f32 v17, v17
    v_exp_f32 v18, v18
    v_smfmac_f32_32x32x32_bf16 v[96:111], v[132:135], v[72:79], v136
    s_mov_b64 exec, s[76:77]
    ds_read_b128 v[128:131], v139 offset:0
    ds_read_b128 v[132:135], v139 offset:640
    s_mov_b64 exec, -1
    v_exp_f32 v19, v19
    v_exp_f32 v20, v20
    v_exp_f32 v21, v21
    v_exp_f32 v22, v22
    v_mfma_f32_32x32x4_2b_bf16 v[48:79], v[122:123], v[120:121], 0 cbsz:1 abid:1
    ds_read_b128 v[124:127], v137 offset:512
    ds_read_b64 v[122:123], v138 offset:1024
    v_exp_f32 v23, v23
    v_exp_f32 v24, v24
    v_exp_f32 v25, v25
    v_exp_f32 v26, v26
    v_exp_f32 v27, v27
    v_exp_f32 v28, v28
    v_exp_f32 v29, v29
    v_exp_f32 v30, v30
    v_exp_f32 v31, v31
    v_exp_f32 v32, v32
    s_waitcnt lgkmcnt(0)
    v_smfmac_f32_32x32x32_bf16 v[80:95], v[128:131], v[16:23], v136
    v_exp_f32 v33, v33
    v_exp_f32 v34, v34
    v_exp_f32 v35, v35
    v_smfmac_f32_32x32x32_bf16 v[80:95], v[132:135], v[24:31], v136
    v_exp_f32 v36, v36
    v_exp_f32 v37, v37
    v_exp_f32 v38, v38
    v_exp_f32 v39, v39
    v_mfma_f32_32x32x16_bf16 v[48:63], v[124:127], v[112:115], v[48:63]
    v_exp_f32 v40, v40
    v_mov_b32 v8, 6
    ds_write_b32 v10, v8
    v_exp_f32 v41, v41
    v_exp_f32 v42, v42
    v_exp_f32 v43, v43
    v_mfma_f32_32x32x16_bf16 v[64:79], v[124:127], v[116:119], v[64:79]
    v_exp_f32 v44, v44
    v_exp_f32 v45, v45
    v_exp_f32 v46, v46
    v_exp_f32 v47, v47
    v_smfmac_f32_32x32x32_bf16 v[96:111], v[128:131], v[32:39], v136
    v_exp_f32 v48, v48
    v_exp_f32 v49, v49
    v_exp_f32 v50, v50
    v_smfmac_f32_32x32x32_bf16 v[96:111], v[132:135], v[40:47], v136
    s_mov_b64 exec, s[76:77]
    ds_read_b128 v[128:131], v139 offset:1280
    ds_read_b128 v[132:135], v139 offset:1920
    s_mov_b64 exec, -1
    v_exp_f32 v51, v51
    v_exp_f32 v52, v52
    v_exp_f32 v53, v53
    v_exp_f32 v54, v54
    v_mfma_f32_32x32x4_2b_bf16 v[16:47], v[122:123], v[120:121], 0 cbsz:1 abid:0
    ds_read_b128 v[124:127], v137 offset:1024
    v_exp_f32 v55, v55
    v_exp_f32 v56, v56
    v_exp_f32 v57, v57
    v_exp_f32 v58, v58
    v_exp_f32 v59, v59
    v_exp_f32 v60, v60
    v_exp_f32 v61, v61
    v_exp_f32 v62, v62
    v_exp_f32 v63, v63
    v_exp_f32 v64, v64
    s_waitcnt lgkmcnt(0)
    v_smfmac_f32_32x32x32_bf16 v[80:95], v[128:131], v[48:55], v136
    v_exp_f32 v65, v65
    v_exp_f32 v66, v66
    v_exp_f32 v67, v67
    v_smfmac_f32_32x32x32_bf16 v[80:95], v[132:135], v[56:63], v136
    v_exp_f32 v68, v68
    v_exp_f32 v69, v69
    v_exp_f32 v70, v70
    v_exp_f32 v71, v71
    v_mfma_f32_32x32x16_bf16 v[16:31], v[124:127], v[112:115], v[16:31]
    v_exp_f32 v72, v72
    ds_read_b32 v9, v11
    v_exp_f32 v73, v73
    v_exp_f32 v74, v74
    v_exp_f32 v75, v75
    v_mfma_f32_32x32x16_bf16 v[32:47], v[124:127], v[116:119], v[32:47]
    v_exp_f32 v76, v76
    v_exp_f32 v77, v77
    v_exp_f32 v78, v78
    v_exp_f32 v79, v79
    s_waitcnt lgkmcnt(0)
    v_cmp_gt_u32 vcc, 6, v9
    s_nop 0
    s_and_b32 vcc_lo, vcc_lo, 0x0f
    s_cbranch_scc1 L_ck_68
L_cko_69:
    v_smfmac_f32_32x32x32_bf16 v[96:111], v[128:131], v[64:71], v136
    v_exp_f32 v16, v16
    v_exp_f32 v17, v17
    v_exp_f32 v18, v18
    v_smfmac_f32_32x32x32_bf16 v[96:111], v[132:135], v[72:79], v136
    s_mov_b64 exec, s[76:77]
    ds_read_b128 v[128:131], v139 offset:2560
    ds_read_b128 v[132:135], v139 offset:3200
    s_mov_b64 exec, -1
    v_exp_f32 v19, v19
    v_exp_f32 v20, v20
    v_exp_f32 v21, v21
    v_exp_f32 v22, v22
    v_mfma_f32_32x32x4_2b_bf16 v[48:79], v[122:123], v[120:121], 0 cbsz:1 abid:1
    ds_read_b128 v[124:127], v137 offset:1536
    v_add_u32 v138, 4294922240, v138
    ds_read_b64 v[122:123], v138 offset:22528
    v_exp_f32 v23, v23
    v_exp_f32 v24, v24
    v_exp_f32 v25, v25
    v_exp_f32 v26, v26
    v_exp_f32 v27, v27
    v_exp_f32 v28, v28
    v_exp_f32 v29, v29
    v_exp_f32 v30, v30
    v_exp_f32 v31, v31
    v_exp_f32 v32, v32
    s_waitcnt lgkmcnt(0)
    v_smfmac_f32_32x32x32_bf16 v[80:95], v[128:131], v[16:23], v136
    v_exp_f32 v33, v33
    v_exp_f32 v34, v34
    v_exp_f32 v35, v35
    v_smfmac_f32_32x32x32_bf16 v[80:95], v[132:135], v[24:31], v136
    v_exp_f32 v36, v36
    v_exp_f32 v37, v37
    v_exp_f32 v38, v38
    v_exp_f32 v39, v39
    v_mfma_f32_32x32x16_bf16 v[48:63], v[124:127], v[112:115], v[48:63]
    v_exp_f32 v40, v40
    v_exp_f32 v41, v41
    v_exp_f32 v42, v42
    v_exp_f32 v43, v43
    v_mfma_f32_32x32x16_bf16 v[64:79], v[124:127], v[116:119], v[64:79]
    v_exp_f32 v44, v44
    v_exp_f32 v45, v45
    v_exp_f32 v46, v46
    v_exp_f32 v47, v47
    v_smfmac_f32_32x32x32_bf16 v[96:111], v[128:131], v[32:39], v136
    s_nop 1
    v_exp_f32 v48, v48
    v_exp_f32 v49, v49
    v_exp_f32 v50, v50
    v_smfmac_f32_32x32x32_bf16 v[96:111], v[132:135], v[40:47], v136
    s_mov_b64 exec, s[76:77]
    ds_read_b128 v[128:131], v139 offset:3840
    ds_read_b128 v[132:135], v139 offset:4480
    s_mov_b64 exec, -1
    v_exp_f32 v51, v51
    v_exp_f32 v52, v52
    v_exp_f32 v53, v53
    v_exp_f32 v54, v54
    v_mfma_f32_32x32x4_2b_bf16 v[16:47], v[122:123], v[120:121], 0 cbsz:1 abid:0
    v_add_u32 v137, 4294922240, v137
    ds_read_b128 v[124:127], v137 offset:22528
    v_exp_f32 v55, v55
    v_exp_f32 v56, v56
    v_exp_f32 v57, v57
    v_exp_f32 v58, v58
    v_exp_f32 v59, v59
    v_exp_f32 v60, v60
    v_exp_f32 v61, v61
    v_exp_f32 v62, v62
    v_exp_f32 v63, v63
    v_exp_f32 v64, v64
    s_waitcnt lgkmcnt(0)
    v_smfmac_f32_32x32x32_bf16 v[80:95], v[128:131], v[48:55], v136
    v_exp_f32 v65, v65
    v_exp_f32 v66, v66
    v_exp_f32 v67, v67
    v_smfmac_f32_32x32x32_bf16 v[80:95], v[132:135], v[56:63], v136
    v_exp_f32 v68, v68
    v_exp_f32 v69, v69
    v_exp_f32 v70, v70
    v_exp_f32 v71, v71
    v_mfma_f32_32x32x16_bf16 v[16:31], v[124:127], v[112:115], v[16:31]
    v_exp_f32 v72, v72
    v_exp_f32 v73, v73
    v_exp_f32 v74, v74
    v_exp_f32 v75, v75
    v_mfma_f32_32x32x16_bf16 v[32:47], v[124:127], v[116:119], v[32:47]
    v_exp_f32 v76, v76
    v_exp_f32 v77, v77
    v_exp_f32 v78, v78
    v_exp_f32 v79, v79
    v_smfmac_f32_32x32x32_bf16 v[96:111], v[128:131], v[64:71], v136
    s_nop 1
    v_exp_f32 v16, v16
    v_exp_f32 v17, v17
    v_exp_f32 v18, v18
    s_setprio 3
    v_smfmac_f32_32x32x32_bf16 v[96:111], v[132:135], v[72:79], v136
    v_add_u32 v139, 4294922240, v139
    s_mov_b64 exec, s[76:77]
    ds_read_b128 v[128:131], v139 offset:22528
    ds_read_b128 v[132:135], v139 offset:23168
    s_mov_b64 exec, -1
    v_exp_f32 v19, v19
    v_exp_f32 v20, v20
    v_exp_f32 v21, v21
    v_exp_f32 v22, v22
    v_mfma_f32_32x32x4_2b_bf16 v[48:79], v[122:123], v[120:121], 0 cbsz:1 abid:1
    ds_read_b128 v[124:127], v137 offset:23040
    ds_read_b64 v[122:123], v138 offset:23552
    v_exp_f32 v23, v23
    v_exp_f32 v24, v24
    v_exp_f32 v25, v25
    v_exp_f32 v26, v26
    v_exp_f32 v27, v27
    v_exp_f32 v28, v28
    v_exp_f32 v29, v29
    v_exp_f32 v30, v30
    v_exp_f32 v31, v31
    v_exp_f32 v32, v32
    s_waitcnt lgkmcnt(0)
    v_smfmac_f32_32x32x32_bf16 v[80:95], v[128:131], v[16:23], v136
    v_exp_f32 v33, v33
    v_exp_f32 v34, v34
    v_exp_f32 v35, v35
    s_setprio 2
    v_smfmac_f32_32x32x32_bf16 v[80:95], v[132:135], v[24:31], v136
    v_exp_f32 v36, v36
    v_exp_f32 v37, v37
    v_exp_f32 v38, v38
    v_exp_f32 v39, v39
    v_mfma_f32_32x32x16_bf16 v[48:63], v[124:127], v[112:115], v[48:63]
    v_exp_f32 v40, v40
    v_mov_b32 v8, 8
    ds_write_b32 v10, v8
    v_exp_f32 v41, v41
    v_exp_f32 v42, v42
    v_exp_f32 v43, v43
    v_mfma_f32_32x32x16_bf16 v[64:79], v[124:127], v[116:119], v[64:79]
    v_exp_f32 v44, v44
    v_exp_f32 v45, v45
    v_exp_f32 v46, v46
    v_exp_f32 v47, v47
    v_smfmac_f32_32x32x32_bf16 v[96:111], v[128:131], v[32:39], v136
    v_exp_f32 v48, v48
    v_exp_f32 v49, v49
    v_exp_f32 v50, v50
    s_setprio 1
    v_smfmac_f32_32x32x32_bf16 v[96:111], v[132:135], v[40:47], v136
    s_mov_b64 exec, s[76:77]
    ds_read_b128 v[128:131], v139 offset:23808
    ds_read_b128 v[132:135], v139 offset:24448
    s_mov_b64 exec, -1
    v_exp_f32 v51, v51
    v_exp_f32 v52, v52
    v_exp_f32 v53, v53
    v_exp_f32 v54, v54
    v_mfma_f32_32x32x4_2b_bf16 v[16:47], v[122:123], v[120:121], 0 cbsz:1 abid:0
    ds_read_b128 v[124:127], v137 offset:23552
    v_exp_f32 v55, v55
    v_exp_f32 v56, v56
    v_exp_f32 v57, v57
    v_exp_f32 v58, v58
    v_exp_f32 v59, v59
    v_exp_f32 v60, v60
    v_exp_f32 v61, v61
    v_exp_f32 v62, v62
    v_exp_f32 v63, v63
    v_exp_f32 v64, v64
    s_waitcnt lgkmcnt(0)
    v_smfmac_f32_32x32x32_bf16 v[80:95], v[128:131], v[48:55], v136
    v_exp_f32 v65, v65
    v_exp_f32 v66, v66
    v_exp_f32 v67, v67
    s_setprio 0
    v_smfmac_f32_32x32x32_bf16 v[80:95], v[132:135], v[56:63], v136
    v_exp_f32 v68, v68
    v_exp_f32 v69, v69
    v_exp_f32 v70, v70
    v_exp_f32 v71, v71
    v_mfma_f32_32x32x16_bf16 v[16:31], v[124:127], v[112:115], v[16:31]
    v_exp_f32 v72, v72
    ds_read_b32 v9, v11
    v_exp_f32 v73, v73
    v_exp_f32 v74, v74
    v_exp_f32 v75, v75
    v_mfma_f32_32x32x16_bf16 v[32:47], v[124:127], v[116:119], v[32:47]
    v_exp_f32 v76, v76
    v_exp_f32 v77, v77
    v_exp_f32 v78, v78
    v_exp_f32 v79, v79
    s_waitcnt lgkmcnt(0)
    v_cmp_gt_u32 vcc, 8, v9
    s_nop 0
    s_and_b32 vcc_lo, vcc_lo, 0xff
    s_cbranch_scc1 L_ck_70
L_cko_71:
    v_smfmac_f32_32x32x32_bf16 v[96:111], v[128:131], v[64:71], v136
    v_exp_f32 v16, v16
    ds_write_b16 v238, v2
    v_exp_f32 v17, v17
    v_exp_f32 v18, v18
    s_setprio 3
    v_smfmac_f32_32x32x32_bf16 v[96:111], v[132:135], v[72:79], v136
    s_mov_b64 exec, s[76:77]
    ds_read_b128 v[128:131], v139 offset:25088
    ds_read_b128 v[132:135], v139 offset:25728
    s_mov_b64 exec, -1
    v_exp_f32 v19, v19
    v_exp_f32 v20, v20
    v_exp_f32 v21, v21
    v_exp_f32 v22, v22
    v_mfma_f32_32x32x4_2b_bf16 v[48:79], v[122:123], v[120:121], 0 cbsz:1 abid:1
    ds_read_b128 v[124:127], v137 offset:24064
    ds_read_b64 v[122:123], v138 offset:0
    v_exp_f32 v23, v23
    v_exp_f32 v24, v24
    v_exp_f32 v25, v25
    v_exp_f32 v26, v26
    v_exp_f32 v27, v27
    v_exp_f32 v28, v28
    v_exp_f32 v29, v29
    v_exp_f32 v30, v30
    v_exp_f32 v31, v31
    v_exp_f32 v32, v32
    s_waitcnt lgkmcnt(0)
    v_smfmac_f32_32x32x32_bf16 v[80:95], v[128:131], v[16:23], v136
    v_exp_f32 v33, v33
    v_exp_f32 v34, v34
    v_exp_f32 v35, v35
    s_setprio 2
    v_smfmac_f32_32x32x32_bf16 v[80:95], v[132:135], v[24:31], v136
    v_exp_f32 v36, v36
    v_exp_f32 v37, v37
    v_exp_f32 v38, v38
    v_exp_f32 v39, v39
    v_mfma_f32_32x32x16_bf16 v[48:63], v[124:127], v[112:115], v[48:63]
    v_exp_f32 v40, v40
    v_exp_f32 v41, v41
    v_exp_f32 v42, v42
    v_exp_f32 v43, v43
    v_mfma_f32_32x32x16_bf16 v[64:79], v[124:127], v[116:119], v[64:79]
    v_exp_f32 v44, v44
    v_exp_f32 v45, v45
    v_exp_f32 v46, v46
    v_exp_f32 v47, v47
    v_smfmac_f32_32x32x32_bf16 v[96:111], v[128:131], v[32:39], v136
    s_nop 1
    v_exp_f32 v48, v48
    v_exp_f32 v49, v49
    v_exp_f32 v50, v50
    s_setprio 1
    v_smfmac_f32_32x32x32_bf16 v[96:111], v[132:135], v[40:47], v136
    s_mov_b64 exec, s[76:77]
    ds_read_b128 v[128:131], v139 offset:26368
    ds_read_b128 v[132:135], v139 offset:27008
    s_mov_b64 exec, -1
    v_exp_f32 v51, v51
    v_exp_f32 v52, v52
    v_exp_f32 v53, v53
    v_exp_f32 v54, v54
    v_mfma_f32_32x32x4_2b_bf16 v[16:47], v[122:123], v[120:121], 0 cbsz:1 abid:0
    ds_read_b128 v[124:127], v137 offset:0
    v_exp_f32 v55, v55
    v_exp_f32 v56, v56
    v_exp_f32 v57, v57
    v_exp_f32 v58, v58
    v_exp_f32 v59, v59
    v_exp_f32 v60, v60
    v_exp_f32 v61, v61
    v_exp_f32 v62, v62
    v_exp_f32 v63, v63
    v_exp_f32 v64, v64
    s_waitcnt lgkmcnt(0)
    v_smfmac_f32_32x32x32_bf16 v[80:95], v[128:131], v[48:55], v136
    v_exp_f32 v65, v65
    v_exp_f32 v66, v66
    v_exp_f32 v67, v67
    s_setprio 0
    v_smfmac_f32_32x32x32_bf16 v[80:95], v[132:135], v[56:63], v136
    v_exp_f32 v68, v68
    v_exp_f32 v69, v69
    v_exp_f32 v70, v70
    v_exp_f32 v71, v71
    v_mfma_f32_32x32x16_bf16 v[16:31], v[124:127], v[112:115], v[16:31]
    v_exp_f32 v72, v72
    v_exp_f32 v73, v73
    v_exp_f32 v74, v74
    v_exp_f32 v75, v75
    v_mfma_f32_32x32x16_bf16 v[32:47], v[124:127], v[116:119], v[32:47]
    v_exp_f32 v76, v76
    v_exp_f32 v77, v77
    v_exp_f32 v78, v78
    v_exp_f32 v79, v79
    v_smfmac_f32_32x32x32_bf16 v[96:111], v[128:131], v[64:71], v136
    s_nop 1
    v_exp_f32 v16, v16
    v_exp_f32 v17, v17
    v_exp_f32 v18, v18
    s_setprio 3
    v_smfmac_f32_32x32x32_bf16 v[96:111], v[132:135], v[72:79], v136
    s_mov_b64 exec, s[76:77]
    ds_read_b128 v[128:131], v139 offset:0
    ds_read_b128 v[132:135], v139 offset:640
    s_mov_b64 exec, -1
    v_exp_f32 v19, v19
    v_exp_f32 v20, v20
    v_exp_f32 v21, v21
    v_exp_f32 v22, v22
    v_mfma_f32_32x32x4_2b_bf16 v[48:79], v[122:123], v[120:121], 0 cbsz:1 abid:1
    ds_read_b128 v[124:127], v137 offset:512
    ds_read_b64 v[122:123], v138 offset:1024
    v_exp_f32 v23, v23
    v_exp_f32 v24, v24
    v_exp_f32 v25, v25
    v_exp_f32 v26, v26
    v_exp_f32 v27, v27
    v_exp_f32 v28, v28
    v_exp_f32 v29, v29
    v_exp_f32 v30, v30
    v_exp_f32 v31, v31
    v_exp_f32 v32, v32
    s_waitcnt lgkmcnt(0)
    v_smfmac_f32_32x32x32_bf16 v[80:95], v[128:131], v[16:23], v136
    v_exp_f32 v33, v33
    v_exp_f32 v34, v34
    v_exp_f32 v35, v35
    s_setprio 2
    v_smfmac_f32_32x32x32_bf16 v[80:95], v[132:135], v[24:31], v136
    v_exp_f32 v36, v36
    v_exp_f32 v37, v37
    v_exp_f32 v38, v38
    v_exp_f32 v39, v39
    v_mfma_f32_32x32x16_bf16 v[48:63], v[124:127], v[112:115], v[48:63]
    v_exp_f32 v40, v40
    v_mov_b32 v8, 10
    ds_write_b32 v10, v8
    v_exp_f32 v41, v41
    v_exp_f32 v42, v42
    v_exp_f32 v43, v43
    v_mfma_f32_32x32x16_bf16 v[64:79], v[124:127], v[116:119], v[64:79]
    v_exp_f32 v44, v44
    v_exp_f32 v45, v45
    v_exp_f32 v46, v46
    v_exp_f32 v47, v47
    v_smfmac_f32_32x32x32_bf16 v[96:111], v[128:131], v[32:39], v136
    v_exp_f32 v48, v48
    v_exp_f32 v49, v49
    v_exp_f32 v50, v50
    s_setprio 1
    v_smfmac_f32_32x32x32_bf16 v[96:111], v[132:135], v[40:47], v136
    s_mov_b64 exec, s[76:77]
    ds_read_b128 v[128:131], v139 offset:1280
    ds_read_b128 v[132:135], v139 offset:1920
    s_mov_b64 exec, -1
    v_exp_f32 v51, v51
    v_exp_f32 v52, v52
    v_exp_f32 v53, v53
    v_exp_f32 v54, v54
    v_mfma_f32_32x32x4_2b_bf16 v[16:47], v[122:123], v[120:121], 0 cbsz:1 abid:0
    ds_read_b128 v[124:127], v137 offset:1024
    v_exp_f32 v55, v55
    v_exp_f32 v56, v56
    v_exp_f32 v57, v57
    v_exp_f32 v58, v58
    v_exp_f32 v59, v59
    v_exp_f32 v60, v60
    v_exp_f32 v61, v61
    v_exp_f32 v62, v62
    v_exp_f32 v63, v63
    v_exp_f32 v64, v64
    s_waitcnt lgkmcnt(0)
    v_smfmac_f32_32x32x32_bf16 v[80:95], v[128:131], v[48:55], v136
    v_exp_f32 v65, v65
    v_exp_f32 v66, v66
    v_exp_f32 v67, v67
    s_setprio 0
    v_smfmac_f32_32x32x32_bf16 v[80:95], v[132:135], v[56:63], v136
    v_exp_f32 v68, v68
    v_exp_f32 v69, v69
    v_exp_f32 v70, v70
    v_exp_f32 v71, v71
    v_mfma_f32_32x32x16_bf16 v[16:31], v[124:127], v[112:115], v[16:31]
    v_exp_f32 v72, v72
    ds_read_b32 v9, v11
    v_exp_f32 v73, v73
    v_exp_f32 v74, v74
    v_exp_f32 v75, v75
    v_mfma_f32_32x32x16_bf16 v[32:47], v[124:127], v[116:119], v[32:47]
    v_exp_f32 v76, v76
    v_exp_f32 v77, v77
    v_exp_f32 v78, v78
    v_exp_f32 v79, v79
    s_waitcnt lgkmcnt(0)
    v_cmp_gt_u32 vcc, 10, v9
    s_nop 0
    s_and_b32 vcc_lo, vcc_lo, 0xff
    s_cbranch_scc1 L_ck_72
L_cko_73:
    v_smfmac_f32_32x32x32_bf16 v[96:111], v[128:131], v[64:71], v136
    v_exp_f32 v16, v16
    s_cmp_ge_u32 s31, s50
    s_cbranch_scc1 L_aw_74
    s_cmp_lg_u32 s51, 0
    s_cbranch_scc1 L_kn_76
    ds_read_b64_tr_b16 v[168:169], v240 offset:0
    ds_read_b64_tr_b16 v[170:171], v240 offset:512
    ds_read_b64_tr_b16 v[172:173], v240 offset:4096
    ds_read_b64_tr_b16 v[174:175], v240 offset:4608
    ds_read_b64_tr_b16 v[176:177], v240 offset:10240
    ds_read_b64_tr_b16 v[178:179], v240 offset:10752
    ds_read_b64_tr_b16 v[180:181], v240 offset:14336
    ds_read_b64_tr_b16 v[182:183], v240 offset:14848
    ds_read_b64_tr_b16 v[184:185], v241 offset:0
    ds_read_b64_tr_b16 v[186:187], v241 offset:512
    s_branch L_ke_75
L_kn_76:
    s_cmp_lg_u32 s51, 1
    s_cbranch_scc1 L_kn_77
    ds_read_b64_tr_b16 v[168:169], v240 offset:0
    ds_read_b64_tr_b16 v[170:171], v240 offset:1280
    ds_read_b64_tr_b16 v[172:173], v240 offset:6400
    ds_read_b64_tr_b16 v[174:175], v240 offset:7680
    ds_read_b64_tr_b16 v[176:177], v240 offset:12800
    ds_read_b64_tr_b16 v[178:179], v240 offset:14080
    ds_read_b64_tr_b16 v[180:181], v240 offset:19200
    ds_read_b64_tr_b16 v[182:183], v240 offset:20480
    ds_read_b64_tr_b16 v[184:185], v241 offset:0
    ds_read_b64_tr_b16 v[186:187], v241 offset:3200
    s_branch L_ke_75
L_kn_77:
    ds_read_b64_tr_b16 v[168:169], v240 offset:0
    ds_read_b64_tr_b16 v[170:171], v240 offset:2560
    ds_read_b64_tr_b16 v[172:173], v240 offset:5120
    ds_read_b64_tr_b16 v[174:175], v240 offset:7680
    ds_read_b64_tr_b16 v[176:177], v240 offset:10240
    ds_read_b64_tr_b16 v[178:179], v240 offset:12800
    ds_read_b64_tr_b16 v[180:181], v240 offset:15360
    ds_read_b64_tr_b16 v[182:183], v240 offset:17920
L_ke_75:
L_aw_74:
    v_exp_f32 v17, v17
    v_exp_f32 v18, v18
    s_setprio 3
    v_smfmac_f32_32x32x32_bf16 v[96:111], v[132:135], v[72:79], v136
    s_mov_b64 exec, s[76:77]
    ds_read_b128 v[128:131], v139 offset:2560
    ds_read_b128 v[132:135], v139 offset:3200
    s_mov_b64 exec, -1
    v_exp_f32 v19, v19
    v_exp_f32 v20, v20
    v_exp_f32 v21, v21
    v_exp_f32 v22, v22
    v_mfma_f32_32x32x4_2b_bf16 v[48:79], v[122:123], v[120:121], 0 cbsz:1 abid:1
    ds_read_b128 v[124:127], v137 offset:1536
    v_add_u32 v138, 45056, v138
    ds_read_b64 v[122:123], v138 offset:22528
    v_exp_f32 v23, v23
    v_exp_f32 v24, v24
    v_exp_f32 v25, v25
    v_exp_f32 v26, v26
    s_mul_i32 s62, s74, 10
    s_add_u32 m0, s71, 22528
    s_add_u32 s62, s62, s68
    buffer_load_dwordx4 v1, s[4:7], s62 offen offset:0 sc1 lds
    buffer_load_dwordx4 v1, s[4:7], s62 offen offset:1024 sc1 lds
    v_exp_f32 v27, v27
    v_exp_f32 v28, v28
    v_exp_f32 v29, v29
    v_exp_f32 v30, v30
    v_exp_f32 v31, v31
    v_exp_f32 v32, v32
    s_waitcnt lgkmcnt(0)
    v_smfmac_f32_32x32x32_bf16 v[80:95], v[128:131], v[16:23], v136
    v_exp_f32 v33, v33
    s_cmp_ge_u32 s31, s50
    s_cbranch_scc1 L_as_79
    buffer_store_dwordx4 v[168:171], v1, s[4:7], s42 offen sc1
    buffer_store_dwordx4 v[172:175], v1, s[4:7], s43 offen sc1
L_as_79:
    v_exp_f32 v34, v34
    v_exp_f32 v35, v35
    s_setprio 2
    v_smfmac_f32_32x32x32_bf16 v[80:95], v[132:135], v[24:31], v136
    v_exp_f32 v36, v36
    s_cmp_ge_u32 s31, s50
    s_cbranch_scc1 L_as_80
    s_cmp_eq_u32 s44, 0
    s_cbranch_scc1 L_as_80
    buffer_store_dwordx4 v[176:179], v1, s[4:7], s44 offen sc1
    buffer_store_dwordx4 v[180:183], v1, s[4:7], s45 offen sc1
L_as_80:
    v_exp_f32 v37, v37
    v_exp_f32 v38, v38
    v_exp_f32 v39, v39
    v_mfma_f32_32x32x16_bf16 v[48:63], v[124:127], v[112:115], v[48:63]
    v_exp_f32 v40, v40
    v_exp_f32 v41, v41
    s_cmp_ge_u32 s31, s50
    s_cbranch_scc1 L_as_81
    s_cmp_eq_u32 s46, 0
    s_cbranch_scc1 L_as_81
    buffer_store_dwordx4 v[184:187], v1, s[4:7], s46 offen sc1
L_as_81:
    v_exp_f32 v42, v42
    v_exp_f32 v43, v43
    v_mfma_f32_32x32x16_bf16 v[64:79], v[124:127], v[116:119], v[64:79]
    v_exp_f32 v44, v44
    s_mul_i32 s62, s74, 10
    s_add_u32 m0, s72, 22528
    s_add_u32 s62, s62, s69
    buffer_load_dwordx4 v1, s[4:7], s62 offen offset:0 sc1 lds
    buffer_load_dwordx4 v1, s[4:7], s62 offen offset:1024 sc1 lds
    v_exp_f32 v45, v45
    v_exp_f32 v46, v46
    v_exp_f32 v47, v47
    v_smfmac_f32_32x32x32_bf16 v[96:111], v[128:131], v[32:39], v136
    v_exp_f32 v48, v48
    v_exp_f32 v49, v49
    v_exp_f32 v50, v50
    s_setprio 1
    v_smfmac_f32_32x32x32_bf16 v[96:111], v[132:135], v[40:47], v136
    s_mov_b64 exec, s[76:77]
    ds_read_b128 v[128:131], v139 offset:3840
    ds_read_b128 v[132:135], v139 offset:4480
    s_mov_b64 exec, -1
    v_exp_f32 v51, v51
    v_exp_f32 v52, v52
    v_exp_f32 v53, v53
    v_exp_f32 v54, v54
    v_mfma_f32_32x32x4_2b_bf16 v[16:47], v[122:123], v[120:121], 0 cbsz:1 abid:0
    v_add_u32 v137, 45056, v137
    ds_read_b128 v[124:127], v137 offset:22528
    v_exp_f32 v55, v55
    v_exp_f32 v56, v56
    v_exp_f32 v57, v57
    v_exp_f32 v58, v58
    s_mul_i32 s62, s74, 10
    s_add_u32 m0, s73, 22528
    s_add_u32 s62, s62, s70
    buffer_load_dwordx4 v1, s[4:7], s62 offen offset:0 sc1 lds
    buffer_load_dwordx4 v1, s[4:7], s62 offen offset:1024 sc1 lds
    v_exp_f32 v59, v59
    v_exp_f32 v60, v60
    v_exp_f32 v61, v61
    v_exp_f32 v62, v62
    v_exp_f32 v63, v63
    v_exp_f32 v64, v64
    s_waitcnt lgkmcnt(0)
    v_smfmac_f32_32x32x32_bf16 v[80:95], v[128:131], v[48:55], v136
    v_exp_f32 v65, v65
    v_exp_f32 v66, v66
    v_exp_f32 v67, v67
    s_setprio 0
    v_smfmac_f32_32x32x32_bf16 v[80:95], v[132:135], v[56:63], v136
    v_exp_f32 v68, v68
    v_exp_f32 v69, v69
    v_exp_f32 v70, v70
    v_exp_f32 v71, v71
    v_mfma_f32_32x32x16_bf16 v[16:31], v[124:127], v[112:115], v[16:31]
    v_exp_f32 v72, v72
    v_exp_f32 v73, v73
    v_exp_f32 v74, v74
    v_exp_f32 v75, v75
    v_mfma_f32_32x32x16_bf16 v[32:47], v[124:127], v[116:119], v[32:47]
    v_exp_f32 v76, v76
    v_exp_f32 v77, v77
    v_exp_f32 v78, v78
    v_exp_f32 v79, v79
    v_smfmac_f32_32x32x32_bf16 v[96:111], v[128:131], v[64:71], v136
    s_nop 1
    v_exp_f32 v16, v16
    v_exp_f32 v17, v17
    v_exp_f32 v18, v18
    s_setprio 3
    v_smfmac_f32_32x32x32_bf16 v[96:111], v[132:135], v[72:79], v136
    v_add_u32 v139, 45056, v139
    s_mov_b64 exec, s[76:77]
    ds_read_b128 v[128:131], v139 offset:22528
    ds_read_b128 v[132:135], v139 offset:23168
    s_mov_b64 exec, -1
    v_exp_f32 v19, v19
    v_exp_f32 v20, v20
    v_exp_f32 v21, v21
    v_exp_f32 v22, v22
    v_mfma_f32_32x32x4_2b_bf16 v[48:79], v[122:123], v[120:121], 0 cbsz:1 abid:1
    ds_read_b128 v[124:127], v137 offset:23040
    ds_read_b64 v[122:123], v138 offset:23552
    v_exp_f32 v23, v23
    v_exp_f32 v24, v24
    v_exp_f32 v25, v25
    v_exp_f32 v26, v26
    v_exp_f32 v27, v27
    v_exp_f32 v28, v28
    v_exp_f32 v29, v29
    v_exp_f32 v30, v30
    v_exp_f32 v31, v31
    v_exp_f32 v32, v32
    s_waitcnt lgkmcnt(0)
    v_smfmac_f32_32x32x32_bf16 v[80:95], v[128:131], v[16:23], v136
    v_exp_f32 v33, v33
    v_exp_f32 v34, v34
    v_exp_f32 v35, v35
    s_setprio 2
    v_smfmac_f32_32x32x32_bf16 v[80:95], v[132:135], v[24:31], v136
    v_exp_f32 v36, v36
    v_exp_f32 v37, v37
    v_exp_f32 v38, v38
    v_exp_f32 v39, v39
    v_mfma_f32_32x32x16_bf16 v[48:63], v[124:127], v[112:115], v[48:63]
    v_exp_f32 v40, v40
    s_waitcnt vmcnt(4)
    v_mov_b32 v8, 12
    ds_write_b32 v10, v8
    v_exp_f32 v41, v41
    v_exp_f32 v42, v42
    v_exp_f32 v43, v43
    v_mfma_f32_32x32x16_bf16 v[64:79], v[124:127], v[116:119], v[64:79]
    v_exp_f32 v44, v44
    v_exp_f32 v45, v45
    v_exp_f32 v46, v46
    v_exp_f32 v47, v47
    v_smfmac_f32_32x32x32_bf16 v[96:111], v[128:131], v[32:39], v136
    v_exp_f32 v48, v48
    v_exp_f32 v49, v49
    v_exp_f32 v50, v50
    s_setprio 1
    v_smfmac_f32_32x32x32_bf16 v[96:111], v[132:135], v[40:47], v136
    s_mov_b64 exec, s[76:77]
    ds_read_b128 v[128:131], v139 offset:23808
    ds_read_b128 v[132:135], v139 offset:24448
    s_mov_b64 exec, -1
    v_exp_f32 v51, v51
    v_exp_f32 v52, v52
    v_exp_f32 v53, v53
    v_exp_f32 v54, v54
    v_mfma_f32_32x32x4_2b_bf16 v[16:47], v[122:123], v[120:121], 0 cbsz:1 abid:0
    ds_read_b128 v[124:127], v137 offset:23552
    v_exp_f32 v55, v55
    v_exp_f32 v56, v56
    v_exp_f32 v57, v57
    v_exp_f32 v58, v58
    v_exp_f32 v59, v59
    v_exp_f32 v60, v60
    v_exp_f32 v61, v61
    v_exp_f32 v62, v62
    v_exp_f32 v63, v63
    v_exp_f32 v64, v64
    s_waitcnt lgkmcnt(0)
    v_smfmac_f32_32x32x32_bf16 v[80:95], v[128:131], v[48:55], v136
    v_exp_f32 v65, v65
    v_exp_f32 v66, v66
    v_exp_f32 v67, v67
    s_setprio 0
    v_smfmac_f32_32x32x32_bf16 v[80:95], v[132:135], v[56:63], v136
    v_exp_f32 v68, v68
    v_exp_f32 v69, v69
    v_exp_f32 v70, v70
    v_exp_f32 v71, v71
    v_mfma_f32_32x32x16_bf16 v[16:31], v[124:127], v[112:115], v[16:31]
    v_exp_f32 v72, v72
    ds_read_b32 v9, v11
    v_exp_f32 v73, v73
    v_exp_f32 v74, v74
    v_exp_f32 v75, v75
    v_mfma_f32_32x32x16_bf16 v[32:47], v[124:127], v[116:119], v[32:47]
    v_exp_f32 v76, v76
    v_exp_f32 v77, v77
    v_exp_f32 v78, v78
    v_exp_f32 v79, v79
    s_waitcnt lgkmcnt(0)
    v_cmp_gt_u32 vcc, 12, v9
    s_nop 0
    s_and_b32 vcc_lo, vcc_lo, 0xff
    s_cbranch_scc1 L_ck_82
L_cko_83:
    v_smfmac_f32_32x32x32_bf16 v[96:111], v[128:131], v[64:71], v136
    v_exp_f32 v16, v16
    v_exp_f32 v17, v17
    v_exp_f32 v18, v18
    s_setprio 3
    v_smfmac_f32_32x32x32_bf16 v[96:111], v[132:135], v[72:79], v136
    s_mov_b64 exec, s[76:77]
    ds_read_b128 v[128:131], v139 offset:25088
    ds_read_b128 v[132:135], v139 offset:25728
    s_mov_b64 exec, -1
    v_exp_f32 v19, v19
    v_exp_f32 v20, v20
    v_exp_f32 v21, v21
    v_exp_f32 v22, v22
    v_mfma_f32_32x32x4_2b_bf16 v[48:79], v[122:123], v[120:121], 0 cbsz:1 abid:1
    ds_read_b128 v[124:127], v137 offset:24064
    ds_read_b64 v[122:123], v138 offset:0
    v_exp_f32 v23, v23
    v_exp_f32 v24, v24
    v_exp_f32 v25, v25
    v_exp_f32 v26, v26
    s_mul_i32 s62, s74, 11
    s_add_u32 m0, s71, 0
    s_add_u32 s62, s62, s68
    buffer_load_dwordx4 v1, s[4:7], s62 offen offset:0 sc1 lds
    buffer_load_dwordx4 v1, s[4:7], s62 offen offset:1024 sc1 lds
    v_exp_f32 v27, v27
    v_exp_f32 v28, v28
    v_exp_f32 v29, v29
    v_exp_f32 v30, v30
    v_exp_f32 v31, v31
    v_exp_f32 v32, v32
    s_waitcnt lgkmcnt(0)
    v_smfmac_f32_32x32x32_bf16 v[80:95], v[128:131], v[16:23], v136
    v_exp_f32 v33, v33
    v_exp_f32 v34, v34
    v_exp_f32 v35, v35
    s_setprio 2
    v_smfmac_f32_32x32x32_bf16 v[80:95], v[132:135], v[24:31], v136
    v_exp_f32 v36, v36
    v_exp_f32 v37, v37
    v_exp_f32 v38, v38
    v_exp_f32 v39, v39
    v_mfma_f32_32x32x16_bf16 v[48:63], v[124:127], v[112:115], v[48:63]
    v_exp_f32 v40, v40
    v_exp_f32 v41, v41
    v_exp_f32 v42, v42
    v_exp_f32 v43, v43
    v_mfma_f32_32x32x16_bf16 v[64:79], v[124:127], v[116:119], v[64:79]
    v_exp_f32 v44, v44
    s_mul_i32 s62, s74, 11
    s_add_u32 m0, s72, 0
    s_add_u32 s62, s62, s69
    buffer_load_dwordx4 v1, s[4:7], s62 offen offset:0 sc1 lds
    buffer_load_dwordx4 v1, s[4:7], s62 offen offset:1024 sc1 lds
    v_exp_f32 v45, v45
    v_exp_f32 v46, v46
    v_exp_f32 v47, v47
    v_smfmac_f32_32x32x32_bf16 v[96:111], v[128:131], v[32:39], v136
    v_exp_f32 v48, v48
    v_exp_f32 v49, v49
    v_exp_f32 v50, v50
    s_setprio 1
    v_smfmac_f32_32x32x32_bf16 v[96:111], v[132:135], v[40:47], v136
    s_mov_b64 exec, s[76:77]
    ds_read_b128 v[128:131], v139 offset:26368
    ds_read_b128 v[132:135], v139 offset:27008
    s_mov_b64 exec, -1
    v_exp_f32 v51, v51
    v_exp_f32 v52, v52
    v_exp_f32 v53, v53
    v_exp_f32 v54, v54
    v_mfma_f32_32x32x4_2b_bf16 v[16:47], v[122:123], v[120:121], 0 cbsz:1 abid:0
    ds_read_b128 v[124:127], v137 offset:0
    v_exp_f32 v55, v55
    v_exp_f32 v56, v56
    v_exp_f32 v57, v57
    v_exp_f32 v58, v58
    s_mul_i32 s62, s74, 11
    s_add_u32 m0, s73, 0
    s_add_u32 s62, s62, s70
    buffer_load_dwordx4 v1, s[4:7], s62 offen offset:0 sc1 lds
    buffer_load_dwordx4 v1, s[4:7], s62 offen offset:1024 sc1 lds
    v_exp_f32 v59, v59
    v_exp_f32 v60, v60
    v_exp_f32 v61, v61
    v_exp_f32 v62, v62
    v_exp_f32 v63, v63
    v_exp_f32 v64, v64
    s_waitcnt lgkmcnt(0)
    v_smfmac_f32_32x32x32_bf16 v[80:95], v[128:131], v[48:55], v136
    v_exp_f32 v65, v65
    v_exp_f32 v66, v66
    v_exp_f32 v67, v67
    s_setprio 0
    v_smfmac_f32_32x32x32_bf16 v[80:95], v[132:135], v[56:63], v136
    v_exp_f32 v68, v68
    v_exp_f32 v69, v69
    v_exp_f32 v70, v70
    v_exp_f32 v71, v71
    v_mfma_f32_32x32x16_bf16 v[16:31], v[124:127], v[112:115], v[16:31]
    v_exp_f32 v72, v72
    v_exp_f32 v73, v73
    v_exp_f32 v74, v74
    v_exp_f32 v75, v75
    v_mfma_f32_32x32x16_bf16 v[32:47], v[124:127], v[116:119], v[32:47]
    v_exp_f32 v76, v76
    v_exp_f32 v77, v77
    v_exp_f32 v78, v78
    v_exp_f32 v79, v79
    v_smfmac_f32_32x32x32_bf16 v[96:111], v[128:131], v[64:71], v136
    s_nop 1
    v_exp_f32 v16, v16
    v_exp_f32 v17, v17
    v_exp_f32 v18, v18
    s_setprio 3
    v_smfmac_f32_32x32x32_bf16 v[96:111], v[132:135], v[72:79], v136
    s_mov_b64 exec, s[76:77]
    ds_read_b128 v[128:131], v139 offset:0
    ds_read_b128 v[132:135], v139 offset:640
    s_mov_b64 exec, -1
    v_exp_f32 v19, v19
    v_exp_f32 v20, v20
    v_exp_f32 v21, v21
    v_exp_f32 v22, v22
    v_mfma_f32_32x32x4_2b_bf16 v[48:79], v[122:123], v[120:121], 0 cbsz:1 abid:1
    ds_read_b128 v[124:127], v137 offset:512
    ds_read_b64 v[122:123], v138 offset:1024
    v_exp_f32 v23, v23
    v_exp_f32 v24, v24
    v_exp_f32 v25, v25
    v_exp_f32 v26, v26
    v_exp_f32 v27, v27
    v_exp_f32 v28, v28
    v_exp_f32 v29, v29
    v_exp_f32 v30, v30
    v_exp_f32 v31, v31
    v_exp_f32 v32, v32
    s_waitcnt lgkmcnt(0)
    v_smfmac_f32_32x32x32_bf16 v[80:95], v[128:131], v[16:23], v136
    v_exp_f32 v33, v33
    v_exp_f32 v34, v34
    v_exp_f32 v35, v35
    s_setprio 2
    v_smfmac_f32_32x32x32_bf16 v[80:95], v[132:135], v[24:31], v136
    v_exp_f32 v36, v36
    v_exp_f32 v37, v37
    v_exp_f32 v38, v38
    v_exp_f32 v39, v39
    v_mfma_f32_32x32x16_bf16 v[48:63], v[124:127], v[112:115], v[48:63]
    v_exp_f32 v40, v40
    s_waitcnt vmcnt(6)
    v_mov_b32 v8, 14
    ds_write_b32 v10, v8
    v_exp_f32 v41, v41
    v_exp_f32 v42, v42
    v_exp_f32 v43, v43
    v_mfma_f32_32x32x16_bf16 v[64:79], v[124:127], v[116:119], v[64:79]
    v_exp_f32 v44, v44
    v_exp_f32 v45, v45
    v_exp_f32 v46, v46
    v_exp_f32 v47, v47
    v_smfmac_f32_32x32x32_bf16 v[96:111], v[128:131], v[32:39], v136
    v_exp_f32 v48, v48
    v_exp_f32 v49, v49
    v_exp_f32 v50, v50
    s_setprio 1
    v_smfmac_f32_32x32x32_bf16 v[96:111], v[132:135], v[40:47], v136
    s_mov_b64 exec, s[76:77]
    ds_read_b128 v[128:131], v139 offset:1280
    ds_read_b128 v[132:135], v139 offset:1920
    s_mov_b64 exec, -1
    v_exp_f32 v51, v51
    v_exp_f32 v52, v52
    v_exp_f32 v53, v53
    v_exp_f32 v54, v54
    v_mfma_f32_32x32x4_2b_bf16 v[16:47], v[122:123], v[120:121], 0 cbsz:1 abid:0
    ds_read_b128 v[124:127], v137 offset:1024
    v_exp_f32 v55, v55
    v_exp_f32 v56, v56
    v_exp_f32 v57, v57
    v_exp_f32 v58, v58
    v_exp_f32 v59, v59
    v_exp_f32 v60, v60
    v_exp_f32 v61, v61
    v_exp_f32 v62, v62
    v_exp_f32 v63, v63
    v_exp_f32 v64, v64
    s_waitcnt lgkmcnt(0)
    v_smfmac_f32_32x32x32_bf16 v[80:95], v[128:131], v[48:55], v136
    v_exp_f32 v65, v65
    v_exp_f32 v66, v66
    v_exp_f32 v67, v67
    s_setprio 0
    v_smfmac_f32_32x32x32_bf16 v[80:95], v[132:135], v[56:63], v136
    v_exp_f32 v68, v68
    v_exp_f32 v69, v69
    v_exp_f32 v70, v70
    v_exp_f32 v71, v71
    v_mfma_f32_32x32x16_bf16 v[16:31], v[124:127], v[112:115], v[16:31]
    v_exp_f32 v72, v72
    ds_read_b32 v9, v11
    v_exp_f32 v73, v73
    v_exp_f32 v74, v74
    v_exp_f32 v75, v75
    v_mfma_f32_32x32x16_bf16 v[32:47], v[124:127], v[116:119], v[32:47]
    v_exp_f32 v76, v76
    v_exp_f32 v77, v77
    v_exp_f32 v78, v78
    v_exp_f32 v79, v79
    s_waitcnt lgkmcnt(0)
    v_cmp_gt_u32 vcc, 14, v9
    s_nop 0
    s_and_b32 vcc_lo, vcc_lo, 0xff
    s_cbranch_scc1 L_ck_84
L_cko_85:
    v_smfmac_f32_32x32x32_bf16 v[96:111], v[128:131], v[64:71], v136
    v_exp_f32 v16, v16
    v_exp_f32 v17, v17
    v_exp_f32 v18, v18
    s_setprio 3
    v_smfmac_f32_32x32x32_bf16 v[96:111], v[132:135], v[72:79], v136
    s_mov_b64 exec, s[76:77]
    ds_read_b128 v[128:131], v139 offset:2560
    ds_read_b128 v[132:135], v139 offset:3200
    s_mov_b64 exec, -1
    v_exp_f32 v19, v19
    v_exp_f32 v20, v20
    v_exp_f32 v21, v21
    v_exp_f32 v22, v22
    v_mfma_f32_32x32x4_2b_bf16 v[48:79], v[122:123], v[120:121], 0 cbsz:1 abid:1
    ds_read_b128 v[124:127], v137 offset:1536
    v_add_u32 v138, 4294922240, v138
    ds_read_b64 v[122:123], v138 offset:22528
    v_exp_f32 v23, v23
    v_exp_f32 v24, v24
    v_exp_f32 v25, v25
    v_exp_f32 v26, v26
    v_exp_f32 v27, v27
    v_exp_f32 v28, v28
    v_exp_f32 v29, v29
    v_exp_f32 v30, v30
    v_exp_f32 v31, v31
    v_exp_f32 v32, v32
    s_waitcnt lgkmcnt(0)
    v_smfmac_f32_32x32x32_bf16 v[80:95], v[128:131], v[16:23], v136
    v_exp_f32 v33, v33
    buffer_load_dword v146, v148, s[4:7], 0 offen sc1
    buffer_load_dword v147, v149, s[4:7], 0 offen sc1
    v_exp_f32 v34, v34
    v_exp_f32 v35, v35
    s_setprio 2
    v_smfmac_f32_32x32x32_bf16 v[80:95], v[132:135], v[24:31], v136
    v_exp_f32 v36, v36
    v_exp_f32 v37, v37
    v_exp_f32 v38, v38
    v_exp_f32 v39, v39
    v_mfma_f32_32x32x16_bf16 v[48:63], v[124:127], v[112:115], v[48:63]
    v_exp_f32 v40, v40
    v_exp_f32 v41, v41
    v_exp_f32 v42, v42
    v_exp_f32 v43, v43
    v_mfma_f32_32x32x16_bf16 v[64:79], v[124:127], v[116:119], v[64:79]
    v_exp_f32 v44, v44
    v_exp_f32 v45, v45
    v_exp_f32 v46, v46
    v_exp_f32 v47, v47
    v_smfmac_f32_32x32x32_bf16 v[96:111], v[128:131], v[32:39], v136
    s_nop 1
    v_exp_f32 v48, v48
    v_exp_f32 v49, v49
    v_exp_f32 v50, v50
    s_setprio 1
    v_smfmac_f32_32x32x32_bf16 v[96:111], v[132:135], v[40:47], v136
    s_mov_b64 exec, s[76:77]
    ds_read_b128 v[128:131], v139 offset:3840
    ds_read_b128 v[132:135], v139 offset:4480
    s_mov_b64 exec, -1
    v_exp_f32 v51, v51
    v_exp_f32 v52, v52
    v_exp_f32 v53, v53
    v_exp_f32 v54, v54
    v_mfma_f32_32x32x4_2b_bf16 v[16:47], v[122:123], v[120:121], 0 cbsz:1 abid:0
    v_add_u32 v137, 4294922240, v137
    ds_read_b128 v[124:127], v137 offset:22528
    v_exp_f32 v55, v55
    v_exp_f32 v56, v56
    v_exp_f32 v57, v57
    v_exp_f32 v58, v58
    v_exp_f32 v59, v59
    v_exp_f32 v60, v60
    v_exp_f32 v61, v61
    v_exp_f32 v62, v62
    v_exp_f32 v63, v63
    v_exp_f32 v64, v64
    s_waitcnt lgkmcnt(0)
    v_smfmac_f32_32x32x32_bf16 v[80:95], v[128:131], v[48:55], v136
    v_exp_f32 v65, v65
    v_exp_f32 v66, v66
    v_exp_f32 v67, v67
    s_setprio 0
    v_smfmac_f32_32x32x32_bf16 v[80:95], v[132:135], v[56:63], v136
    v_exp_f32 v68, v68
    v_exp_f32 v69, v69
    v_exp_f32 v70, v70
    v_exp_f32 v71, v71
    v_mfma_f32_32x32x16_bf16 v[16:31], v[124:127], v[112:115], v[16:31]
    v_exp_f32 v72, v72
    v_exp_f32 v73, v73
    v_exp_f32 v74, v74
    v_exp_f32 v75, v75
    v_mfma_f32_32x32x16_bf16 v[32:47], v[124:127], v[116:119], v[32:47]
    v_exp_f32 v76, v76
    v_exp_f32 v77, v77
    v_exp_f32 v78, v78
    v_exp_f32 v79, v79
    v_smfmac_f32_32x32x32_bf16 v[96:111], v[128:131], v[64:71], v136
    s_nop 1
    v_exp_f32 v16, v16
    s_waitcnt vmcnt(0)
    v_xor_b32 v146, s30, v146
    v_xor_b32 v147, s30, v147
    v_or_b32 v146, v146, v147
    v_cmp_ne_u32 vcc, 0, v146
    s_cbranch_vccnz L_auxs_86
L_auxok_87:
    v_exp_f32 v17, v17
    v_exp_f32 v18, v18
    s_setprio 3
    v_smfmac_f32_32x32x32_bf16 v[96:111], v[132:135], v[72:79], v136
    v_add_u32 v139, 4294922240, v139
    s_mov_b64 exec, s[76:77]
    ds_read_b128 v[128:131], v139 offset:22528
    ds_read_b128 v[132:135], v139 offset:23168
    s_mov_b64 exec, -1
    v_exp_f32 v19, v19
    v_exp_f32 v20, v20
    v_lshlrev_b32 v140, 4, v142
    s_mov_b32 s60, 1053696
    buffer_load_dwordx4 v[144:147], v140, s[4:7], s60 offen sc1
    v_exp_f32 v21, v21
    v_exp_f32 v22, v22
    v_mfma_f32_32x32x4_2b_bf16 v[48:79], v[122:123], v[120:121], 0 cbsz:1 abid:1
    ds_read_b128 v[124:127], v137 offset:23040
    ds_read_b64 v[122:123], v138 offset:23552
    v_exp_f32 v23, v23
    v_exp_f32 v24, v24
    v_exp_f32 v25, v25
    v_exp_f32 v26, v26
    v_exp_f32 v27, v27
    v_exp_f32 v28, v28
    s_mov_b32 s60, 1069056
    buffer_load_dwordx4 v[148:151], v140, s[4:7], s60 offen sc1
    v_exp_f32 v29, v29
    v_exp_f32 v30, v30
    v_exp_f32 v31, v31
    v_exp_f32 v32, v32
    s_waitcnt lgkmcnt(0)
    v_smfmac_f32_32x32x32_bf16 v[80:95], v[128:131], v[16:23], v136
    v_exp_f32 v33, v33
    v_exp_f32 v34, v34
    v_exp_f32 v35, v35
    s_setprio 2
    v_smfmac_f32_32x32x32_bf16 v[80:95], v[132:135], v[24:31], v136
    v_exp_f32 v36, v36
    v_exp_f32 v37, v37
    s_mov_b32 s60, 1084416
    buffer_load_dwordx4 v[152:155], v140, s[4:7], s60 offen sc1
    v_exp_f32 v38, v38
    v_exp_f32 v39, v39
    v_mfma_f32_32x32x16_bf16 v[48:63], v[124:127], v[112:115], v[48:63]
    v_exp_f32 v40, v40
    v_mov_b32 v8, 16
    ds_write_b32 v10, v8
    v_exp_f32 v41, v41
    v_exp_f32 v42, v42
    v_exp_f32 v43, v43
    v_mfma_f32_32x32x16_bf16 v[64:79], v[124:127], v[116:119], v[64:79]
    v_exp_f32 v44, v44
    v_exp_f32 v45, v45
    s_mov_b32 s60, 1099776
    buffer_load_dwordx4 v[156:159], v140, s[4:7], s60 offen sc1
    v_exp_f32 v46, v46
    v_exp_f32 v47, v47
    v_smfmac_f32_32x32x32_bf16 v[96:111], v[128:131], v[32:39], v136
    v_exp_f32 v48, v48
    v_exp_f32 v49, v49
    v_exp_f32 v50, v50
    s_setprio 1
    v_smfmac_f32_32x32x32_bf16 v[96:111], v[132:135], v[40:47], v136
    s_mov_b64 exec, s[76:77]
    ds_read_b128 v[128:131], v139 offset:23808
    ds_read_b128 v[132:135], v139 offset:24448
    s_mov_b64 exec, -1
    v_exp_f32 v51, v51
    v_exp_f32 v52, v52
    buffer_load_dwordx4 v[2:5], v14, s[8:11], s64 offen
    v_exp_f32 v53, v53
    v_exp_f32 v54, v54
    v_mfma_f32_32x32x4_2b_bf16 v[16:47], v[122:123], v[120:121], 0 cbsz:1 abid:0
    ds_read_b128 v[124:127], v137 offset:23552
    v_exp_f32 v55, v55
    v_exp_f32 v56, v56
    v_exp_f32 v57, v57
    v_exp_f32 v58, v58
    v_exp_f32 v59, v59
    v_exp_f32 v60, v60
    buffer_load_dwordx2 v[6:7], v15, s[8:11], s64 offen offset:128
    v_exp_f32 v61, v61
    v_exp_f32 v62, v62
    v_exp_f32 v63, v63
    v_exp_f32 v64, v64
    s_waitcnt lgkmcnt(0)
    v_smfmac_f32_32x32x32_bf16 v[80:95], v[128:131], v[48:55], v136
    v_exp_f32 v65, v65
    v_exp_f32 v66, v66
    v_exp_f32 v67, v67
    s_setprio 0
    v_smfmac_f32_32x32x32_bf16 v[80:95], v[132:135], v[56:63], v136
    v_exp_f32 v68, v68
    v_exp_f32 v69, v69
    s_mul_i32 s78, s57, 102400
    s_add_u32 s78, s78, 26034176
    s_lshl_b32 s79, s84, 10
    s_add_u32 s79, s79, s78
    s_add_u32 s79, s79, 16384
    s_lshl_b32 s61, s84, 12
    s_add_u32 s78, s78, s61
    buffer_load_dwordx4 v[236:239], v1, s[4:7], s78 offen offset:0 sc1
    v_exp_f32 v70, v70
    v_exp_f32 v71, v71
    v_mfma_f32_32x32x16_bf16 v[16:31], v[124:127], v[112:115], v[16:31]
    v_exp_f32 v72, v72
    ds_read_b32 v9, v11
    v_exp_f32 v73, v73
    v_exp_f32 v74, v74
    v_exp_f32 v75, v75
    v_mfma_f32_32x32x16_bf16 v[32:47], v[124:127], v[116:119], v[32:47]
    v_exp_f32 v76, v76
    v_exp_f32 v77, v77
    buffer_load_dwordx4 v[240:243], v1, s[4:7], s78 offen offset:1024 sc1
    v_exp_f32 v78, v78
    v_exp_f32 v79, v79
    s_waitcnt lgkmcnt(0)
    v_cmp_gt_u32 vcc, 16, v9
    s_nop 0
    s_and_b32 vcc_lo, vcc_lo, 0xff
    s_cbranch_scc1 L_ck_88
L_cko_89:
    v_smfmac_f32_32x32x32_bf16 v[96:111], v[128:131], v[64:71], v136
    v_exp_f32 v16, v16
    v_exp_f32 v17, v17
    v_exp_f32 v18, v18
    s_setprio 3
    v_smfmac_f32_32x32x32_bf16 v[96:111], v[132:135], v[72:79], v136
    s_mov_b64 exec, s[76:77]
    ds_read_b128 v[128:131], v139 offset:25088
    ds_read_b128 v[132:135], v139 offset:25728
    s_mov_b64 exec, -1
    v_exp_f32 v19, v19
    v_exp_f32 v20, v20
    buffer_load_dwordx4 v[244:247], v1, s[4:7], s78 offen offset:2048 sc1
    v_exp_f32 v21, v21
    v_exp_f32 v22, v22
    v_mfma_f32_32x32x4_2b_bf16 v[48:79], v[122:123], v[120:121], 0 cbsz:1 abid:1
    ds_read_b128 v[124:127], v137 offset:24064
    ds_read_b64 v[122:123], v138 offset:0
    v_exp_f32 v23, v23
    v_exp_f32 v24, v24
    v_exp_f32 v25, v25
    v_exp_f32 v26, v26
    v_exp_f32 v27, v27
    v_exp_f32 v28, v28
    buffer_load_dwordx4 v[248:251], v1, s[4:7], s78 offen offset:3072 sc1
    v_exp_f32 v29, v29
    v_exp_f32 v30, v30
    v_exp_f32 v31, v31
    v_exp_f32 v32, v32
    s_waitcnt lgkmcnt(0)
    v_smfmac_f32_32x32x32_bf16 v[80:95], v[128:131], v[16:23], v136
    v_exp_f32 v33, v33
    v_exp_f32 v34, v34
    v_exp_f32 v35, v35
    s_setprio 2
    v_smfmac_f32_32x32x32_bf16 v[80:95], v[132:135], v[24:31], v136
    v_exp_f32 v36, v36
    v_exp_f32 v37, v37
    buffer_load_dwordx4 v[252:255], v1, s[4:7], s79 offen offset:0 sc1
    v_exp_f32 v38, v38
    v_exp_f32 v39, v39
    v_mfma_f32_32x32x16_bf16 v[48:63], v[124:127], v[112:115], v[48:63]
    v_exp_f32 v40, v40
    v_exp_f32 v41, v41
    v_exp_f32 v42, v42
    v_exp_f32 v43, v43
    v_mfma_f32_32x32x16_bf16 v[64:79], v[124:127], v[116:119], v[64:79]
    v_exp_f32 v44, v44
    v_exp_f32 v45, v45
    s_sub_u32 s78, s78, 20480
    s_sub_u32 s79, s79, 20480
    buffer_load_dwordx4 v[216:219], v1, s[4:7], s78 offen offset:0 sc1
    v_exp_f32 v46, v46
    v_exp_f32 v47, v47
    v_smfmac_f32_32x32x32_bf16 v[96:111], v[128:131], v[32:39], v136
    v_exp_f32 v48, v48
    v_exp_f32 v49, v49
    v_exp_f32 v50, v50
    s_setprio 1
    v_smfmac_f32_32x32x32_bf16 v[96:111], v[132:135], v[40:47], v136
    s_mov_b64 exec, s[76:77]
    ds_read_b128 v[128:131], v139 offset:26368
    ds_read_b128 v[132:135], v139 offset:27008
    s_mov_b64 exec, -1
    v_exp_f32 v51, v51
    s_waitcnt vmcnt(8)
    v_subrev_u32 v140, 320, v142
    v_cmp_gt_u32 vcc, 160, v140
    v_lshlrev_b32 v141, 3, v142
    v_add_u32 v141, 158720, v141
    v_cndmask_b32 v140, 0, 1.0, vcc
    v_add_f32 v144, v144, v148
    v_add_f32 v152, v152, v156
    v_add_f32 v145, v145, v149
    v_add_f32 v153, v153, v157
    v_add_f32 v146, v146, v150
    v_add_f32 v154, v154, v158
    v_add_f32 v147, v147, v151
    v_add_f32 v155, v155, v159
    v_add_f32 v144, v144, v152
    v_add_f32 v145, v145, v153
    v_add_f32 v146, v146, v154
    v_add_f32 v147, v147, v155
    v_cvt_pk_bf16_f32 v148, v144, v145
    v_cvt_pk_bf16_f32 v149, v146, v147
    v_lshlrev_b32 v144, 16, v148
    v_and_b32 v145, 0xffff0000, v148
    v_lshlrev_b32 v146, 16, v149
    v_and_b32 v147, 0xffff0000, v149
    v_add_f32 v144, v144, v140
    v_add_f32 v145, v145, v140
    v_add_f32 v146, v146, v140
    v_add_f32 v147, v147, v140
    v_cvt_pk_bf16_f32 v144, v144, v145
    v_cvt_pk_bf16_f32 v145, v146, v147
    ds_write_b64 v141, v[144:145]
    v_exp_f32 v52, v52
    buffer_load_dwordx4 v[220:223], v1, s[4:7], s78 offen offset:1024 sc1
    v_exp_f32 v53, v53
    v_exp_f32 v54, v54
    v_mfma_f32_32x32x4_2b_bf16 v[16:47], v[122:123], v[120:121], 0 cbsz:1 abid:0
    ds_read_b128 v[124:127], v137 offset:0
    v_exp_f32 v55, v55
    v_exp_f32 v56, v56
    v_exp_f32 v57, v57
    v_exp_f32 v58, v58
    v_exp_f32 v59, v59
    v_exp_f32 v60, v60
    buffer_load_dwordx4 v[224:227], v1, s[4:7], s78 offen offset:2048 sc1
    v_exp_f32 v61, v61
    v_exp_f32 v62, v62
    v_exp_f32 v63, v63
    v_exp_f32 v64, v64
    s_waitcnt lgkmcnt(0)
    v_smfmac_f32_32x32x32_bf16 v[80:95], v[128:131], v[48:55], v136
    v_exp_f32 v65, v65
    v_exp_f32 v66, v66
    v_exp_f32 v67, v67
    s_setprio 0
    v_smfmac_f32_32x32x32_bf16 v[80:95], v[132:135], v[56:63], v136
    v_exp_f32 v68, v68
    v_exp_f32 v69, v69
    buffer_load_dwordx4 v[228:231], v1, s[4:7], s78 offen offset:3072 sc1
    v_exp_f32 v70, v70
    v_exp_f32 v71, v71
    v_mfma_f32_32x32x16_bf16 v[16:31], v[124:127], v[112:115], v[16:31]
    v_exp_f32 v72, v72
    v_exp_f32 v73, v73
    v_exp_f32 v74, v74
    v_exp_f32 v75, v75
    v_mfma_f32_32x32x16_bf16 v[32:47], v[124:127], v[116:119], v[32:47]
    v_exp_f32 v76, v76
    v_exp_f32 v77, v77
    buffer_load_dwordx4 v[232:235], v1, s[4:7], s79 offen offset:0 sc1
    v_exp_f32 v78, v78
    v_exp_f32 v79, v79
    v_smfmac_f32_32x32x32_bf16 v[96:111], v[128:131], v[64:71], v136
    s_nop 0
    v_exp_f32 v16, v16
    v_exp_f32 v17, v17
    v_exp_f32 v18, v18
    s_setprio 3
    v_smfmac_f32_32x32x32_bf16 v[96:111], v[132:135], v[72:79], v136
    s_mov_b64 exec, s[76:77]
    ds_read_b128 v[128:131], v139 offset:0
    ds_read_b128 v[132:135], v139 offset:640
    s_mov_b64 exec, -1
    v_exp_f32 v19, v19
    v_exp_f32 v20, v20
    s_sub_u32 s78, s78, 20480
    s_sub_u32 s79, s79, 20480
    buffer_load_dwordx4 v[196:199], v1, s[4:7], s78 offen offset:0 sc1
    v_exp_f32 v21, v21
    v_exp_f32 v22, v22
    v_mfma_f32_32x32x4_2b_bf16 v[48:79], v[122:123], v[120:121], 0 cbsz:1 abid:1
    ds_read_b128 v[124:127], v137 offset:512
    ds_read_b64 v[122:123], v138 offset:1024
    v_exp_f32 v23, v23
    v_exp_f32 v24, v24
    v_exp_f32 v25, v25
    v_exp_f32 v26, v26
    v_exp_f32 v27, v27
    v_exp_f32 v28, v28
    buffer_load_dwordx4 v[200:203], v1, s[4:7], s78 offen offset:1024 sc1
    v_exp_f32 v29, v29
    v_exp_f32 v30, v30
    v_exp_f32 v31, v31
    v_exp_f32 v32, v32
    s_waitcnt lgkmcnt(0)
    v_smfmac_f32_32x32x32_bf16 v[80:95], v[128:131], v[16:23], v136
    v_exp_f32 v33, v33
    v_exp_f32 v34, v34
    v_exp_f32 v35, v35
    s_setprio 2
    v_smfmac_f32_32x32x32_bf16 v[80:95], v[132:135], v[24:31], v136
    v_exp_f32 v36, v36
    v_exp_f32 v37, v37
    buffer_load_dwordx4 v[204:207], v1, s[4:7], s78 offen offset:2048 sc1
    v_exp_f32 v38, v38
    v_exp_f32 v39, v39
    v_mfma_f32_32x32x16_bf16 v[48:63], v[124:127], v[112:115], v[48:63]
    v_exp_f32 v40, v40
    v_mov_b32 v8, 18
    ds_write_b32 v10, v8
    v_exp_f32 v41, v41
    v_exp_f32 v42, v42
    v_exp_f32 v43, v43
    v_mfma_f32_32x32x16_bf16 v[64:79], v[124:127], v[116:119], v[64:79]
    v_exp_f32 v44, v44
    v_exp_f32 v45, v45
    buffer_load_dwordx4 v[208:211], v1, s[4:7], s78 offen offset:3072 sc1
    v_exp_f32 v46, v46
    v_exp_f32 v47, v47
    v_smfmac_f32_32x32x32_bf16 v[96:111], v[128:131], v[32:39], v136
    v_exp_f32 v48, v48
    v_exp_f32 v49, v49
    v_exp_f32 v50, v50
    s_setprio 1
    v_smfmac_f32_32x32x32_bf16 v[96:111], v[132:135], v[40:47], v136
    s_mov_b64 exec, s[76:77]
    ds_read_b128 v[128:131], v139 offset:1280
    ds_read_b128 v[132:135], v139 offset:1920
    s_mov_b64 exec, -1
    v_exp_f32 v51, v51
    v_exp_f32 v52, v52
    buffer_load_dwordx4 v[212:215], v1, s[4:7], s79 offen offset:0 sc1
    v_exp_f32 v53, v53
    v_exp_f32 v54, v54
    v_mfma_f32_32x32x4_2b_bf16 v[16:47], v[122:123], v[120:121], 0 cbsz:1 abid:0
    ds_read_b128 v[124:127], v137 offset:1024
    v_exp_f32 v55, v55
    v_exp_f32 v56, v56
    v_exp_f32 v57, v57
    v_exp_f32 v58, v58
    v_exp_f32 v59, v59
    v_exp_f32 v60, v60
    s_sub_u32 s78, s78, 20480
    s_sub_u32 s79, s79, 20480
    buffer_load_dwordx4 v[176:179], v1, s[4:7], s78 offen offset:0 sc1
    v_exp_f32 v61, v61
    v_exp_f32 v62, v62
    v_exp_f32 v63, v63
    v_exp_f32 v64, v64
    s_waitcnt lgkmcnt(0)
    v_smfmac_f32_32x32x32_bf16 v[80:95], v[128:131], v[48:55], v136
    v_exp_f32 v65, v65
    v_exp_f32 v66, v66
    v_exp_f32 v67, v67
    s_setprio 0
    v_smfmac_f32_32x32x32_bf16 v[80:95], v[132:135], v[56:63], v136
    v_exp_f32 v68, v68
    v_exp_f32 v69, v69
    buffer_load_dwordx4 v[180:183], v1, s[4:7], s78 offen offset:1024 sc1
    v_exp_f32 v70, v70
    v_exp_f32 v71, v71
    v_mfma_f32_32x32x16_bf16 v[16:31], v[124:127], v[112:115], v[16:31]
    v_exp_f32 v72, v72
    ds_read_b32 v9, v11
    v_exp_f32 v73, v73
    v_exp_f32 v74, v74
    v_exp_f32 v75, v75
    v_mfma_f32_32x32x16_bf16 v[32:47], v[124:127], v[116:119], v[32:47]
    v_exp_f32 v76, v76
    v_exp_f32 v77, v77
    buffer_load_dwordx4 v[184:187], v1, s[4:7], s78 offen offset:2048 sc1
    v_exp_f32 v78, v78
    v_exp_f32 v79, v79
    s_waitcnt lgkmcnt(0)
    v_cmp_gt_u32 vcc, 18, v9
    s_nop 0
    s_and_b32 vcc_lo, vcc_lo, 0xff
    s_cbranch_scc1 L_ck_92
L_cko_93:
    s_setprio 3
    v_smfmac_f32_32x32x32_bf16 v[96:111], v[128:131], v[64:71], v136
    v_exp_f32 v16, v16
    v_exp_f32 v17, v17
    v_exp_f32 v18, v18
    v_smfmac_f32_32x32x32_bf16 v[96:111], v[132:135], v[72:79], v136
    s_mov_b64 exec, s[76:77]
    ds_read_b128 v[128:131], v139 offset:2560
    ds_read_b128 v[132:135], v139 offset:3200
    s_mov_b64 exec, -1
    v_exp_f32 v19, v19
    v_exp_f32 v20, v20
    buffer_load_dwordx4 v[188:191], v1, s[4:7], s78 offen offset:3072 sc1
    v_exp_f32 v21, v21
    v_exp_f32 v22, v22
    v_mfma_f32_32x32x4_2b_bf16 v[48:79], v[122:123], v[120:121], 0 cbsz:1 abid:1
    ds_read_b128 v[124:127], v137 offset:1536
    v_exp_f32 v23, v23
    v_exp_f32 v24, v24
    v_exp_f32 v25, v25
    v_exp_f32 v26, v26
    v_exp_f32 v27, v27
    v_exp_f32 v28, v28
    buffer_load_dwordx4 v[192:195], v1, s[4:7], s79 offen offset:0 sc1
    v_exp_f32 v29, v29
    v_exp_f32 v30, v30
    v_exp_f32 v31, v31
    v_exp_f32 v32, v32
    s_waitcnt lgkmcnt(0)
    v_smfmac_f32_32x32x32_bf16 v[80:95], v[128:131], v[16:23], v136
    v_exp_f32 v33, v33
    v_exp_f32 v34, v34
    v_exp_f32 v35, v35
    v_smfmac_f32_32x32x32_bf16 v[80:95], v[132:135], v[24:31], v136
    v_exp_f32 v36, v36
    v_exp_f32 v37, v37
    s_sub_u32 s78, s78, 20480
    s_sub_u32 s79, s79, 20480
    buffer_load_dwordx4 v[156:159], v1, s[4:7], s78 offen offset:0 sc1
    v_exp_f32 v38, v38
    v_exp_f32 v39, v39
    v_mfma_f32_32x32x16_bf16 v[48:63], v[124:127], v[112:115], v[48:63]
    v_exp_f32 v40, v40
    v_exp_f32 v41, v41
    v_exp_f32 v42, v42
    v_exp_f32 v43, v43
    v_mfma_f32_32x32x16_bf16 v[64:79], v[124:127], v[116:119], v[64:79]
    v_exp_f32 v44, v44
    v_exp_f32 v45, v45
    buffer_load_dwordx4 v[160:163], v1, s[4:7], s78 offen offset:1024 sc1
    v_exp_f32 v46, v46
    v_exp_f32 v47, v47
    v_smfmac_f32_32x32x32_bf16 v[96:111], v[128:131], v[32:39], v136
    s_nop 0
    v_exp_f32 v48, v48
    v_exp_f32 v49, v49
    v_exp_f32 v50, v50
    v_smfmac_f32_32x32x32_bf16 v[96:111], v[132:135], v[40:47], v136
    s_mov_b64 exec, s[76:77]
    ds_read_b128 v[128:131], v139 offset:3840
    ds_read_b128 v[132:135], v139 offset:4480
    s_mov_b64 exec, -1
    v_exp_f32 v51, v51
    v_exp_f32 v52, v52
    buffer_load_dwordx4 v[164:167], v1, s[4:7], s78 offen offset:2048 sc1
    v_exp_f32 v53, v53
    v_exp_f32 v54, v54
    v_exp_f32 v55, v55
    v_exp_f32 v56, v56
    v_exp_f32 v57, v57
    v_exp_f32 v58, v58
    v_exp_f32 v59, v59
    v_exp_f32 v60, v60
    buffer_load_dwordx4 v[168:171], v1, s[4:7], s78 offen offset:3072 sc1
    v_exp_f32 v61, v61
    v_exp_f32 v62, v62
    v_exp_f32 v63, v63
    v_exp_f32 v64, v64
    s_waitcnt lgkmcnt(0)
    v_smfmac_f32_32x32x32_bf16 v[80:95], v[128:131], v[48:55], v136
    v_exp_f32 v65, v65
    v_exp_f32 v66, v66
    v_exp_f32 v67, v67
    v_smfmac_f32_32x32x32_bf16 v[80:95], v[132:135], v[56:63], v136
    v_exp_f32 v68, v68
    v_exp_f32 v69, v69
    buffer_load_dwordx4 v[172:175], v1, s[4:7], s79 offen offset:0 sc1
    v_exp_f32 v70, v70
    v_exp_f32 v71, v71
    v_exp_f32 v72, v72
    v_exp_f32 v73, v73
    v_exp_f32 v74, v74
    v_exp_f32 v75, v75
    v_exp_f32 v76, v76
    v_exp_f32 v77, v77
    v_exp_f32 v78, v78
    v_exp_f32 v79, v79
    s_lshl_b32 s60, s84, 12
    s_xor_b32 s61, s60, 4096
    v_smfmac_f32_32x32x32_bf16 v[96:111], v[128:131], v[64:71], v136
    v_smfmac_f32_32x32x32_bf16 v[96:111], v[132:135], v[72:79], v136
    s_setprio 3
    s_add_u32 s60, s60, 89600
    s_add_u32 s61, s61, 89600
    v_add_u32 v32, s60, v1
    v_add_u32 v33, s61, v1
    s_xor_b32 s60, s31, 1
    s_lshl_b32 s63, 1, s60
    s_cmp_eq_u32 s75, 0
    s_cbranch_scc1 L_give_94
    ds_write_b128 v32, v[80:83] offset:0
    ds_write_b128 v32, v[84:87] offset:1024
    ds_write_b128 v32, v[88:91] offset:2048
    ds_write_b128 v32, v[92:95] offset:3072
    v_mov_b32 v8, 24
    ds_write_b32 v10, v8
    s_waitcnt lgkmcnt(0)
    v_mov_b32 v80, v96
    v_mov_b32 v81, v97
    v_mov_b32 v82, v98
    v_mov_b32 v83, v99
    v_mov_b32 v84, v100
    v_mov_b32 v85, v101
    v_mov_b32 v86, v102
    v_mov_b32 v87, v103
    v_mov_b32 v88, v104
    v_mov_b32 v89, v105
    v_mov_b32 v90, v106
    v_mov_b32 v91, v107
    v_mov_b32 v92, v108
    s_branch L_keep_95
L_ck_66:
L_gs_96:
    ds_read_b32 v9, v11
    s_sub_i32 s66, s66, 1
    s_cmp_lt_i32 s66, 0
    s_waitcnt lgkmcnt(0)
    s_cbranch_scc1 L_gsd_97
    v_cmp_gt_u32 vcc, 4, v9
    s_nop 0
    s_and_b32 vcc_lo, vcc_lo, 0x0f
    s_cbranch_scc1 L_gs_96
L_gsd_97:
    s_branch L_cko_67
L_ck_68:
L_gs_98:
    ds_read_b32 v9, v11
    s_sub_i32 s66, s66, 1
    s_cmp_lt_i32 s66, 0
    s_waitcnt lgkmcnt(0)
    s_cbranch_scc1 L_gsd_99
    v_cmp_gt_u32 vcc, 6, v9
    s_nop 0
    s_and_b32 vcc_lo, vcc_lo, 0x0f
    s_cbranch_scc1 L_gs_98
L_gsd_99:
    s_branch L_cko_69
L_ck_70:
L_gs_100:
    ds_read_b32 v9, v11
    s_sub_i32 s66, s66, 1
    s_cmp_lt_i32 s66, 0
    s_waitcnt lgkmcnt(0)
    s_cbranch_scc1 L_gsd_101
    v_cmp_gt_u32 vcc, 8, v9
    s_nop 0
    s_and_b32 vcc_lo, vcc_lo, 0xff
    s_cbranch_scc1 L_gs_100
L_gsd_101:
    s_branch L_cko_71
L_ck_72:
L_gs_102:
    ds_read_b32 v9, v11
    s_sub_i32 s66, s66, 1
    s_cmp_lt_i32 s66, 0
    s_waitcnt lgkmcnt(0)
    s_cbranch_scc1 L_gsd_103
    v_cmp_gt_u32 vcc, 10, v9
    s_nop 0
    s_and_b32 vcc_lo, vcc_lo, 0xff
    s_cbranch_scc1 L_gs_102
L_gsd_103:
    s_branch L_cko_73
L_ck_82:
L_gs_104:
    ds_read_b32 v9, v11
    s_sub_i32 s66, s66, 1
    s_cmp_lt_i32 s66, 0
    s_waitcnt lgkmcnt(0)
    s_cbranch_scc1 L_gsd_105
    v_cmp_gt_u32 vcc, 12, v9
    s_nop 0
    s_and_b32 vcc_lo, vcc_lo, 0xff
    s_cbranch_scc1 L_gs_104
L_gsd_105:
    s_branch L_cko_83
L_ck_84:
L_gs_106:
    ds_read_b32 v9, v11
    s_sub_i32 s66, s66, 1
    s_cmp_lt_i32 s66, 0
    s_waitcnt lgkmcnt(0)
    s_cbranch_scc1 L_gsd_107
    v_cmp_gt_u32 vcc, 14, v9
    s_nop 0
    s_and_b32 vcc_lo, vcc_lo, 0xff
    s_cbranch_scc1 L_gs_106
L_gsd_107:
    s_branch L_cko_85
L_auxs_86:
    buffer_load_dword v146, v148, s[4:7], 0 offen sc1
    buffer_load_dword v147, v149, s[4:7], 0 offen sc1
    s_sub_i32 s66, s66, 4
    s_cmp_lt_i32 s66, 0
    s_waitcnt vmcnt(0)
    s_cbranch_scc1 L_auxok_87
    v_xor_b32 v146, s30, v146
    v_xor_b32 v147, s30, v147
    v_or_b32 v146, v146, v147
    v_cmp_ne_u32 vcc, 0, v146
    s_cbranch_vccnz L_auxs_86
    s_branch L_auxok_87
L_ck_88:
L_gs_108:
    ds_read_b32 v9, v11
    s_sub_i32 s66, s66, 1
    s_cmp_lt_i32 s66, 0
    s_waitcnt lgkmcnt(0)
    s_cbranch_scc1 L_gsd_109
    v_cmp_gt_u32 vcc, 16, v9
    s_nop 0
    s_and_b32 vcc_lo, vcc_lo, 0xff
    s_cbranch_scc1 L_gs_108
L_gsd_109:
    s_branch L_cko_89
L_ck_92:
L_gs_110:
    ds_read_b32 v9, v11
    s_sub_i32 s66, s66, 1
    s_cmp_lt_i32 s66, 0
    s_waitcnt lgkmcnt(0)
    s_cbranch_scc1 L_gsd_111
    v_cmp_gt_u32 vcc, 18, v9
    s_nop 0
    s_and_b32 vcc_lo, vcc_lo, 0xff
    s_cbranch_scc1 L_gs_110
L_gsd_111:
    s_branch L_cko_93
L_give_94:
    s_nop 2
    ds_write_b128 v32, v[96:99] offset:0
    ds_write_b128 v32, v[100:103] offset:1024
    ds_write_b128 v32, v[104:107] offset:2048
    ds_write_b128 v32, v[108:111] offset:3072
    v_mov_b32 v8, 24
    ds_write_b32 v10, v8
L_keep_95:
    s_lshl_b32 s65, s55, 2
    s_add_u32 s65, s65, s84
    s_mul_i32 s60, s65, 81920
    s_add_u32 s60, s60, 13631488
    s_lshl_b32 s61, s54, 10
    s_add_u32 s61, s61, s60
    s_lshl_b32 s62, s54, 8
    s_add_u32 s60, s60, s62
    s_add_u32 s60, s60, 32768
    s_lshl_b32 s65, s65, 3
    v_lshlrev_b32 v32, 3, v0
L_gs_112:
    ds_read_b32 v9, v11
    s_sub_i32 s66, s66, 1
    s_cmp_lt_i32 s66, 0
    s_waitcnt lgkmcnt(0)
    s_cbranch_scc1 L_gsd_113
    v_cmp_gt_u32 vcc, 24, v9
    s_nop 0
    s_and_b32 vcc_lo, vcc_lo, s63
    s_cbranch_scc1 L_gs_112
L_gsd_113:
    ds_read_b128 v[28:31], v33 offset:3072
    ds_read_b128 v[16:19], v33 offset:0
    ds_read_b128 v[20:23], v33 offset:1024
    ds_read_b128 v[24:27], v33 offset:2048
    v_mov_b32 v8, 25
    ds_write_b32 v10, v8
    s_waitcnt lgkmcnt(4)
    v_add_f32 v92, v92, v28
    v_rcp_f32 v34, v92
    v_subrev_u32 v35, 528482304, v92
    v_cmp_le_u32 vcc, 1140850688, v35
    s_waitcnt lgkmcnt(1)
    v_add_f32 v80, v80, v16
    v_add_f32 v81, v81, v17
    v_add_f32 v82, v82, v18
    v_add_f32 v83, v83, v19
    v_add_f32 v84, v84, v20
    v_add_f32 v85, v85, v21
    v_add_f32 v86, v86, v22
    v_add_f32 v87, v87, v23
    v_add_f32 v88, v88, v24
    v_add_f32 v89, v89, v25
    v_add_f32 v90, v90, v26
    v_add_f32 v91, v91, v27
    s_cbranch_vccz L_safe_114
    s_call_b64 s[40:41], L_exact
    v_lshlrev_b32 v32, 3, v0
    v_rcp_f32 v34, v92
    s_nop 1
L_safe_114:
    v_mul_f32 v80, v80, v34
    v_mul_f32 v81, v81, v34
    v_mul_f32 v82, v82, v34
    v_mul_f32 v83, v83, v34
    v_mul_f32 v84, v84, v34
    v_mul_f32 v85, v85, v34
    v_mul_f32 v86, v86, v34
    v_mul_f32 v87, v87, v34
    v_mul_f32 v88, v88, v34
    v_mul_f32 v89, v89, v34
    v_mul_f32 v90, v90, v34
    v_mul_f32 v91, v91, v34
    v_cvt_pk_bf16_f32 v16, v80, v81
    v_cvt_pk_bf16_f32 v17, v82, v83
    v_cvt_pk_bf16_f32 v18, v84, v85
    v_cvt_pk_bf16_f32 v19, v86, v87
    v_cvt_pk_bf16_f32 v20, v88, v89
    v_cvt_pk_bf16_f32 v21, v90, v91
    buffer_store_dwordx4 v[16:19], v1, s[4:7], s61 offen sc1
    s_mov_b32 exec_hi, 0
    buffer_store_dwordx2 v[20:21], v32, s[4:7], s60 offen sc1
    s_mov_b64 exec, -1
    s_lshl_b32 s80, s56, 3
    s_add_u32 s80, s80, s57
    s_mul_i32 s70, s84, 14
    s_min_u32 s70, s70, 41
    s_mul_i32 s60, s57, 276480
    s_add_u32 s60, s60, 28983296
    s_lshl_b32 s61, s70, 10
    s_add_u32 s60, s60, s61
    s_add_u32 s73, s60, 221184
    s_mul_i32 s61, s85, 110592
    s_add_u32 s71, s61, s60
    s_add_u32 s72, s71, 55296
    s_xor_b32 s61, s31, 4
    s_lshl_b32 s77, 1, s61
    s_lshl_b32 s81, s80, 7
    s_add_u32 s81, s81, 294912
    s_lshr_b32 s60, s84, 1
    s_and_b32 s61, s84, 1
    s_xor_b32 s62, s60, s61
    s_lshl_b32 s62, s62, 11
    s_mul_i32 s46, s60, 5120
    s_add_u32 s46, s46, s62
    s_mul_i32 s47, s61, 5120
    s_add_u32 s47, s47, 4096
    s_lshl_b32 s44, s56, 1
    s_add_u32 s44, s44, 0
    s_lshl_b32 s44, s44, 1
    s_and_b32 s45, s84, 1
    s_add_u32 s44, s44, s45
    s_lshl_b32 s44, s44, 4
    s_lshr_b32 s45, s84, 1
    s_lshl_b32 s45, s45, 6
    s_mov_b32 s40, 0
    s_add_u32 s46, s46, 67072
    s_add_u32 s47, s47, 67072
    s_mul_i32 s43, s84, 10240
    s_add_u32 s43, s43, 67072
    s_mul_i32 s60, s56, 81920
    s_lshl_b32 s61, s84, 13
    s_add_u32 s41, s60, s61
    s_add_u32 s41, s41, 13631488
    s_lshl_b32 s61, s84, 11
    s_add_u32 s42, s60, s61
    s_add_u32 s42, s42, 13664256
    s_lshl_b32 s62, s57, 1
    s_lshr_b32 s63, s84, 1
    s_add_u32 s62, s62, s63
    s_and_b32 s61, s44, 16
    s_lshl_b32 s61, s61, 3
    s_add_u32 s60, s60, s61
    s_lshl_b32 s49, s57, 10
    s_add_u32 s49, s49, s60
    s_add_u32 s49, s49, 16285696
    s_add_u32 s60, s60, s61
    s_lshl_b32 s48, s62, 11
    s_add_u32 s48, s48, s60
    s_add_u32 s48, s48, 16252928
    s_add_u32 s50, s44, s62
    s_lshl_b32 s50, s50, 7
    s_add_u32 s50, s50, 1310720
    s_lshl_b32 s82, s80, 7
    s_lshl_b32 s61, s84, 15
    s_add_u32 s82, s82, s61
    s_add_u32 s82, s82, 524288
    s_add_u32 s44, s64, 40960
    v_lshlrev_b32 v14, 9, v13
    v_lshl_add_u32 v14, v12, 4, v14
    s_lshr_b32 s63, s54, 3
    s_lshl_b32 s63, s63, 8
    s_add_u32 s65, s65, s63
    s_and_b32 s63, s54, 7
    s_lshl_b32 s60, s65, 7
    s_lshl_b32 s61, s63, 2
    s_add_u32 s60, s60, s61
    s_add_u32 s60, s60, 524288
    v_lshlrev_b32 v8, 7, v0
    v_mov_b32 v9, s30
    s_mov_b32 exec_lo, 255
    s_mov_b32 exec_hi, 0
    s_waitcnt vmcnt(0)
    buffer_store_dword v9, v8, s[4:7], s60 offen sc1
    s_mov_b64 exec, -1
    s_setprio 1
    s_cmp_eq_u32 s87, 7
    s_cbranch_scc1 L_attend_48_i
    s_mul_i32 s78, s86, 40960
    s_add_u32 s78, s78, 26786816
    s_mul_i32 s79, s87, 21504
    s_add_u32 m0, s79, 0
    s_nop 0
    buffer_load_dwordx4 v1, s[4:7], s78 offen offset:0 sc1 lds
    s_add_u32 m0, s79, 0
    s_nop 0
    buffer_load_dwordx4 v1, s[4:7], s78 offen offset:1024 sc1 lds
    s_add_u32 m0, s79, 0
    s_nop 0
    buffer_load_dwordx4 v1, s[4:7], s78 offen offset:2048 sc1 lds
    s_add_u32 m0, s79, 0
    s_nop 0
    buffer_load_dwordx4 v1, s[4:7], s78 offen offset:3072 sc1 lds
    s_add_u32 m0, s79, 4096
    s_add_u32 s78, s78, 4096
    buffer_load_dwordx4 v1, s[4:7], s78 offen offset:0 sc1 lds
    s_add_u32 m0, s79, 4096
    s_nop 0
    buffer_load_dwordx4 v1, s[4:7], s78 offen offset:1024 sc1 lds
    s_add_u32 m0, s79, 4096
    s_nop 0
    buffer_load_dwordx4 v1, s[4:7], s78 offen offset:2048 sc1 lds
    s_add_u32 m0, s79, 4096
    s_nop 0
    buffer_load_dwordx4 v1, s[4:7], s78 offen offset:3072 sc1 lds
    s_add_u32 m0, s79, 8192
    s_add_u32 s78, s78, 4096
    buffer_load_dwordx4 v1, s[4:7], s78 offen offset:0 sc1 lds
    s_add_u32 m0, s79, 8192
    s_nop 0
    buffer_load_dwordx4 v1, s[4:7], s78 offen offset:1024 sc1 lds
    s_add_u32 m0, s79, 8192
    s_nop 0
    buffer_load_dwordx4 v1, s[4:7], s78 offen offset:2048 sc1 lds
    s_add_u32 m0, s79, 8192
    s_nop 0
    buffer_load_dwordx4 v1, s[4:7], s78 offen offset:3072 sc1 lds
    s_add_u32 m0, s79, 12288
    s_add_u32 s78, s78, 4096
    buffer_load_dwordx4 v1, s[4:7], s78 offen offset:0 sc1 lds
    s_add_u32 m0, s79, 12288
    s_nop 0
    buffer_load_dwordx4 v1, s[4:7], s78 offen offset:1024 sc1 lds
    s_add_u32 m0, s79, 12288
    s_nop 0
    buffer_load_dwordx4 v1, s[4:7], s78 offen offset:2048 sc1 lds
    s_add_u32 m0, s79, 12288
    s_nop 0
    buffer_load_dwordx4 v1, s[4:7], s78 offen offset:3072 sc1 lds
    s_add_u32 m0, s79, 16384
    s_add_u32 s78, s78, 4096
    buffer_load_dwordx4 v1, s[4:7], s78 offen offset:0 sc1 lds
    s_add_u32 m0, s79, 16384
    s_nop 0
    buffer_load_dwordx4 v1, s[4:7], s78 offen offset:1024 sc1 lds
    s_add_u32 m0, s79, 16384
    s_nop 0
    buffer_load_dwordx4 v1, s[4:7], s78 offen offset:2048 sc1 lds
    s_add_u32 m0, s79, 16384
    s_nop 0
    buffer_load_dwordx4 v1, s[4:7], s78 offen offset:3072 sc1 lds
    s_add_u32 m0, s79, 20480
    s_add_u32 s78, s78, 4096
    buffer_load_dwordx4 v1, s[4:7], s78 offen offset:0 sc1 lds
    s_buffer_load_dwordx8 s[32:39], s[4:7], s82 glc
    s_cmp_eq_u32 s87, 7
    s_cbranch_scc1 L_w1s_115
    s_mul_i32 s60, s86, 40960
    s_add_u32 s60, s60, 26777600
    buffer_load_dwordx4 v[120:123], v1, s[4:7], s60 offen offset:0 sc1
    buffer_load_dwordx4 v[124:127], v1, s[4:7], s60 offen offset:1024 sc1
    buffer_load_dwordx4 v[128:131], v1, s[4:7], s60 offen offset:2048 sc1
    buffer_load_dwordx4 v[132:135], v1, s[4:7], s60 offen offset:3072 sc1
    s_add_u32 s60, s60, 4096
    buffer_load_dwordx4 v[136:139], v1, s[4:7], s60 offen offset:0 sc1
    buffer_load_dwordx4 v[140:143], v1, s[4:7], s60 offen offset:1024 sc1
    buffer_load_dwordx4 v[144:147], v1, s[4:7], s60 offen offset:2048 sc1
    buffer_load_dwordx4 v[148:151], v1, s[4:7], s60 offen offset:3072 sc1
    s_add_u32 s60, s60, 4096
    buffer_load_dwordx4 v[152:155], v1, s[4:7], s60 offen offset:0 sc1
L_w1s_115:
    s_branch L_attend_48
L_attend_48_i:
    s_add_u32 s62, s71, 4096
    buffer_load_dwordx4 v[120:123], v1, s[4:7], s62 offen offset:1024 sc1
    s_add_u32 s62, s72, 4096
    buffer_load_dwordx4 v[124:127], v1, s[4:7], s62 offen offset:1024 sc1
    s_add_u32 s62, s71, 4096
    buffer_load_dwordx4 v[128:131], v1, s[4:7], s62 offen offset:2048 sc1
    s_add_u32 s62, s72, 4096
    buffer_load_dwordx4 v[132:135], v1, s[4:7], s62 offen offset:2048 sc1
    s_add_u32 s62, s71, 4096
    buffer_load_dwordx4 v[136:139], v1, s[4:7], s62 offen offset:3072 sc1
    s_add_u32 s62, s72, 4096
    buffer_load_dwordx4 v[140:143], v1, s[4:7], s62 offen offset:3072 sc1
    s_add_u32 s62, s71, 8192
    buffer_load_dwordx4 v[144:147], v1, s[4:7], s62 offen offset:0 sc1
    s_add_u32 s62, s72, 8192
    buffer_load_dwordx4 v[148:151], v1, s[4:7], s62 offen offset:0 sc1
    s_add_u32 s62, s71, 8192
    buffer_load_dwordx4 v[152:155], v1, s[4:7], s62 offen offset:1024 sc1
    s_waitcnt vmcnt(0)
    s_buffer_load_dwordx8 s[32:39], s[4:7], s82 glc
    s_branch L_attend_48
L_attB_47:
    s_setprio 2
    s_waitcnt vmcnt(0)
    v_mov_b32 v8, 3
    ds_write_b32 v10, v8
L_gs_116:
    ds_read_b32 v9, v11
    s_sub_i32 s66, s66, 1
    s_cmp_lt_i32 s66, 0
    s_waitcnt lgkmcnt(0)
    s_cbranch_scc1 L_gsd_117
    v_cmp_gt_u32 vcc, 3, v9
    s_nop 0
    s_and_b32 vcc_lo, vcc_lo, 0xf0
    s_cbranch_scc1 L_gs_116
L_gsd_117:
    s_cmp_lg_u32 s31, 4
    s_cbranch_scc1 L_pubd_118
    s_cmp_eq_u32 s53, 15
    s_cbranch_scc1 L_pubd_118
    s_mov_b64 exec, 0xff
    buffer_store_dword v61, v60, s[4:7], s65 offen sc1
    s_mov_b64 exec, -1
L_pubd_118:
    v_lshrrev_b32 v50, 4, v0
    v_bfe_u32 v51, v0, 2, 2
    v_and_b32 v52, 3, v0
    s_lshl_b32 s60, s31, 6
    s_add_u32 s60, s60, 57344
    v_and_b32 v53, 31, v0
    v_lshl_add_u32 v238, v53, 1, s60
    s_cmp_lg_u32 s51, 0
    s_cbranch_scc1 L_kn_120
    v_bfe_u32 v53, v0, 4, 1
    v_lshrrev_b32 v54, 5, v0
    v_lshl_add_u32 v240, v50, 3, v51
    v_lshl_add_u32 v53, v53, 3, v51
    v_mul_u32_u24 v54, 80, v54
    v_add3_u32 v241, v53, v54, 64
    v_lshl_add_u32 v52, v52, 3, s2
    v_mul_u32_u24 v240, 128, v240
    v_add_u32 v240, v240, v52
    v_mul_u32_u24 v241, 128, v241
    v_add_u32 v241, v241, v52
    v_mul_u32_u24 v53, 8192, v0
    v_lshrrev_b32 v53, 16, v53
    v_mul_u32_u24 v53, 3328, v53
    s_mul_i32 s60, s84, 27648
    v_add3_u32 v236, v53, v1, s60
    s_branch L_ke_119
L_kn_120:
    s_cmp_lg_u32 s51, 1
    s_cbranch_scc1 L_kn_121
    v_bfe_u32 v53, v0, 4, 1
    v_lshrrev_b32 v54, 5, v0
    v_lshl_add_u32 v53, v53, 2, v51
    v_mad_u32_u24 v240, v54, 20, v53
    v_mad_u32_u24 v241, v50, 40, v51
    v_add_u32 v241, 16, v241
    v_lshl_add_u32 v52, v52, 3, s2
    v_mul_u32_u24 v240, 160, v240
    v_add_u32 v240, v240, v52
    v_mul_u32_u24 v241, 160, v241
    v_add_u32 v241, v241, v52
    v_mul_u32_u24 v53, 6554, v0
    v_lshrrev_b32 v53, 16, v53
    v_mul_u32_u24 v53, 1120, v53
    s_mul_i32 s60, s84, 7680
    v_add3_u32 v236, v53, v1, s60
    s_branch L_ke_119
L_kn_121:
    v_lshl_add_u32 v240, v50, 2, v51
    v_lshl_add_u32 v52, v52, 3, s2
    v_mul_u32_u24 v240, 160, v240
    v_add_u32 v240, v240, v52
    v_mul_u32_u24 v53, 6554, v0
    v_lshrrev_b32 v53, 16, v53
    v_mul_u32_u24 v53, 1120, v53
    s_mul_i32 s60, s84, 7680
    v_add3_u32 v236, v53, v1, s60
L_ke_119:
    v_lshrrev_b32 v50, 3, v0
    v_and_b32 v51, 7, v0
    v_and_b32 v52, 2, v50
    v_xor_b32 v51, v51, v52
    v_mul_u32_u24 v50, 7680, v50
    v_lshl_add_u32 v50, v51, 4, v50
    s_lshl_b32 s60, s31, 6
    s_and_b32 s60, s60, 64
    v_xor_b32 v237, s60, v50
    v_lshrrev_b32 v189, 4, v0
    v_bfe_u32 v232, v0, 2, 2
    v_lshl_add_u32 v188, v189, 3, v232
    v_lshlrev_b32 v188, 7, v188
    v_bfe_u32 v232, v0, 3, 2
    v_xor_b32 v232, s84, v232
    v_lshl_add_u32 v188, v232, 5, v188
    v_and_b32 v232, 3, v0
    v_lshl_add_u32 v188, v232, 3, v188
    v_add_u32 v188, 32768, v188
    v_lshlrev_b32 v189, 4, v189
    v_add_u32 v189, 57344, v189
    v_and_b32 v12, 15, v0
    v_lshrrev_b32 v13, 4, v0
    v_lshlrev_b32 v143, 7, v0
    s_lshl_b32 s60, s31, 6
    s_add_u32 s60, s60, 160
    v_add_u32 v142, s60, v0
    s_cmp_eq_u32 s31, 4
    s_cbranch_scc1 L_tq_123
    s_mul_i32 s60, s57, 20
    v_min_u32 v51, 59, v0
    v_cmp_lt_u32 vcc, 19, v51
    v_add_u32 v142, s60, v51
    v_add_u32 v52, 300, v142
    v_cndmask_b32 v142, v142, v52, vcc
    v_cmp_lt_u32 vcc, 39, v51
    v_add_u32 v52, 140, v142
    s_nop 0
    v_cndmask_b32 v142, v142, v52, vcc
L_tq_123:
    v_and_b32 v50, 3, v0
    v_lshrrev_b32 v51, 4, v142
    v_mad_u32_u24 v51, v50, 40, v51
    v_add_lshl_u32 v148, v51, 20, 7
    s_lshr_b32 s60, s86, 1
    v_mad_u32_u24 v50, v50, 27, s60
    s_add_u32 s60, s57, 108
    v_lshl_add_u32 v51, v0, 3, s60
    v_cmp_gt_u32 vcc, 18, v0
    v_lshlrev_b32 v50, 7, v50
    v_lshlrev_b32 v51, 7, v51
    v_cndmask_b32 v50, v50, v51, vcc
    v_add_u32 v149, 131072, v50
    v_and_b32 v54, 0x23, v0
    v_and_b32 v53, 4, v0
    v_lshl_or_b32 v54, v53, 2, v54
    v_bfe_u32 v53, v0, 3, 2
    v_lshl_or_b32 v54, v53, 2, v54
    s_and_b32 s61, s54, 1
    s_lshl_b32 s61, s61, 3
    s_add_u32 s60, s61, s80
    s_add_u32 s60, s60, 4096
    v_lshl_add_u32 v138, v54, 4, s60
    v_and_b32 v54, 31, v54
    v_lshl_add_u32 v137, v55, 11, s80
    v_lshl_add_u32 v137, v54, 4, v137
    s_add_u32 s60, s80, 6144
    v_add_u32 v139, s60, v139
    v_mov_b32 v136, 0xdddddddd
    v_mov_b32 v128, 0
    s_mov_b32 exec_lo, 285212672
    s_mov_b32 exec_hi, 285212672
    v_mov_b32 v128, 0x3f803f80
    s_mov_b64 exec, -1
    v_mov_b32 v129, v128
    v_mov_b32 v130, v128
    v_mov_b32 v131, v129
    v_mov_b32 v132, v128
    v_mov_b32 v133, v129
    v_mov_b32 v134, v128
    v_mov_b32 v135, v129
L_gs_124:
    ds_read_b32 v9, v11
    s_sub_i32 s66, s66, 1
    s_cmp_lt_i32 s66, 0
    s_waitcnt lgkmcnt(0)
    s_cbranch_scc1 L_gsd_125
    v_cmp_gt_u32 vcc, 2, v9
    s_nop 0
    s_and_b32 vcc_lo, vcc_lo, 0xf8
    s_cbranch_scc1 L_gs_124
L_gsd_125:
    s_mul_i32 s62, s74, 3
    s_add_u32 m0, s71, 0
    s_add_u32 s62, s62, s68
    buffer_load_dwordx4 v1, s[4:7], s62 offen offset:0 sc1 lds
    buffer_load_dwordx4 v1, s[4:7], s62 offen offset:1024 sc1 lds
    s_mul_i32 s62, s74, 3
    s_add_u32 m0, s72, 0
    s_add_u32 s62, s62, s69
    buffer_load_dwordx4 v1, s[4:7], s62 offen offset:0 sc1 lds
    buffer_load_dwordx4 v1, s[4:7], s62 offen offset:1024 sc1 lds
    s_mul_i32 s62, s74, 3
    s_add_u32 m0, s73, 0
    s_add_u32 s62, s62, s70
    buffer_load_dwordx4 v1, s[4:7], s62 offen offset:0 sc1 lds
    buffer_load_dwordx4 v1, s[4:7], s62 offen offset:1024 sc1 lds
    v_mov_b32 v80, 0
    v_mov_b32 v81, 0
    v_mov_b32 v82, 0
    v_mov_b32 v83, 0
    v_mov_b32 v84, 0
    v_mov_b32 v85, 0
    v_mov_b32 v86, 0
    v_mov_b32 v87, 0
    v_mov_b32 v88, 0
    v_mov_b32 v89, 0
    v_mov_b32 v90, 0
    v_mov_b32 v91, 0
    v_mov_b32 v92, 0
    v_mov_b32 v93, 0
    v_mov_b32 v94, 0
    v_mov_b32 v95, 0
    v_mov_b32 v96, 0
    v_mov_b32 v97, 0
    v_mov_b32 v98, 0
    v_mov_b32 v99, 0
    v_mov_b32 v100, 0
    v_mov_b32 v101, 0
    v_mov_b32 v102, 0
    v_mov_b32 v103, 0
    v_mov_b32 v104, 0
    v_mov_b32 v105, 0
    v_mov_b32 v106, 0
    v_mov_b32 v107, 0
    v_mov_b32 v108, 0
    v_mov_b32 v109, 0
    v_mov_b32 v110, 0
    v_mov_b32 v111, 0
    ds_write_b16 v238, v2
    s_waitcnt vmcnt(0)
    v_mov_b32 v8, 8
    ds_write_b32 v10, v8
    s_cmp_lg_u32 s31, 7
    s_cbranch_scc1 L_fp_126
L_gs_127:
    ds_read_b32 v9, v11
    s_sub_i32 s66, s66, 1
    s_cmp_lt_i32 s66, 0
    s_waitcnt lgkmcnt(0)
    s_cbranch_scc1 L_gsd_128
    v_cmp_gt_u32 vcc, 4, v9
    s_nop 0
    s_and_b32 vcc_lo, vcc_lo, 8
    s_cbranch_scc1 L_gs_127
L_gsd_128:
    v_and_b32 v56, s81, v0
    v_and_b32 v57, 17, v56
    v_lshlrev_b32 v56, 2, v56
    v_lshlrev_b32 v57, 2, v57
    s_mov_b32 exec_lo, 4294967295
    s_mov_b32 exec_hi, 4294967295
L_poll_129:
    buffer_load_dword v58, v56, s[4:7], s82 offen sc1
    buffer_load_dword v59, v57, s[4:7], s83 offen sc1
    s_sub_i32 s66, s66, 4
    s_cmp_lt_i32 s66, 0
    s_cbranch_scc1 L_pdone_130
    s_waitcnt vmcnt(0)
    v_xor_b32 v58, s30, v58
    v_xor_b32 v59, s30, v59
    v_or_b32 v58, v58, v59
    v_cmp_ne_u32 vcc, 0, v58
    s_cbranch_vccnz L_poll_129
L_pdone_130:
    s_waitcnt vmcnt(0)
    s_mov_b64 exec, -1
    v_mov_b32 v8, 9
    ds_write_b32 v10, v8
L_fp_126:
L_gs_131:
    ds_read_b32 v9, v11
    s_sub_i32 s66, s66, 1
    s_cmp_lt_i32 s66, 0
    s_waitcnt lgkmcnt(0)
    s_cbranch_scc1 L_gsd_132
    v_cmp_gt_u32 vcc, 9, v9
    s_nop 0
    s_and_b32 vcc_lo, vcc_lo, 128
    s_cbranch_scc1 L_gs_131
L_gsd_132:
    buffer_load_dwordx4 v[112:115], v48, s[4:7], s78 offen sc1
    buffer_load_dwordx4 v[116:119], v48, s[4:7], s78 offen offset:512 sc1
    buffer_load_dwordx2 v[120:121], v1, s[4:7], s79 offen sc1
L_gs_133:
    ds_read_b32 v9, v11
    s_sub_i32 s66, s66, 1
    s_cmp_lt_i32 s66, 0
    s_waitcnt lgkmcnt(0)
    s_cbranch_scc1 L_gsd_134
    v_cmp_gt_u32 vcc, 6, v9
    s_nop 0
    s_and_b32 vcc_lo, vcc_lo, 0x0f
    s_cbranch_scc1 L_gs_133
L_gsd_134:
    s_mul_i32 s62, s74, 8
    s_add_u32 m0, s71, 67584
    s_add_u32 s62, s62, s68
    buffer_load_dwordx4 v1, s[4:7], s62 offen offset:0 sc1 lds
    buffer_load_dwordx4 v1, s[4:7], s62 offen offset:1024 sc1 lds
    s_mul_i32 s62, s74, 8
    s_add_u32 m0, s72, 67584
    s_add_u32 s62, s62, s69
    buffer_load_dwordx4 v1, s[4:7], s62 offen offset:0 sc1 lds
    buffer_load_dwordx4 v1, s[4:7], s62 offen offset:1024 sc1 lds
    s_mul_i32 s62, s74, 8
    s_add_u32 m0, s73, 67584
    s_add_u32 s62, s62, s70
    buffer_load_dwordx4 v1, s[4:7], s62 offen offset:0 sc1 lds
    buffer_load_dwordx4 v1, s[4:7], s62 offen offset:1024 sc1 lds
    s_waitcnt vmcnt(6)
    ds_read_b64 v[122:123], v138 offset:22528
    ds_read_b128 v[124:127], v137 offset:22528
    s_waitcnt lgkmcnt(1)
    v_mfma_f32_32x32x4_2b_bf16 v[16:47], v[122:123], v[120:121], 0 cbsz:1 abid:0
    s_waitcnt lgkmcnt(0)
    s_nop 15
    s_nop 0
    v_mfma_f32_32x32x16_bf16 v[16:31], v[124:127], v[112:115], v[16:31]
    v_mfma_f32_32x32x16_bf16 v[32:47], v[124:127], v[116:119], v[32:47]
    s_nop 10
    v_exp_f32 v16, v16
    v_exp_f32 v17, v17
    v_exp_f32 v18, v18
    s_setprio 3
    s_mov_b64 exec, s[76:77]
    ds_read_b128 v[128:131], v139 offset:22528
    ds_read_b128 v[132:135], v139 offset:23168
    s_mov_b64 exec, -1
    v_exp_f32 v19, v19
    v_exp_f32 v20, v20
    v_exp_f32 v21, v21
    v_exp_f32 v22, v22
    v_mfma_f32_32x32x4_2b_bf16 v[48:79], v[122:123], v[120:121], 0 cbsz:1 abid:1
    ds_read_b128 v[124:127], v137 offset:23040
    ds_read_b64 v[122:123], v138 offset:23552
    v_exp_f32 v23, v23
    v_exp_f32 v24, v24
    v_exp_f32 v25, v25
    v_exp_f32 v26, v26
    v_exp_f32 v27, v27
    v_exp_f32 v28, v28
    v_exp_f32 v29, v29
    v_exp_f32 v30, v30
    v_exp_f32 v31, v31
    v_exp_f32 v32, v32
    s_waitcnt lgkmcnt(0)
    v_smfmac_f32_32x32x32_bf16 v[80:95], v[128:131], v[16:23], v136
    v_exp_f32 v33, v33
    v_exp_f32 v34, v34
    v_exp_f32 v35, v35
    s_setprio 2
    v_smfmac_f32_32x32x32_bf16 v[80:95], v[132:135], v[24:31], v136
    v_exp_f32 v36, v36
    v_exp_f32 v37, v37
    v_exp_f32 v38, v38
    v_exp_f32 v39, v39
    v_mfma_f32_32x32x16_bf16 v[48:63], v[124:127], v[112:115], v[48:63]
    v_exp_f32 v40, v40
    s_cmp_lg_u32 s51, 0
    s_cbranch_scc1 L_kn_136
    s_add_u32 m0, s0, 0
    s_nop 0
    buffer_load_dwordx4 v236, s[20:23], s47 offen lds
    s_add_u32 m0, s0, 4096
    v_add_u32 v236, 110592, v236
    buffer_load_dwordx4 v236, s[20:23], s47 offen lds
    s_add_u32 m0, s0, 8192
    v_add_u32 v236, 110592, v236
    buffer_load_dwordx4 v236, s[20:23], s47 offen lds
    s_add_u32 m0, s0, 12288
    v_add_u32 v236, 110592, v236
    buffer_load_dwordx4 v236, s[20:23], s47 offen lds
    s_add_u32 m0, s0, 16384
    v_add_u32 v236, 110592, v236
    buffer_load_dwordx4 v236, s[20:23], s47 offen lds
    s_mov_b64 exec, -1
    s_branch L_ke_135
L_kn_136:
    s_cmp_lg_u32 s51, 1
    s_cbranch_scc1 L_kn_137
    s_mov_b32 exec_hi, 0x0fffffff
    s_add_u32 m0, s0, 0
    s_nop 0
    buffer_load_dwordx4 v236, s[20:23], s47 offen lds
    s_add_u32 m0, s0, 3840
    v_add_u32 v236, 30720, v236
    buffer_load_dwordx4 v236, s[20:23], s47 offen lds
    s_add_u32 m0, s0, 7680
    v_add_u32 v236, 30720, v236
    buffer_load_dwordx4 v236, s[20:23], s47 offen lds
    s_add_u32 m0, s0, 11520
    v_add_u32 v236, 30720, v236
    buffer_load_dwordx4 v236, s[20:23], s47 offen lds
    s_add_u32 m0, s0, 15360
    v_add_u32 v236, 30720, v236
    buffer_load_dwordx4 v236, s[20:23], s47 offen lds
    s_add_u32 m0, s0, 19200
    v_add_u32 v236, 30720, v236
    buffer_load_dwordx4 v236, s[20:23], s47 offen lds
    s_add_u32 m0, s0, 23040
    v_add_u32 v236, 30720, v236
    buffer_load_dwordx4 v236, s[20:23], s47 offen lds
    s_mov_b64 exec, -1
    s_branch L_ke_135
L_kn_137:
    s_mov_b32 exec_hi, 0x0fffffff
    s_add_u32 m0, s0, 0
    s_nop 0
    buffer_load_dwordx4 v236, s[20:23], s47 offen lds
    s_add_u32 m0, s0, 3840
    v_add_u32 v236, 30720, v236
    buffer_load_dwordx4 v236, s[20:23], s47 offen lds
    s_add_u32 m0, s0, 7680
    v_add_u32 v236, 30720, v236
    buffer_load_dwordx4 v236, s[20:23], s47 offen lds
    s_add_u32 m0, s0, 11520
    v_add_u32 v236, 30720, v236
    buffer_load_dwordx4 v236, s[20:23], s47 offen lds
    s_add_u32 m0, s0, 15360
    v_add_u32 v236, 30720, v236
    buffer_load_dwordx4 v236, s[20:23], s47 offen lds
    s_add_u32 m0, s0, 19200
    v_add_u32 v236, 30720, v236
    buffer_load_dwordx4 v236, s[20:23], s47 offen lds
    s_mov_b64 exec, -1
L_ke_135:
    v_exp_f32 v41, v41
    v_exp_f32 v42, v42
    v_exp_f32 v43, v43
    v_mfma_f32_32x32x16_bf16 v[64:79], v[124:127], v[116:119], v[64:79]
    v_exp_f32 v44, v44
    v_exp_f32 v45, v45
    v_exp_f32 v46, v46
    v_exp_f32 v47, v47
    v_smfmac_f32_32x32x32_bf16 v[96:111], v[128:131], v[32:39], v136
    v_exp_f32 v48, v48
    v_exp_f32 v49, v49
    v_exp_f32 v50, v50
    s_setprio 1
    v_smfmac_f32_32x32x32_bf16 v[96:111], v[132:135], v[40:47], v136
    s_mov_b64 exec, s[76:77]
    ds_read_b128 v[128:131], v139 offset:23808
    ds_read_b128 v[132:135], v139 offset:24448
    s_mov_b64 exec, -1
    v_exp_f32 v51, v51
    v_exp_f32 v52, v52
    v_exp_f32 v53, v53
    v_exp_f32 v54, v54
    v_mfma_f32_32x32x4_2b_bf16 v[16:47], v[122:123], v[120:121], 0 cbsz:1 abid:0
    ds_read_b128 v[124:127], v137 offset:23552
    v_exp_f32 v55, v55
    v_exp_f32 v56, v56
    v_exp_f32 v57, v57
    v_exp_f32 v58, v58
    v_exp_f32 v59, v59
    v_exp_f32 v60, v60
    v_exp_f32 v61, v61
    v_exp_f32 v62, v62
    v_exp_f32 v63, v63
    v_exp_f32 v64, v64
    s_waitcnt lgkmcnt(0)
    v_smfmac_f32_32x32x32_bf16 v[80:95], v[128:131], v[48:55], v136
    v_exp_f32 v65, v65
    s_cmp_eq_u32 s49, 0
    s_cbranch_scc1 L_rm_139
    s_lshl_b32 s60, s84, 10
    s_add_u32 m0, s60, 32768
    s_add_u32 s61, s48, 0
    buffer_load_dwordx4 v237, s[16:19], s61 offen lds
    s_add_u32 m0, s60, 36864
    s_add_u32 s61, s48, 245760
    buffer_load_dwordx4 v237, s[16:19], s61 offen lds
    s_add_u32 m0, s60, 40960
    s_add_u32 s61, s48, 491520
    buffer_load_dwordx4 v237, s[16:19], s61 offen lds
    s_add_u32 m0, s60, 45056
    s_add_u32 s61, s48, 737280
    buffer_load_dwordx4 v237, s[16:19], s61 offen lds
    s_add_u32 m0, s60, 49152
    s_add_u32 s61, s48, 983040
    buffer_load_dwordx4 v237, s[16:19], s61 offen lds
L_rm_139:
    v_exp_f32 v66, v66
    v_exp_f32 v67, v67
    s_setprio 0
    v_smfmac_f32_32x32x32_bf16 v[80:95], v[132:135], v[56:63], v136
    v_exp_f32 v68, v68
    v_exp_f32 v69, v69
    v_exp_f32 v70, v70
    v_exp_f32 v71, v71
    v_mfma_f32_32x32x16_bf16 v[16:31], v[124:127], v[112:115], v[16:31]
    v_exp_f32 v72, v72
    ds_read_b32 v9, v11
    v_exp_f32 v73, v73
    v_exp_f32 v74, v74
    v_exp_f32 v75, v75
    v_mfma_f32_32x32x16_bf16 v[32:47], v[124:127], v[116:119], v[32:47]
    v_exp_f32 v76, v76
    v_exp_f32 v77, v77
    v_exp_f32 v78, v78
    v_exp_f32 v79, v79
    s_waitcnt lgkmcnt(0)
    v_cmp_gt_u32 vcc, 8, v9
    s_nop 0
    s_and_b32 vcc_lo, vcc_lo, 0xff
    s_cbranch_scc1 L_ck_140
L_cko_141:
    v_smfmac_f32_32x32x32_bf16 v[96:111], v[128:131], v[64:71], v136
    v_exp_f32 v16, v16
    v_exp_f32 v17, v17
    v_exp_f32 v18, v18
    s_setprio 3
    v_smfmac_f32_32x32x32_bf16 v[96:111], v[132:135], v[72:79], v136
    s_mov_b64 exec, s[76:77]
    ds_read_b128 v[128:131], v139 offset:25088
    ds_read_b128 v[132:135], v139 offset:25728
    s_mov_b64 exec, -1
    v_exp_f32 v19, v19
    v_exp_f32 v20, v20
    v_exp_f32 v21, v21
    v_exp_f32 v22, v22
    v_mfma_f32_32x32x4_2b_bf16 v[48:79], v[122:123], v[120:121], 0 cbsz:1 abid:1
    ds_read_b128 v[124:127], v137 offset:24064
    ds_read_b64 v[122:123], v138 offset:0
    v_exp_f32 v23, v23
    v_exp_f32 v24, v24
    v_exp_f32 v25, v25
    v_exp_f32 v26, v26
    s_mul_i32 s62, s74, 9
    s_add_u32 m0, s71, 45056
    s_add_u32 s62, s62, s68
    buffer_load_dwordx4 v1, s[4:7], s62 offen offset:0 sc1 lds
    buffer_load_dwordx4 v1, s[4:7], s62 offen offset:1024 sc1 lds
    v_exp_f32 v27, v27
    v_exp_f32 v28, v28
    v_exp_f32 v29, v29
    v_exp_f32 v30, v30
    v_exp_f32 v31, v31
    v_exp_f32 v32, v32
    s_waitcnt lgkmcnt(0)
    v_smfmac_f32_32x32x32_bf16 v[80:95], v[128:131], v[16:23], v136
    v_exp_f32 v33, v33
    v_exp_f32 v34, v34
    v_exp_f32 v35, v35
    s_setprio 2
    v_smfmac_f32_32x32x32_bf16 v[80:95], v[132:135], v[24:31], v136
    v_exp_f32 v36, v36
    v_exp_f32 v37, v37
    v_exp_f32 v38, v38
    v_exp_f32 v39, v39
    v_mfma_f32_32x32x16_bf16 v[48:63], v[124:127], v[112:115], v[48:63]
    v_exp_f32 v40, v40
    v_exp_f32 v41, v41
    v_exp_f32 v42, v42
    v_exp_f32 v43, v43
    v_mfma_f32_32x32x16_bf16 v[64:79], v[124:127], v[116:119], v[64:79]
    v_exp_f32 v44, v44
    s_mul_i32 s62, s74, 9
    s_add_u32 m0, s72, 45056
    s_add_u32 s62, s62, s69
    buffer_load_dwordx4 v1, s[4:7], s62 offen offset:0 sc1 lds
    buffer_load_dwordx4 v1, s[4:7], s62 offen offset:1024 sc1 lds
    v_exp_f32 v45, v45
    v_exp_f32 v46, v46
    v_exp_f32 v47, v47
    v_smfmac_f32_32x32x32_bf16 v[96:111], v[128:131], v[32:39], v136
    v_exp_f32 v48, v48
    v_exp_f32 v49, v49
    v_exp_f32 v50, v50
    s_setprio 1
    v_smfmac_f32_32x32x32_bf16 v[96:111], v[132:135], v[40:47], v136
    s_mov_b64 exec, s[76:77]
    ds_read_b128 v[128:131], v139 offset:26368
    ds_read_b128 v[132:135], v139 offset:27008
    s_mov_b64 exec, -1
    v_exp_f32 v51, v51
    v_exp_f32 v52, v52
    v_exp_f32 v53, v53
    v_exp_f32 v54, v54
    v_mfma_f32_32x32x4_2b_bf16 v[16:47], v[122:123], v[120:121], 0 cbsz:1 abid:0
    ds_read_b128 v[124:127], v137 offset:0
    v_exp_f32 v55, v55
    v_exp_f32 v56, v56
    v_exp_f32 v57, v57
    v_exp_f32 v58, v58
    s_mul_i32 s62, s74, 9
    s_add_u32 m0, s73, 45056
    s_add_u32 s62, s62, s70
    buffer_load_dwordx4 v1, s[4:7], s62 offen offset:0 sc1 lds
    buffer_load_dwordx4 v1, s[4:7], s62 offen offset:1024 sc1 lds
    v_exp_f32 v59, v59
    v_exp_f32 v60, v60
    v_exp_f32 v61, v61
    v_exp_f32 v62, v62
    v_exp_f32 v63, v63
    v_exp_f32 v64, v64
    s_waitcnt lgkmcnt(0)
    v_smfmac_f32_32x32x32_bf16 v[80:95], v[128:131], v[48:55], v136
    v_exp_f32 v65, v65
    v_exp_f32 v66, v66
    v_exp_f32 v67, v67
    s_setprio 0
    v_smfmac_f32_32x32x32_bf16 v[80:95], v[132:135], v[56:63], v136
    v_exp_f32 v68, v68
    v_exp_f32 v69, v69
    v_exp_f32 v70, v70
    v_exp_f32 v71, v71
    v_mfma_f32_32x32x16_bf16 v[16:31], v[124:127], v[112:115], v[16:31]
    v_exp_f32 v72, v72
    v_exp_f32 v73, v73
    v_exp_f32 v74, v74
    v_exp_f32 v75, v75
    v_mfma_f32_32x32x16_bf16 v[32:47], v[124:127], v[116:119], v[32:47]
    v_exp_f32 v76, v76
    v_exp_f32 v77, v77
    v_exp_f32 v78, v78
    v_exp_f32 v79, v79
    v_smfmac_f32_32x32x32_bf16 v[96:111], v[128:131], v[64:71], v136
    s_nop 1
    v_exp_f32 v16, v16
    v_exp_f32 v17, v17
    v_exp_f32 v18, v18
    s_setprio 3
    v_smfmac_f32_32x32x32_bf16 v[96:111], v[132:135], v[72:79], v136
    s_mov_b64 exec, s[76:77]
    ds_read_b128 v[128:131], v139 offset:0
    ds_read_b128 v[132:135], v139 offset:640
    s_mov_b64 exec, -1
    v_exp_f32 v19, v19
    v_exp_f32 v20, v20
    v_exp_f32 v21, v21
    v_exp_f32 v22, v22
    v_mfma_f32_32x32x4_2b_bf16 v[48:79], v[122:123], v[120:121], 0 cbsz:1 abid:1
    ds_read_b128 v[124:127], v137 offset:512
    ds_read_b64 v[122:123], v138 offset:1024
    v_exp_f32 v23, v23
    v_exp_f32 v24, v24
    v_exp_f32 v25, v25
    v_exp_f32 v26, v26
    v_exp_f32 v27, v27
    v_exp_f32 v28, v28
    v_exp_f32 v29, v29
    v_exp_f32 v30, v30
    v_exp_f32 v31, v31
    v_exp_f32 v32, v32
    s_waitcnt lgkmcnt(0)
    v_smfmac_f32_32x32x32_bf16 v[80:95], v[128:131], v[16:23], v136
    v_exp_f32 v33, v33
    v_exp_f32 v34, v34
    v_exp_f32 v35, v35
    s_setprio 2
    v_smfmac_f32_32x32x32_bf16 v[80:95], v[132:135], v[24:31], v136
    v_exp_f32 v36, v36
    v_exp_f32 v37, v37
    v_exp_f32 v38, v38
    v_exp_f32 v39, v39
    v_mfma_f32_32x32x16_bf16 v[48:63], v[124:127], v[112:115], v[48:63]
    v_exp_f32 v40, v40
    s_waitcnt vmcnt(6)
    v_mov_b32 v8, 10
    ds_write_b32 v10, v8
    v_exp_f32 v41, v41
    v_exp_f32 v42, v42
    v_exp_f32 v43, v43
    v_mfma_f32_32x32x16_bf16 v[64:79], v[124:127], v[116:119], v[64:79]
    v_exp_f32 v44, v44
    v_exp_f32 v45, v45
    v_exp_f32 v46, v46
    v_exp_f32 v47, v47
    v_smfmac_f32_32x32x32_bf16 v[96:111], v[128:131], v[32:39], v136
    v_exp_f32 v48, v48
    v_exp_f32 v49, v49
    v_exp_f32 v50, v50
    s_setprio 1
    v_smfmac_f32_32x32x32_bf16 v[96:111], v[132:135], v[40:47], v136
    s_mov_b64 exec, s[76:77]
    ds_read_b128 v[128:131], v139 offset:1280
    ds_read_b128 v[132:135], v139 offset:1920
    s_mov_b64 exec, -1
    v_exp_f32 v51, v51
    v_exp_f32 v52, v52
    v_exp_f32 v53, v53
    v_exp_f32 v54, v54
    v_mfma_f32_32x32x4_2b_bf16 v[16:47], v[122:123], v[120:121], 0 cbsz:1 abid:0
    ds_read_b128 v[124:127], v137 offset:1024
    v_exp_f32 v55, v55
    v_exp_f32 v56, v56
    v_exp_f32 v57, v57
    v_exp_f32 v58, v58
    v_exp_f32 v59, v59
    v_exp_f32 v60, v60
    v_exp_f32 v61, v61
    v_exp_f32 v62, v62
    v_exp_f32 v63, v63
    v_exp_f32 v64, v64
    s_waitcnt lgkmcnt(0)
    v_smfmac_f32_32x32x32_bf16 v[80:95], v[128:131], v[48:55], v136
    v_exp_f32 v65, v65
    v_exp_f32 v66, v66
    v_exp_f32 v67, v67
    s_setprio 0
    v_smfmac_f32_32x32x32_bf16 v[80:95], v[132:135], v[56:63], v136
    v_exp_f32 v68, v68
    v_exp_f32 v69, v69
    v_exp_f32 v70, v70
    v_exp_f32 v71, v71
    v_mfma_f32_32x32x16_bf16 v[16:31], v[124:127], v[112:115], v[16:31]
    v_exp_f32 v72, v72
    ds_read_b32 v9, v11
    v_exp_f32 v73, v73
    v_exp_f32 v74, v74
    v_exp_f32 v75, v75
    v_mfma_f32_32x32x16_bf16 v[32:47], v[124:127], v[116:119], v[32:47]
    v_exp_f32 v76, v76
    v_exp_f32 v77, v77
    v_exp_f32 v78, v78
    v_exp_f32 v79, v79
    s_waitcnt lgkmcnt(0)
    v_cmp_gt_u32 vcc, 10, v9
    s_nop 0
    s_and_b32 vcc_lo, vcc_lo, 0xff
    s_cbranch_scc1 L_ck_142
L_cko_143:
    v_smfmac_f32_32x32x32_bf16 v[96:111], v[128:131], v[64:71], v136
    v_exp_f32 v16, v16
    s_cmp_ge_u32 s31, s50
    s_cbranch_scc1 L_aw_144
    s_cmp_lg_u32 s51, 0
    s_cbranch_scc1 L_kn_146
    ds_read_b64_tr_b16 v[168:169], v240 offset:0
    ds_read_b64_tr_b16 v[170:171], v240 offset:512
    ds_read_b64_tr_b16 v[172:173], v240 offset:4096
    ds_read_b64_tr_b16 v[174:175], v240 offset:4608
    ds_read_b64_tr_b16 v[176:177], v240 offset:10240
    ds_read_b64_tr_b16 v[178:179], v240 offset:10752
    ds_read_b64_tr_b16 v[180:181], v240 offset:14336
    ds_read_b64_tr_b16 v[182:183], v240 offset:14848
    ds_read_b64_tr_b16 v[184:185], v241 offset:0
    ds_read_b64_tr_b16 v[186:187], v241 offset:512
    s_branch L_ke_145
L_kn_146:
    s_cmp_lg_u32 s51, 1
    s_cbranch_scc1 L_kn_147
    ds_read_b64_tr_b16 v[168:169], v240 offset:0
    ds_read_b64_tr_b16 v[170:171], v240 offset:1280
    ds_read_b64_tr_b16 v[172:173], v240 offset:6400
    ds_read_b64_tr_b16 v[174:175], v240 offset:7680
    ds_read_b64_tr_b16 v[176:177], v240 offset:12800
    ds_read_b64_tr_b16 v[178:179], v240 offset:14080
    ds_read_b64_tr_b16 v[180:181], v240 offset:19200
    ds_read_b64_tr_b16 v[182:183], v240 offset:20480
    ds_read_b64_tr_b16 v[184:185], v241 offset:0
    ds_read_b64_tr_b16 v[186:187], v241 offset:3200
    s_branch L_ke_145
L_kn_147:
    ds_read_b64_tr_b16 v[168:169], v240 offset:0
    ds_read_b64_tr_b16 v[170:171], v240 offset:2560
    ds_read_b64_tr_b16 v[172:173], v240 offset:5120
    ds_read_b64_tr_b16 v[174:175], v240 offset:7680
    ds_read_b64_tr_b16 v[176:177], v240 offset:10240
    ds_read_b64_tr_b16 v[178:179], v240 offset:12800
    ds_read_b64_tr_b16 v[180:181], v240 offset:15360
    ds_read_b64_tr_b16 v[182:183], v240 offset:17920
L_ke_145:
L_aw_144:
    v_exp_f32 v17, v17
    v_exp_f32 v18, v18
    s_setprio 3
    v_smfmac_f32_32x32x32_bf16 v[96:111], v[132:135], v[72:79], v136
    s_mov_b64 exec, s[76:77]
    ds_read_b128 v[128:131], v139 offset:2560
    ds_read_b128 v[132:135], v139 offset:3200
    s_mov_b64 exec, -1
    v_exp_f32 v19, v19
    v_exp_f32 v20, v20
    v_exp_f32 v21, v21
    v_exp_f32 v22, v22
    v_mfma_f32_32x32x4_2b_bf16 v[48:79], v[122:123], v[120:121], 0 cbsz:1 abid:1
    ds_read_b128 v[124:127], v137 offset:1536
    v_add_u32 v138, 45056, v138
    ds_read_b64 v[122:123], v138 offset:22528
    v_exp_f32 v23, v23
    v_exp_f32 v24, v24
    v_exp_f32 v25, v25
    v_exp_f32 v26, v26
    v_exp_f32 v27, v27
    v_exp_f32 v28, v28
    v_exp_f32 v29, v29
    v_exp_f32 v30, v30
    v_exp_f32 v31, v31
    v_exp_f32 v32, v32
    s_waitcnt lgkmcnt(0)
    v_smfmac_f32_32x32x32_bf16 v[80:95], v[128:131], v[16:23], v136
    v_exp_f32 v33, v33
    s_cmp_ge_u32 s31, s50
    s_cbranch_scc1 L_as_149
    buffer_store_dwordx4 v[168:171], v1, s[4:7], s42 offen sc1
    buffer_store_dwordx4 v[172:175], v1, s[4:7], s43 offen sc1
L_as_149:
    v_exp_f32 v34, v34
    v_exp_f32 v35, v35
    s_setprio 2
    v_smfmac_f32_32x32x32_bf16 v[80:95], v[132:135], v[24:31], v136
    v_exp_f32 v36, v36
    s_cmp_ge_u32 s31, s50
    s_cbranch_scc1 L_as_150
    s_cmp_eq_u32 s44, 0
    s_cbranch_scc1 L_as_150
    buffer_store_dwordx4 v[176:179], v1, s[4:7], s44 offen sc1
    buffer_store_dwordx4 v[180:183], v1, s[4:7], s45 offen sc1
L_as_150:
    v_exp_f32 v37, v37
    v_exp_f32 v38, v38
    v_exp_f32 v39, v39
    v_mfma_f32_32x32x16_bf16 v[48:63], v[124:127], v[112:115], v[48:63]
    v_exp_f32 v40, v40
    v_exp_f32 v41, v41
    s_cmp_ge_u32 s31, s50
    s_cbranch_scc1 L_as_151
    s_cmp_eq_u32 s46, 0
    s_cbranch_scc1 L_as_151
    buffer_store_dwordx4 v[184:187], v1, s[4:7], s46 offen sc1
L_as_151:
    v_exp_f32 v42, v42
    v_exp_f32 v43, v43
    v_mfma_f32_32x32x16_bf16 v[64:79], v[124:127], v[116:119], v[64:79]
    v_exp_f32 v44, v44
    v_exp_f32 v45, v45
    s_cmp_eq_u32 s49, 0
    s_cbranch_scc1 L_am_152
    ds_read_b64_tr_b16 v[192:193], v188 offset:0
    ds_read_b64_tr_b16 v[194:195], v188 offset:512
    ds_read_b128 v[212:215], v189 offset:0
    ds_read_b64_tr_b16 v[196:197], v188 offset:4096
    ds_read_b64_tr_b16 v[198:199], v188 offset:4608
    ds_read_b128 v[216:219], v189 offset:64
    ds_read_b64_tr_b16 v[200:201], v188 offset:8192
    ds_read_b64_tr_b16 v[202:203], v188 offset:8704
    ds_read_b128 v[220:223], v189 offset:128
L_am_152:
    v_exp_f32 v46, v46
    v_exp_f32 v47, v47
    v_smfmac_f32_32x32x32_bf16 v[96:111], v[128:131], v[32:39], v136
    v_exp_f32 v48, v48
    s_cmp_eq_u32 s49, 0
    s_cbranch_scc1 L_am_153
    ds_read_b64_tr_b16 v[204:205], v188 offset:12288
    ds_read_b64_tr_b16 v[206:207], v188 offset:12800
    ds_read_b128 v[224:227], v189 offset:192
    ds_read_b64_tr_b16 v[208:209], v188 offset:16384
    ds_read_b64_tr_b16 v[210:211], v188 offset:16896
    ds_read_b128 v[228:231], v189 offset:256
L_am_153:
    v_exp_f32 v49, v49
    v_exp_f32 v50, v50
    s_setprio 1
    v_smfmac_f32_32x32x32_bf16 v[96:111], v[132:135], v[40:47], v136
    s_mov_b64 exec, s[76:77]
    ds_read_b128 v[128:131], v139 offset:3840
    ds_read_b128 v[132:135], v139 offset:4480
    s_mov_b64 exec, -1
    v_exp_f32 v51, v51
    v_exp_f32 v52, v52
    v_exp_f32 v53, v53
    v_exp_f32 v54, v54
    v_mfma_f32_32x32x4_2b_bf16 v[16:47], v[122:123], v[120:121], 0 cbsz:1 abid:0
    v_add_u32 v137, 45056, v137
    ds_read_b128 v[124:127], v137 offset:22528
    v_exp_f32 v55, v55
    v_exp_f32 v56, v56
    v_exp_f32 v57, v57
    v_exp_f32 v58, v58
    v_exp_f32 v59, v59
    v_exp_f32 v60, v60
    v_exp_f32 v61, v61
    v_exp_f32 v62, v62
    v_exp_f32 v63, v63
    v_exp_f32 v64, v64
    s_waitcnt lgkmcnt(0)
    v_smfmac_f32_32x32x32_bf16 v[80:95], v[128:131], v[48:55], v136
    v_exp_f32 v65, v65
    s_cmp_eq_u32 s49, 0
    s_cbranch_scc1 L_am_154
    v_mfma_f32_16x16x32_bf16 v[232:235], v[212:215], v[192:195], 0
    v_mfma_f32_16x16x32_bf16 v[232:235], v[216:219], v[196:199], v[232:235]
    v_mfma_f32_16x16x32_bf16 v[232:235], v[220:223], v[200:203], v[232:235]
    v_mfma_f32_16x16x32_bf16 v[232:235], v[224:227], v[204:207], v[232:235]
    v_mfma_f32_16x16x32_bf16 v[232:235], v[228:231], v[208:211], v[232:235]
L_am_154:
    v_exp_f32 v66, v66
    v_exp_f32 v67, v67
    s_setprio 0
    v_smfmac_f32_32x32x32_bf16 v[80:95], v[132:135], v[56:63], v136
    v_exp_f32 v68, v68
    v_exp_f32 v69, v69
    v_exp_f32 v70, v70
    v_exp_f32 v71, v71
    v_mfma_f32_32x32x16_bf16 v[16:31], v[124:127], v[112:115], v[16:31]
    v_exp_f32 v72, v72
    v_exp_f32 v73, v73
    v_exp_f32 v74, v74
    s_cmp_eq_u32 s49, 0
    s_cbranch_scc1 L_am_155
    v_lshlrev_b32 v188, 2, v0
    s_mov_b64 exec, 0xffff
    buffer_store_dword v232, v188, s[4:7], s49 offen sc1
    s_mov_b64 exec, -1
L_am_155:
    v_exp_f32 v75, v75
    v_mfma_f32_32x32x16_bf16 v[32:47], v[124:127], v[116:119], v[32:47]
    v_exp_f32 v76, v76
    v_exp_f32 v77, v77
    v_exp_f32 v78, v78
    v_exp_f32 v79, v79
    v_smfmac_f32_32x32x32_bf16 v[96:111], v[128:131], v[64:71], v136
    v_exp_f32 v16, v16
    v_exp_f32 v17, v17
    v_exp_f32 v18, v18
    s_setprio 3
    v_smfmac_f32_32x32x32_bf16 v[96:111], v[132:135], v[72:79], v136
    v_add_u32 v139, 45056, v139
    s_mov_b64 exec, s[76:77]
    ds_read_b128 v[128:131], v139 offset:22528
    ds_read_b128 v[132:135], v139 offset:23168
    s_mov_b64 exec, -1
    v_exp_f32 v19, v19
    v_exp_f32 v20, v20
    v_exp_f32 v21, v21
    v_exp_f32 v22, v22
    v_mfma_f32_32x32x4_2b_bf16 v[48:79], v[122:123], v[120:121], 0 cbsz:1 abid:1
    ds_read_b128 v[124:127], v137 offset:23040
    ds_read_b64 v[122:123], v138 offset:23552
    v_exp_f32 v23, v23
    v_exp_f32 v24, v24
    v_exp_f32 v25, v25
    v_exp_f32 v26, v26
    v_exp_f32 v27, v27
    v_exp_f32 v28, v28
    v_exp_f32 v29, v29
    v_exp_f32 v30, v30
    v_exp_f32 v31, v31
    v_exp_f32 v32, v32
    s_waitcnt lgkmcnt(0)
    v_smfmac_f32_32x32x32_bf16 v[80:95], v[128:131], v[16:23], v136
    v_exp_f32 v33, v33
    v_exp_f32 v34, v34
    v_exp_f32 v35, v35
    s_setprio 2
    v_smfmac_f32_32x32x32_bf16 v[80:95], v[132:135], v[24:31], v136
    v_exp_f32 v36, v36
    v_exp_f32 v37, v37
    v_exp_f32 v38, v38
    v_exp_f32 v39, v39
    v_mfma_f32_32x32x16_bf16 v[48:63], v[124:127], v[112:115], v[48:63]
    v_exp_f32 v40, v40
    s_waitcnt vmcnt(0)
    v_mov_b32 v8, 12
    ds_write_b32 v10, v8
    v_exp_f32 v41, v41
    v_exp_f32 v42, v42
    v_exp_f32 v43, v43
    v_mfma_f32_32x32x16_bf16 v[64:79], v[124:127], v[116:119], v[64:79]
    v_exp_f32 v44, v44
    v_exp_f32 v45, v45
    v_exp_f32 v46, v46
    v_exp_f32 v47, v47
    v_smfmac_f32_32x32x32_bf16 v[96:111], v[128:131], v[32:39], v136
    v_exp_f32 v48, v48
    v_exp_f32 v49, v49
    v_exp_f32 v50, v50
    s_setprio 1
    v_smfmac_f32_32x32x32_bf16 v[96:111], v[132:135], v[40:47], v136
    s_mov_b64 exec, s[76:77]
    ds_read_b128 v[128:131], v139 offset:23808
    ds_read_b128 v[132:135], v139 offset:24448
    s_mov_b64 exec, -1
    v_exp_f32 v51, v51
    v_exp_f32 v52, v52
    v_exp_f32 v53, v53
    v_exp_f32 v54, v54
    v_mfma_f32_32x32x4_2b_bf16 v[16:47], v[122:123], v[120:121], 0 cbsz:1 abid:0
    ds_read_b128 v[124:127], v137 offset:23552
    v_exp_f32 v55, v55
    v_exp_f32 v56, v56
    v_exp_f32 v57, v57
    v_exp_f32 v58, v58
    v_exp_f32 v59, v59
    v_exp_f32 v60, v60
    v_exp_f32 v61, v61
    v_exp_f32 v62, v62
    v_exp_f32 v63, v63
    v_exp_f32 v64, v64
    s_waitcnt lgkmcnt(0)
    v_smfmac_f32_32x32x32_bf16 v[80:95], v[128:131], v[48:55], v136
    v_exp_f32 v65, v65
    v_exp_f32 v66, v66
    v_exp_f32 v67, v67
    s_setprio 0
    v_smfmac_f32_32x32x32_bf16 v[80:95], v[132:135], v[56:63], v136
    v_exp_f32 v68, v68
    v_exp_f32 v69, v69
    v_exp_f32 v70, v70
    v_exp_f32 v71, v71
    v_mfma_f32_32x32x16_bf16 v[16:31], v[124:127], v[112:115], v[16:31]
    v_exp_f32 v72, v72
    ds_read_b32 v9, v11
    v_exp_f32 v73, v73
    v_exp_f32 v74, v74
    v_exp_f32 v75, v75
    v_mfma_f32_32x32x16_bf16 v[32:47], v[124:127], v[116:119], v[32:47]
    v_exp_f32 v76, v76
    v_exp_f32 v77, v77
    v_exp_f32 v78, v78
    v_exp_f32 v79, v79
    s_waitcnt lgkmcnt(0)
    v_cmp_gt_u32 vcc, 12, v9
    s_nop 0
    s_and_b32 vcc_lo, vcc_lo, 0xff
    s_cbranch_scc1 L_ck_156
L_cko_157:
    v_smfmac_f32_32x32x32_bf16 v[96:111], v[128:131], v[64:71], v136
    v_exp_f32 v16, v16
    s_cmp_lg_u32 s31, 7
    s_cbranch_scc1 L_auxf_158
    s_lshl_b32 s60, s58, 7
    s_add_u32 s60, s60, 131072
    s_mov_b64 exec, 1
    v_mov_b32 v144, s30
    buffer_store_dword v144, off, s[4:7], s60 sc1
    s_mov_b64 exec, -1
    s_cmp_eq_u32 s49, 0
    s_cbranch_scc1 L_auxf_158
    s_mul_i32 s60, s67, 40
    s_add_u32 s60, s60, s59
    s_lshl_b32 s60, s60, 7
    s_mov_b64 exec, 1
    v_mov_b32 v144, s30
    buffer_store_dword v144, off, s[4:7], s60 sc1
    s_mov_b64 exec, -1
L_auxf_158:
    v_exp_f32 v17, v17
    v_exp_f32 v18, v18
    s_setprio 3
    v_smfmac_f32_32x32x32_bf16 v[96:111], v[132:135], v[72:79], v136
    s_mov_b64 exec, s[76:77]
    ds_read_b128 v[128:131], v139 offset:25088
    ds_read_b128 v[132:135], v139 offset:25728
    s_mov_b64 exec, -1
    v_exp_f32 v19, v19
    v_exp_f32 v20, v20
    v_exp_f32 v21, v21
    v_exp_f32 v22, v22
    v_mfma_f32_32x32x4_2b_bf16 v[48:79], v[122:123], v[120:121], 0 cbsz:1 abid:1
    ds_read_b128 v[124:127], v137 offset:24064
    ds_read_b64 v[122:123], v138 offset:0
    v_exp_f32 v23, v23
    v_exp_f32 v24, v24
    v_exp_f32 v25, v25
    v_exp_f32 v26, v26
    v_exp_f32 v27, v27
    v_exp_f32 v28, v28
    v_exp_f32 v29, v29
    v_exp_f32 v30, v30
    v_exp_f32 v31, v31
    v_exp_f32 v32, v32
    s_waitcnt lgkmcnt(0)
    v_smfmac_f32_32x32x32_bf16 v[80:95], v[128:131], v[16:23], v136
    v_exp_f32 v33, v33
    v_exp_f32 v34, v34
    v_exp_f32 v35, v35
    s_setprio 2
    v_smfmac_f32_32x32x32_bf16 v[80:95], v[132:135], v[24:31], v136
    v_exp_f32 v36, v36
    v_exp_f32 v37, v37
    v_exp_f32 v38, v38
    v_exp_f32 v39, v39
    v_mfma_f32_32x32x16_bf16 v[48:63], v[124:127], v[112:115], v[48:63]
    v_exp_f32 v40, v40
    v_exp_f32 v41, v41
    v_exp_f32 v42, v42
    v_exp_f32 v43, v43
    v_mfma_f32_32x32x16_bf16 v[64:79], v[124:127], v[116:119], v[64:79]
    v_exp_f32 v44, v44
    v_exp_f32 v45, v45
    v_exp_f32 v46, v46
    v_exp_f32 v47, v47
    v_smfmac_f32_32x32x32_bf16 v[96:111], v[128:131], v[32:39], v136
    s_nop 1
    v_exp_f32 v48, v48
    v_exp_f32 v49, v49
    v_exp_f32 v50, v50
    s_setprio 1
    v_smfmac_f32_32x32x32_bf16 v[96:111], v[132:135], v[40:47], v136
    s_mov_b64 exec, s[76:77]
    ds_read_b128 v[128:131], v139 offset:26368
    ds_read_b128 v[132:135], v139 offset:27008
    s_mov_b64 exec, -1
    v_exp_f32 v51, v51
    v_exp_f32 v52, v52
    v_exp_f32 v53, v53
    v_exp_f32 v54, v54
    v_mfma_f32_32x32x4_2b_bf16 v[16:47], v[122:123], v[120:121], 0 cbsz:1 abid:0
    ds_read_b128 v[124:127], v137 offset:0
    v_exp_f32 v55, v55
    v_exp_f32 v56, v56
    v_exp_f32 v57, v57
    v_exp_f32 v58, v58
    v_exp_f32 v59, v59
    v_exp_f32 v60, v60
    v_exp_f32 v61, v61
    v_exp_f32 v62, v62
    v_exp_f32 v63, v63
    v_exp_f32 v64, v64
    s_waitcnt lgkmcnt(0)
    v_smfmac_f32_32x32x32_bf16 v[80:95], v[128:131], v[48:55], v136
    v_exp_f32 v65, v65
    v_exp_f32 v66, v66
    v_exp_f32 v67, v67
    s_setprio 0
    v_smfmac_f32_32x32x32_bf16 v[80:95], v[132:135], v[56:63], v136
    v_exp_f32 v68, v68
    v_exp_f32 v69, v69
    v_exp_f32 v70, v70
    v_exp_f32 v71, v71
    v_mfma_f32_32x32x16_bf16 v[16:31], v[124:127], v[112:115], v[16:31]
    v_exp_f32 v72, v72
    v_exp_f32 v73, v73
    v_exp_f32 v74, v74
    v_exp_f32 v75, v75
    v_mfma_f32_32x32x16_bf16 v[32:47], v[124:127], v[116:119], v[32:47]
    v_exp_f32 v76, v76
    v_exp_f32 v77, v77
    v_exp_f32 v78, v78
    v_exp_f32 v79, v79
    v_smfmac_f32_32x32x32_bf16 v[96:111], v[128:131], v[64:71], v136
    s_nop 1
    v_exp_f32 v16, v16
    v_exp_f32 v17, v17
    v_exp_f32 v18, v18
    s_setprio 3
    v_smfmac_f32_32x32x32_bf16 v[96:111], v[132:135], v[72:79], v136
    s_mov_b64 exec, s[76:77]
    ds_read_b128 v[128:131], v139 offset:0
    ds_read_b128 v[132:135], v139 offset:640
    s_mov_b64 exec, -1
    v_exp_f32 v19, v19
    v_exp_f32 v20, v20
    v_exp_f32 v21, v21
    v_exp_f32 v22, v22
    v_mfma_f32_32x32x4_2b_bf16 v[48:79], v[122:123], v[120:121], 0 cbsz:1 abid:1
    ds_read_b128 v[124:127], v137 offset:512
    ds_read_b64 v[122:123], v138 offset:1024
    v_exp_f32 v23, v23
    v_exp_f32 v24, v24
    v_exp_f32 v25, v25
    v_exp_f32 v26, v26
    v_exp_f32 v27, v27
    v_exp_f32 v28, v28
    v_exp_f32 v29, v29
    v_exp_f32 v30, v30
    v_exp_f32 v31, v31
    v_exp_f32 v32, v32
    s_waitcnt lgkmcnt(0)
    v_smfmac_f32_32x32x32_bf16 v[80:95], v[128:131], v[16:23], v136
    v_exp_f32 v33, v33
    v_exp_f32 v34, v34
    v_exp_f32 v35, v35
    s_setprio 2
    v_smfmac_f32_32x32x32_bf16 v[80:95], v[132:135], v[24:31], v136
    v_exp_f32 v36, v36
    v_exp_f32 v37, v37
    v_exp_f32 v38, v38
    v_exp_f32 v39, v39
    v_mfma_f32_32x32x16_bf16 v[48:63], v[124:127], v[112:115], v[48:63]
    v_exp_f32 v40, v40
    v_mov_b32 v8, 14
    ds_write_b32 v10, v8
    v_exp_f32 v41, v41
    v_exp_f32 v42, v42
    v_exp_f32 v43, v43
    v_mfma_f32_32x32x16_bf16 v[64:79], v[124:127], v[116:119], v[64:79]
    v_exp_f32 v44, v44
    v_exp_f32 v45, v45
    v_exp_f32 v46, v46
    v_exp_f32 v47, v47
    v_smfmac_f32_32x32x32_bf16 v[96:111], v[128:131], v[32:39], v136
    v_exp_f32 v48, v48
    v_exp_f32 v49, v49
    v_exp_f32 v50, v50
    s_setprio 1
    v_smfmac_f32_32x32x32_bf16 v[96:111], v[132:135], v[40:47], v136
    s_mov_b64 exec, s[76:77]
    ds_read_b128 v[128:131], v139 offset:1280
    ds_read_b128 v[132:135], v139 offset:1920
    s_mov_b64 exec, -1
    v_exp_f32 v51, v51
    v_exp_f32 v52, v52
    v_exp_f32 v53, v53
    v_exp_f32 v54, v54
    v_mfma_f32_32x32x4_2b_bf16 v[16:47], v[122:123], v[120:121], 0 cbsz:1 abid:0
    ds_read_b128 v[124:127], v137 offset:1024
    v_exp_f32 v55, v55
    v_exp_f32 v56, v56
    v_exp_f32 v57, v57
    v_exp_f32 v58, v58
    v_exp_f32 v59, v59
    v_exp_f32 v60, v60
    v_exp_f32 v61, v61
    v_exp_f32 v62, v62
    v_exp_f32 v63, v63
    v_exp_f32 v64, v64
    s_waitcnt lgkmcnt(0)
    v_smfmac_f32_32x32x32_bf16 v[80:95], v[128:131], v[48:55], v136
    v_exp_f32 v65, v65
    v_exp_f32 v66, v66
    v_exp_f32 v67, v67
    s_setprio 0
    v_smfmac_f32_32x32x32_bf16 v[80:95], v[132:135], v[56:63], v136
    v_exp_f32 v68, v68
    v_exp_f32 v69, v69
    v_exp_f32 v70, v70
    v_exp_f32 v71, v71
    v_mfma_f32_32x32x16_bf16 v[16:31], v[124:127], v[112:115], v[16:31]
    v_exp_f32 v72, v72
    ds_read_b32 v9, v11
    v_exp_f32 v73, v73
    v_exp_f32 v74, v74
    v_exp_f32 v75, v75
    v_mfma_f32_32x32x16_bf16 v[32:47], v[124:127], v[116:119], v[32:47]
    v_exp_f32 v76, v76
    v_exp_f32 v77, v77
    v_exp_f32 v78, v78
    v_exp_f32 v79, v79
    s_waitcnt lgkmcnt(0)
    v_cmp_gt_u32 vcc, 14, v9
    s_nop 0
    s_and_b32 vcc_lo, vcc_lo, 0xff
    s_cbranch_scc1 L_ck_159
L_cko_160:
    v_smfmac_f32_32x32x32_bf16 v[96:111], v[128:131], v[64:71], v136
    v_exp_f32 v16, v16
    v_exp_f32 v17, v17
    v_exp_f32 v18, v18
    s_setprio 3
    v_smfmac_f32_32x32x32_bf16 v[96:111], v[132:135], v[72:79], v136
    s_mov_b64 exec, s[76:77]
    ds_read_b128 v[128:131], v139 offset:2560
    ds_read_b128 v[132:135], v139 offset:3200
    s_mov_b64 exec, -1
    v_exp_f32 v19, v19
    v_exp_f32 v20, v20
    v_exp_f32 v21, v21
    v_exp_f32 v22, v22
    v_mfma_f32_32x32x4_2b_bf16 v[48:79], v[122:123], v[120:121], 0 cbsz:1 abid:1
    ds_read_b128 v[124:127], v137 offset:1536
    v_add_u32 v138, 4294922240, v138
    ds_read_b64 v[122:123], v138 offset:22528
    v_exp_f32 v23, v23
    v_exp_f32 v24, v24
    v_exp_f32 v25, v25
    v_exp_f32 v26, v26
    s_mul_i32 s62, s74, 0
    s_add_u32 m0, s71, 67584
    s_add_u32 s62, s62, s68
    buffer_load_dwordx4 v1, s[4:7], s62 offen offset:0 sc1 lds
    buffer_load_dwordx4 v1, s[4:7], s62 offen offset:1024 sc1 lds
    v_exp_f32 v27, v27
    v_exp_f32 v28, v28
    v_exp_f32 v29, v29
    v_exp_f32 v30, v30
    v_exp_f32 v31, v31
    v_exp_f32 v32, v32
    s_waitcnt lgkmcnt(0)
    v_smfmac_f32_32x32x32_bf16 v[80:95], v[128:131], v[16:23], v136
    v_exp_f32 v33, v33
    buffer_load_dword v146, v148, s[4:7], 0 offen sc1
    buffer_load_dword v147, v149, s[4:7], 0 offen sc1
    v_exp_f32 v34, v34
    v_exp_f32 v35, v35
    s_setprio 2
    v_smfmac_f32_32x32x32_bf16 v[80:95], v[132:135], v[24:31], v136
    v_exp_f32 v36, v36
    v_exp_f32 v37, v37
    v_exp_f32 v38, v38
    v_exp_f32 v39, v39
    v_mfma_f32_32x32x16_bf16 v[48:63], v[124:127], v[112:115], v[48:63]
    v_exp_f32 v40, v40
    v_exp_f32 v41, v41
    v_exp_f32 v42, v42
    v_exp_f32 v43, v43
    v_mfma_f32_32x32x16_bf16 v[64:79], v[124:127], v[116:119], v[64:79]
    v_exp_f32 v44, v44
    s_mul_i32 s62, s74, 0
    s_add_u32 m0, s72, 67584
    s_add_u32 s62, s62, s69
    buffer_load_dwordx4 v1, s[4:7], s62 offen offset:0 sc1 lds
    buffer_load_dwordx4 v1, s[4:7], s62 offen offset:1024 sc1 lds
    v_exp_f32 v45, v45
    v_exp_f32 v46, v46
    v_exp_f32 v47, v47
    v_smfmac_f32_32x32x32_bf16 v[96:111], v[128:131], v[32:39], v136
    v_exp_f32 v48, v48
    v_exp_f32 v49, v49
    v_exp_f32 v50, v50
    s_setprio 1
    v_smfmac_f32_32x32x32_bf16 v[96:111], v[132:135], v[40:47], v136
    s_mov_b64 exec, s[76:77]
    ds_read_b128 v[128:131], v139 offset:3840
    ds_read_b128 v[132:135], v139 offset:4480
    s_mov_b64 exec, -1
    v_exp_f32 v51, v51
    v_exp_f32 v52, v52
    v_exp_f32 v53, v53
    v_exp_f32 v54, v54
    v_mfma_f32_32x32x4_2b_bf16 v[16:47], v[122:123], v[120:121], 0 cbsz:1 abid:0
    v_add_u32 v137, 4294922240, v137
    ds_read_b128 v[124:127], v137 offset:22528
    v_exp_f32 v55, v55
    v_exp_f32 v56, v56
    v_exp_f32 v57, v57
    v_exp_f32 v58, v58
    s_mul_i32 s62, s74, 0
    s_add_u32 m0, s73, 67584
    s_add_u32 s62, s62, s70
    buffer_load_dwordx4 v1, s[4:7], s62 offen offset:0 sc1 lds
    buffer_load_dwordx4 v1, s[4:7], s62 offen offset:1024 sc1 lds
    v_exp_f32 v59, v59
    v_exp_f32 v60, v60
    v_exp_f32 v61, v61
    v_exp_f32 v62, v62
    v_exp_f32 v63, v63
    v_exp_f32 v64, v64
    s_waitcnt lgkmcnt(0)
    v_smfmac_f32_32x32x32_bf16 v[80:95], v[128:131], v[48:55], v136
    v_exp_f32 v65, v65
    v_exp_f32 v66, v66
    v_exp_f32 v67, v67
    s_setprio 0
    v_smfmac_f32_32x32x32_bf16 v[80:95], v[132:135], v[56:63], v136
    v_exp_f32 v68, v68
    v_exp_f32 v69, v69
    v_exp_f32 v70, v70
    v_exp_f32 v71, v71
    v_mfma_f32_32x32x16_bf16 v[16:31], v[124:127], v[112:115], v[16:31]
    v_exp_f32 v72, v72
    v_exp_f32 v73, v73
    v_exp_f32 v74, v74
    v_exp_f32 v75, v75
    v_mfma_f32_32x32x16_bf16 v[32:47], v[124:127], v[116:119], v[32:47]
    v_exp_f32 v76, v76
    v_exp_f32 v77, v77
    v_exp_f32 v78, v78
    v_exp_f32 v79, v79
    v_smfmac_f32_32x32x32_bf16 v[96:111], v[128:131], v[64:71], v136
    s_nop 1
    v_exp_f32 v16, v16
    s_waitcnt vmcnt(4)
    v_xor_b32 v146, s30, v146
    v_xor_b32 v147, s30, v147
    v_or_b32 v146, v146, v147
    v_cmp_ne_u32 vcc, 0, v146
    s_cbranch_vccnz L_auxs_161
L_auxok_162:
    v_exp_f32 v17, v17
    v_exp_f32 v18, v18
    s_setprio 3
    v_smfmac_f32_32x32x32_bf16 v[96:111], v[132:135], v[72:79], v136
    v_add_u32 v139, 4294922240, v139
    s_mov_b64 exec, s[76:77]
    ds_read_b128 v[128:131], v139 offset:22528
    ds_read_b128 v[132:135], v139 offset:23168
    s_mov_b64 exec, -1
    v_exp_f32 v19, v19
    v_exp_f32 v20, v20
    v_lshlrev_b32 v140, 4, v142
    s_mov_b32 s60, 1053696
    buffer_load_dwordx4 v[144:147], v140, s[4:7], s60 offen sc1
    v_exp_f32 v21, v21
    v_exp_f32 v22, v22
    v_mfma_f32_32x32x4_2b_bf16 v[48:79], v[122:123], v[120:121], 0 cbsz:1 abid:1
    ds_read_b128 v[124:127], v137 offset:23040
    ds_read_b64 v[122:123], v138 offset:23552
    v_exp_f32 v23, v23
    v_exp_f32 v24, v24
    v_exp_f32 v25, v25
    v_exp_f32 v26, v26
    v_exp_f32 v27, v27
    v_exp_f32 v28, v28
    s_mov_b32 s60, 1069056
    buffer_load_dwordx4 v[148:151], v140, s[4:7], s60 offen sc1
    v_exp_f32 v29, v29
    v_exp_f32 v30, v30
    v_exp_f32 v31, v31
    v_exp_f32 v32, v32
    s_waitcnt lgkmcnt(0)
    v_smfmac_f32_32x32x32_bf16 v[80:95], v[128:131], v[16:23], v136
    v_exp_f32 v33, v33
    v_exp_f32 v34, v34
    v_exp_f32 v35, v35
    s_setprio 2
    v_smfmac_f32_32x32x32_bf16 v[80:95], v[132:135], v[24:31], v136
    v_exp_f32 v36, v36
    v_exp_f32 v37, v37
    s_mov_b32 s60, 1084416
    buffer_load_dwordx4 v[152:155], v140, s[4:7], s60 offen sc1
    v_exp_f32 v38, v38
    v_exp_f32 v39, v39
    v_mfma_f32_32x32x16_bf16 v[48:63], v[124:127], v[112:115], v[48:63]
    v_exp_f32 v40, v40
    v_mov_b32 v8, 16
    ds_write_b32 v10, v8
    v_exp_f32 v41, v41
    v_exp_f32 v42, v42
    v_exp_f32 v43, v43
    v_mfma_f32_32x32x16_bf16 v[64:79], v[124:127], v[116:119], v[64:79]
    v_exp_f32 v44, v44
    v_exp_f32 v45, v45
    s_mov_b32 s60, 1099776
    buffer_load_dwordx4 v[156:159], v140, s[4:7], s60 offen sc1
    v_exp_f32 v46, v46
    v_exp_f32 v47, v47
    v_smfmac_f32_32x32x32_bf16 v[96:111], v[128:131], v[32:39], v136
    v_exp_f32 v48, v48
    v_exp_f32 v49, v49
    v_exp_f32 v50, v50
    s_setprio 1
    v_smfmac_f32_32x32x32_bf16 v[96:111], v[132:135], v[40:47], v136
    s_mov_b64 exec, s[76:77]
    ds_read_b128 v[128:131], v139 offset:23808
    ds_read_b128 v[132:135], v139 offset:24448
    s_mov_b64 exec, -1
    v_exp_f32 v51, v51
    v_exp_f32 v52, v52
    s_mul_i32 s78, s86, 40960
    s_add_u32 s78, s78, 26808320
    buffer_load_dwordx4 v[252:255], v1, s[4:7], s78 offen offset:3072 sc1
    v_exp_f32 v53, v53
    v_exp_f32 v54, v54
    v_mfma_f32_32x32x4_2b_bf16 v[16:47], v[122:123], v[120:121], 0 cbsz:1 abid:0
    ds_read_b128 v[124:127], v137 offset:23552
    v_exp_f32 v55, v55
    v_exp_f32 v56, v56
    v_exp_f32 v57, v57
    v_exp_f32 v58, v58
    v_exp_f32 v59, v59
    v_exp_f32 v60, v60
    buffer_load_dwordx4 v[248:251], v1, s[4:7], s78 offen offset:2048 sc1
    v_exp_f32 v61, v61
    v_exp_f32 v62, v62
    v_exp_f32 v63, v63
    v_exp_f32 v64, v64
    s_waitcnt lgkmcnt(0)
    v_smfmac_f32_32x32x32_bf16 v[80:95], v[128:131], v[48:55], v136
    v_exp_f32 v65, v65
    v_exp_f32 v66, v66
    v_exp_f32 v67, v67
    s_setprio 0
    v_smfmac_f32_32x32x32_bf16 v[80:95], v[132:135], v[56:63], v136
    v_exp_f32 v68, v68
    v_exp_f32 v69, v69
    buffer_load_dwordx4 v[244:247], v1, s[4:7], s78 offen offset:1024 sc1
    v_exp_f32 v70, v70
    v_exp_f32 v71, v71
    v_mfma_f32_32x32x16_bf16 v[16:31], v[124:127], v[112:115], v[16:31]
    v_exp_f32 v72, v72
    ds_read_b32 v9, v11
    v_exp_f32 v73, v73
    v_exp_f32 v74, v74
    v_exp_f32 v75, v75
    v_mfma_f32_32x32x16_bf16 v[32:47], v[124:127], v[116:119], v[32:47]
    v_exp_f32 v76, v76
    v_exp_f32 v77, v77
    buffer_load_dwordx4 v[240:243], v1, s[4:7], s78 offen offset:0 sc1
    v_exp_f32 v78, v78
    v_exp_f32 v79, v79
    s_waitcnt lgkmcnt(0)
    v_cmp_gt_u32 vcc, 16, v9
    s_nop 0
    s_and_b32 vcc_lo, vcc_lo, 0xff
    s_cbranch_scc1 L_ck_163
L_cko_164:
    v_smfmac_f32_32x32x32_bf16 v[96:111], v[128:131], v[64:71], v136
    v_exp_f32 v16, v16
    v_exp_f32 v17, v17
    v_exp_f32 v18, v18
    s_setprio 3
    v_smfmac_f32_32x32x32_bf16 v[96:111], v[132:135], v[72:79], v136
    s_mov_b64 exec, s[76:77]
    ds_read_b128 v[128:131], v139 offset:25088
    ds_read_b128 v[132:135], v139 offset:25728
    s_mov_b64 exec, -1
    v_exp_f32 v19, v19
    s_waitcnt vmcnt(4)
    s_cmp_ge_u32 s31, 6
    s_cbranch_scc1 L_tb_166
    v_subrev_u32 v140, 320, v142
    v_cmp_gt_u32 vcc, 160, v140
    v_lshlrev_b32 v141, 3, v142
    v_add_u32 v141, 158720, v141
    v_cndmask_b32 v140, 0, 1.0, vcc
    v_add_f32 v144, v144, v148
    v_add_f32 v152, v152, v156
    v_add_f32 v145, v145, v149
    v_add_f32 v153, v153, v157
    v_add_f32 v146, v146, v150
    v_add_f32 v154, v154, v158
    v_add_f32 v147, v147, v151
    v_add_f32 v155, v155, v159
    v_add_f32 v144, v144, v152
    v_add_f32 v145, v145, v153
    v_add_f32 v146, v146, v154
    v_add_f32 v147, v147, v155
    v_cvt_pk_bf16_f32 v148, v144, v145
    v_cvt_pk_bf16_f32 v149, v146, v147
    v_lshlrev_b32 v144, 16, v148
    v_and_b32 v145, 0xffff0000, v148
    v_lshlrev_b32 v146, 16, v149
    v_and_b32 v147, 0xffff0000, v149
    v_add_f32 v144, v144, v140
    v_add_f32 v145, v145, v140
    v_add_f32 v146, v146, v140
    v_add_f32 v147, v147, v140
    v_cvt_pk_bf16_f32 v144, v144, v145
    v_cvt_pk_bf16_f32 v145, v146, v147
    s_cmp_lg_u32 s31, 4
    s_cbranch_scc1 L_tb_165
    ds_write_b64 v141, v[144:145]
    s_branch L_tb_166
L_tb_165:
    v_lshlrev_b32 v148, 16, v144
    v_and_b32 v149, 0xffff0000, v144
    v_lshlrev_b32 v150, 16, v145
    v_and_b32 v151, 0xffff0000, v145
    v_min_u32 v141, 944, v1
    v_add_u32 v141, 158720, v141
    ds_write_b128 v141, v[148:151]
L_tb_166:
    v_exp_f32 v20, v20
    s_sub_u32 s78, s78, 4096
    buffer_load_dwordx4 v[236:239], v1, s[4:7], s78 offen offset:3072 sc1
    v_exp_f32 v21, v21
    v_exp_f32 v22, v22
    v_mfma_f32_32x32x4_2b_bf16 v[48:79], v[122:123], v[120:121], 0 cbsz:1 abid:1
    ds_read_b128 v[124:127], v137 offset:24064
    ds_read_b64 v[122:123], v138 offset:0
    v_exp_f32 v23, v23
    v_exp_f32 v24, v24
    v_exp_f32 v25, v25
    v_exp_f32 v26, v26
    s_mul_i32 s62, s74, 1
    s_add_u32 m0, s71, 45056
    s_add_u32 s62, s62, s68
    buffer_load_dwordx4 v1, s[4:7], s62 offen offset:0 sc1 lds
    buffer_load_dwordx4 v1, s[4:7], s62 offen offset:1024 sc1 lds
    v_exp_f32 v27, v27
    v_exp_f32 v28, v28
    buffer_load_dwordx4 v[232:235], v1, s[4:7], s78 offen offset:2048 sc1
    v_exp_f32 v29, v29
    v_exp_f32 v30, v30
    v_exp_f32 v31, v31
    v_exp_f32 v32, v32
    s_waitcnt lgkmcnt(0)
    v_smfmac_f32_32x32x32_bf16 v[80:95], v[128:131], v[16:23], v136
    v_exp_f32 v33, v33
    v_exp_f32 v34, v34
    v_exp_f32 v35, v35
    s_setprio 2
    v_smfmac_f32_32x32x32_bf16 v[80:95], v[132:135], v[24:31], v136
    v_exp_f32 v36, v36
    v_exp_f32 v37, v37
    buffer_load_dwordx4 v[228:231], v1, s[4:7], s78 offen offset:1024 sc1
    v_exp_f32 v38, v38
    v_exp_f32 v39, v39
    v_mfma_f32_32x32x16_bf16 v[48:63], v[124:127], v[112:115], v[48:63]
    v_exp_f32 v40, v40
    v_exp_f32 v41, v41
    v_exp_f32 v42, v42
    v_exp_f32 v43, v43
    v_mfma_f32_32x32x16_bf16 v[64:79], v[124:127], v[116:119], v[64:79]
    v_exp_f32 v44, v44
    s_mul_i32 s62, s74, 1
    s_add_u32 m0, s72, 45056
    s_add_u32 s62, s62, s69
    buffer_load_dwordx4 v1, s[4:7], s62 offen offset:0 sc1 lds
    buffer_load_dwordx4 v1, s[4:7], s62 offen offset:1024 sc1 lds
    v_exp_f32 v45, v45
    buffer_load_dwordx4 v[224:227], v1, s[4:7], s78 offen offset:0 sc1
    v_exp_f32 v46, v46
    v_exp_f32 v47, v47
    v_smfmac_f32_32x32x32_bf16 v[96:111], v[128:131], v[32:39], v136
    v_exp_f32 v48, v48
    v_exp_f32 v49, v49
    v_exp_f32 v50, v50
    s_setprio 1
    v_smfmac_f32_32x32x32_bf16 v[96:111], v[132:135], v[40:47], v136
    s_mov_b64 exec, s[76:77]
    ds_read_b128 v[128:131], v139 offset:26368
    ds_read_b128 v[132:135], v139 offset:27008
    s_mov_b64 exec, -1
    v_exp_f32 v51, v51
    v_exp_f32 v52, v52
    s_sub_u32 s78, s78, 4096
    buffer_load_dwordx4 v[220:223], v1, s[4:7], s78 offen offset:3072 sc1
    v_exp_f32 v53, v53
    v_exp_f32 v54, v54
    v_mfma_f32_32x32x4_2b_bf16 v[16:47], v[122:123], v[120:121], 0 cbsz:1 abid:0
    ds_read_b128 v[124:127], v137 offset:0
    v_exp_f32 v55, v55
    v_exp_f32 v56, v56
    v_exp_f32 v57, v57
    v_exp_f32 v58, v58
    s_mul_i32 s62, s74, 1
    s_add_u32 m0, s73, 45056
    s_add_u32 s62, s62, s70
    buffer_load_dwordx4 v1, s[4:7], s62 offen offset:0 sc1 lds
    buffer_load_dwordx4 v1, s[4:7], s62 offen offset:1024 sc1 lds
    v_exp_f32 v59, v59
    v_exp_f32 v60, v60
    buffer_load_dwordx4 v[216:219], v1, s[4:7], s78 offen offset:2048 sc1
    v_exp_f32 v61, v61
    v_exp_f32 v62, v62
    v_exp_f32 v63, v63
    v_exp_f32 v64, v64
    s_waitcnt lgkmcnt(0)
    v_smfmac_f32_32x32x32_bf16 v[80:95], v[128:131], v[48:55], v136
    v_exp_f32 v65, v65
    v_exp_f32 v66, v66
    v_exp_f32 v67, v67
    s_setprio 0
    v_smfmac_f32_32x32x32_bf16 v[80:95], v[132:135], v[56:63], v136
    v_exp_f32 v68, v68
    v_exp_f32 v69, v69
    buffer_load_dwordx4 v[212:215], v1, s[4:7], s78 offen offset:1024 sc1
    v_exp_f32 v70, v70
    v_exp_f32 v71, v71
    v_mfma_f32_32x32x16_bf16 v[16:31], v[124:127], v[112:115], v[16:31]
    v_exp_f32 v72, v72
    v_exp_f32 v73, v73
    v_exp_f32 v74, v74
    v_exp_f32 v75, v75
    v_mfma_f32_32x32x16_bf16 v[32:47], v[124:127], v[116:119], v[32:47]
    v_exp_f32 v76, v76
    v_exp_f32 v77, v77
    buffer_load_dwordx4 v[208:211], v1, s[4:7], s78 offen offset:0 sc1
    v_exp_f32 v78, v78
    v_exp_f32 v79, v79
    v_smfmac_f32_32x32x32_bf16 v[96:111], v[128:131], v[64:71], v136
    s_nop 0
    v_exp_f32 v16, v16
    v_exp_f32 v17, v17
    v_exp_f32 v18, v18
    s_setprio 3
    v_smfmac_f32_32x32x32_bf16 v[96:111], v[132:135], v[72:79], v136
    s_mov_b64 exec, s[76:77]
    ds_read_b128 v[128:131], v139 offset:0
    ds_read_b128 v[132:135], v139 offset:640
    s_mov_b64 exec, -1
    v_exp_f32 v19, v19
    v_exp_f32 v20, v20
    s_sub_u32 s78, s78, 4096
    buffer_load_dwordx4 v[204:207], v1, s[4:7], s78 offen offset:3072 sc1
    v_exp_f32 v21, v21
    v_exp_f32 v22, v22
    v_mfma_f32_32x32x4_2b_bf16 v[48:79], v[122:123], v[120:121], 0 cbsz:1 abid:1
    ds_read_b128 v[124:127], v137 offset:512
    ds_read_b64 v[122:123], v138 offset:1024
    v_exp_f32 v23, v23
    v_exp_f32 v24, v24
    v_exp_f32 v25, v25
    v_exp_f32 v26, v26
    v_exp_f32 v27, v27
    v_exp_f32 v28, v28
    buffer_load_dwordx4 v[200:203], v1, s[4:7], s78 offen offset:2048 sc1
    v_exp_f32 v29, v29
    v_exp_f32 v30, v30
    v_exp_f32 v31, v31
    v_exp_f32 v32, v32
    s_waitcnt lgkmcnt(0)
    v_smfmac_f32_32x32x32_bf16 v[80:95], v[128:131], v[16:23], v136
    v_exp_f32 v33, v33
    v_exp_f32 v34, v34
    v_exp_f32 v35, v35
    s_setprio 2
    v_smfmac_f32_32x32x32_bf16 v[80:95], v[132:135], v[24:31], v136
    v_exp_f32 v36, v36
    v_exp_f32 v37, v37
    buffer_load_dwordx4 v[196:199], v1, s[4:7], s78 offen offset:1024 sc1
    v_exp_f32 v38, v38
    v_exp_f32 v39, v39
    v_mfma_f32_32x32x16_bf16 v[48:63], v[124:127], v[112:115], v[48:63]
    v_exp_f32 v40, v40
    v_mov_b32 v8, 18
    ds_write_b32 v10, v8
    v_exp_f32 v41, v41
    v_exp_f32 v42, v42
    v_exp_f32 v43, v43
    v_mfma_f32_32x32x16_bf16 v[64:79], v[124:127], v[116:119], v[64:79]
    v_exp_f32 v44, v44
    v_exp_f32 v45, v45
    buffer_load_dwordx4 v[192:195], v1, s[4:7], s78 offen offset:0 sc1
    v_exp_f32 v46, v46
    v_exp_f32 v47, v47
    v_smfmac_f32_32x32x32_bf16 v[96:111], v[128:131], v[32:39], v136
    v_exp_f32 v48, v48
    v_exp_f32 v49, v49
    v_exp_f32 v50, v50
    s_setprio 1
    v_smfmac_f32_32x32x32_bf16 v[96:111], v[132:135], v[40:47], v136
    s_mov_b64 exec, s[76:77]
    ds_read_b128 v[128:131], v139 offset:1280
    ds_read_b128 v[132:135], v139 offset:1920
    s_mov_b64 exec, -1
    v_exp_f32 v51, v51
    v_exp_f32 v52, v52
    s_sub_u32 s78, s78, 4096
    buffer_load_dwordx4 v[188:191], v1, s[4:7], s78 offen offset:3072 sc1
    v_exp_f32 v53, v53
    v_exp_f32 v54, v54
    v_mfma_f32_32x32x4_2b_bf16 v[16:47], v[122:123], v[120:121], 0 cbsz:1 abid:0
    ds_read_b128 v[124:127], v137 offset:1024
    v_exp_f32 v55, v55
    v_exp_f32 v56, v56
    v_exp_f32 v57, v57
    v_exp_f32 v58, v58
    v_exp_f32 v59, v59
    v_exp_f32 v60, v60
    buffer_load_dwordx4 v[184:187], v1, s[4:7], s78 offen offset:2048 sc1
    v_exp_f32 v61, v61
    v_exp_f32 v62, v62
    v_exp_f32 v63, v63
    v_exp_f32 v64, v64
    s_waitcnt lgkmcnt(0)
    v_smfmac_f32_32x32x32_bf16 v[80:95], v[128:131], v[48:55], v136
    v_exp_f32 v65, v65
    v_exp_f32 v66, v66
    v_exp_f32 v67, v67
    s_setprio 0
    v_smfmac_f32_32x32x32_bf16 v[80:95], v[132:135], v[56:63], v136
    v_exp_f32 v68, v68
    v_exp_f32 v69, v69
    buffer_load_dwordx4 v[180:183], v1, s[4:7], s78 offen offset:1024 sc1
    v_exp_f32 v70, v70
    v_exp_f32 v71, v71
    v_mfma_f32_32x32x16_bf16 v[16:31], v[124:127], v[112:115], v[16:31]
    v_exp_f32 v72, v72
    ds_read_b32 v9, v11
    v_exp_f32 v73, v73
    v_exp_f32 v74, v74
    v_exp_f32 v75, v75
    v_mfma_f32_32x32x16_bf16 v[32:47], v[124:127], v[116:119], v[32:47]
    v_exp_f32 v76, v76
    v_exp_f32 v77, v77
    buffer_load_dwordx4 v[176:179], v1, s[4:7], s78 offen offset:0 sc1
    v_exp_f32 v78, v78
    v_exp_f32 v79, v79
    s_waitcnt lgkmcnt(0)
    v_cmp_gt_u32 vcc, 18, v9
    s_nop 0
    s_and_b32 vcc_lo, vcc_lo, 0xff
    s_cbranch_scc1 L_ck_167
L_cko_168:
    s_setprio 2
    v_smfmac_f32_32x32x32_bf16 v[96:111], v[128:131], v[64:71], v136
    v_exp_f32 v16, v16
    v_exp_f32 v17, v17
    v_exp_f32 v18, v18
    v_smfmac_f32_32x32x32_bf16 v[96:111], v[132:135], v[72:79], v136
    s_mov_b64 exec, s[76:77]
    ds_read_b128 v[128:131], v139 offset:2560
    ds_read_b128 v[132:135], v139 offset:3200
    s_mov_b64 exec, -1
    v_exp_f32 v19, v19
    v_exp_f32 v20, v20
    s_sub_u32 s78, s78, 4096
    buffer_load_dwordx4 v[172:175], v1, s[4:7], s78 offen offset:3072 sc1
    v_exp_f32 v21, v21
    v_exp_f32 v22, v22
    v_mfma_f32_32x32x4_2b_bf16 v[48:79], v[122:123], v[120:121], 0 cbsz:1 abid:1
    ds_read_b128 v[124:127], v137 offset:1536
    v_add_u32 v138, 45056, v138
    ds_read_b64 v[122:123], v138 offset:22528
    v_exp_f32 v23, v23
    v_exp_f32 v24, v24
    v_exp_f32 v25, v25
    v_exp_f32 v26, v26
    v_exp_f32 v27, v27
    v_exp_f32 v28, v28
    buffer_load_dwordx4 v[168:171], v1, s[4:7], s78 offen offset:2048 sc1
    v_exp_f32 v29, v29
    v_exp_f32 v30, v30
    v_exp_f32 v31, v31
    v_exp_f32 v32, v32
    s_waitcnt lgkmcnt(0)
    v_smfmac_f32_32x32x32_bf16 v[80:95], v[128:131], v[16:23], v136
    v_exp_f32 v33, v33
    v_exp_f32 v34, v34
    v_exp_f32 v35, v35
    v_smfmac_f32_32x32x32_bf16 v[80:95], v[132:135], v[24:31], v136
    v_exp_f32 v36, v36
    v_exp_f32 v37, v37
    buffer_load_dwordx4 v[164:167], v1, s[4:7], s78 offen offset:1024 sc1
    v_exp_f32 v38, v38
    v_exp_f32 v39, v39
    v_mfma_f32_32x32x16_bf16 v[48:63], v[124:127], v[112:115], v[48:63]
    v_exp_f32 v40, v40
    v_exp_f32 v41, v41
    v_exp_f32 v42, v42
    v_exp_f32 v43, v43
    v_mfma_f32_32x32x16_bf16 v[64:79], v[124:127], v[116:119], v[64:79]
    v_exp_f32 v44, v44
    v_exp_f32 v45, v45
    buffer_load_dwordx4 v[160:163], v1, s[4:7], s78 offen offset:0 sc1
    v_exp_f32 v46, v46
    v_exp_f32 v47, v47
    v_smfmac_f32_32x32x32_bf16 v[96:111], v[128:131], v[32:39], v136
    s_nop 0
    v_exp_f32 v48, v48
    v_exp_f32 v49, v49
    v_exp_f32 v50, v50
    v_smfmac_f32_32x32x32_bf16 v[96:111], v[132:135], v[40:47], v136
    s_mov_b64 exec, s[76:77]
    ds_read_b128 v[128:131], v139 offset:3840
    ds_read_b128 v[132:135], v139 offset:4480
    s_mov_b64 exec, -1
    v_exp_f32 v51, v51
    v_exp_f32 v52, v52
    s_sub_u32 s78, s78, 4096
    buffer_load_dwordx4 v[156:159], v1, s[4:7], s78 offen offset:3072 sc1
    v_exp_f32 v53, v53
    v_exp_f32 v54, v54
    v_mfma_f32_32x32x4_2b_bf16 v[16:47], v[122:123], v[120:121], 0 cbsz:1 abid:0
    v_add_u32 v137, 45056, v137
    ds_read_b128 v[124:127], v137 offset:22528
    v_exp_f32 v55, v55
    v_exp_f32 v56, v56
    v_exp_f32 v57, v57
    v_exp_f32 v58, v58
    v_exp_f32 v59, v59
    v_exp_f32 v60, v60
    buffer_load_dwordx4 v[152:155], v1, s[4:7], s78 offen offset:2048 sc1
    v_exp_f32 v61, v61
    v_exp_f32 v62, v62
    v_exp_f32 v63, v63
    v_exp_f32 v64, v64
    s_waitcnt lgkmcnt(0)
    v_smfmac_f32_32x32x32_bf16 v[80:95], v[128:131], v[48:55], v136
    v_exp_f32 v65, v65
    v_exp_f32 v66, v66
    v_exp_f32 v67, v67
    v_smfmac_f32_32x32x32_bf16 v[80:95], v[132:135], v[56:63], v136
    v_exp_f32 v68, v68
    v_exp_f32 v69, v69
    buffer_load_dwordx4 v[148:151], v1, s[4:7], s78 offen offset:1024 sc1
    v_exp_f32 v70, v70
    v_exp_f32 v71, v71
    v_mfma_f32_32x32x16_bf16 v[16:31], v[124:127], v[112:115], v[16:31]
    v_exp_f32 v72, v72
    v_exp_f32 v73, v73
    v_exp_f32 v74, v74
    v_exp_f32 v75, v75
    v_mfma_f32_32x32x16_bf16 v[32:47], v[124:127], v[116:119], v[32:47]
    v_exp_f32 v76, v76
    v_exp_f32 v77, v77
    buffer_load_dwordx4 v[144:147], v1, s[4:7], s78 offen offset:0 sc1
    v_exp_f32 v78, v78
    v_exp_f32 v79, v79
    v_smfmac_f32_32x32x32_bf16 v[96:111], v[128:131], v[64:71], v136
    s_nop 0
    v_exp_f32 v16, v16
    v_exp_f32 v17, v17
    v_exp_f32 v18, v18
    v_smfmac_f32_32x32x32_bf16 v[96:111], v[132:135], v[72:79], v136
    v_add_u32 v139, 45056, v139
    s_mov_b64 exec, s[76:77]
    ds_read_b128 v[128:131], v139 offset:22528
    ds_read_b128 v[132:135], v139 offset:23168
    s_mov_b64 exec, -1
    v_exp_f32 v19, v19
    v_exp_f32 v20, v20
    v_exp_f32 v21, v21
    v_exp_f32 v22, v22
    v_mfma_f32_32x32x4_2b_bf16 v[48:79], v[122:123], v[120:121], 0 cbsz:1 abid:1
    ds_read_b128 v[124:127], v137 offset:23040
    ds_read_b64 v[122:123], v138 offset:23552
    v_exp_f32 v23, v23
    v_exp_f32 v24, v24
    v_exp_f32 v25, v25
    v_exp_f32 v26, v26
    v_exp_f32 v27, v27
    v_exp_f32 v28, v28
    v_exp_f32 v29, v29
    v_exp_f32 v30, v30
    v_exp_f32 v31, v31
    v_exp_f32 v32, v32
    s_waitcnt lgkmcnt(0)
    v_smfmac_f32_32x32x32_bf16 v[80:95], v[128:131], v[16:23], v136
    v_exp_f32 v33, v33
    v_exp_f32 v34, v34
    v_exp_f32 v35, v35
    v_smfmac_f32_32x32x32_bf16 v[80:95], v[132:135], v[24:31], v136
    v_exp_f32 v36, v36
    v_exp_f32 v37, v37
    v_exp_f32 v38, v38
    v_exp_f32 v39, v39
    v_mfma_f32_32x32x16_bf16 v[48:63], v[124:127], v[112:115], v[48:63]
    v_exp_f32 v40, v40
    s_waitcnt vmcnt(19)
    v_mov_b32 v8, 20
    ds_write_b32 v10, v8
    v_exp_f32 v41, v41
    v_exp_f32 v42, v42
    v_exp_f32 v43, v43
    v_mfma_f32_32x32x16_bf16 v[64:79], v[124:127], v[116:119], v[64:79]
    v_exp_f32 v44, v44
    v_exp_f32 v45, v45
    v_exp_f32 v46, v46
    v_exp_f32 v47, v47
    v_smfmac_f32_32x32x32_bf16 v[96:111], v[128:131], v[32:39], v136
    v_exp_f32 v48, v48
    v_exp_f32 v49, v49
    v_exp_f32 v50, v50
    v_smfmac_f32_32x32x32_bf16 v[96:111], v[132:135], v[40:47], v136
    s_mov_b64 exec, s[76:77]
    ds_read_b128 v[128:131], v139 offset:23808
    ds_read_b128 v[132:135], v139 offset:24448
    s_mov_b64 exec, -1
    v_exp_f32 v51, v51
    v_exp_f32 v52, v52
    v_exp_f32 v53, v53
    v_exp_f32 v54, v54
    v_mfma_f32_32x32x4_2b_bf16 v[16:47], v[122:123], v[120:121], 0 cbsz:1 abid:0
    ds_read_b128 v[124:127], v137 offset:23552
    v_exp_f32 v55, v55
    v_exp_f32 v56, v56
    v_exp_f32 v57, v57
    v_exp_f32 v58, v58
    v_exp_f32 v59, v59
    v_exp_f32 v60, v60
    v_exp_f32 v61, v61
    v_exp_f32 v62, v62
    v_exp_f32 v63, v63
    v_exp_f32 v64, v64
    s_waitcnt lgkmcnt(0)
    v_smfmac_f32_32x32x32_bf16 v[80:95], v[128:131], v[48:55], v136
    v_exp_f32 v65, v65
    v_exp_f32 v66, v66
    v_exp_f32 v67, v67
    v_smfmac_f32_32x32x32_bf16 v[80:95], v[132:135], v[56:63], v136
    v_exp_f32 v68, v68
    v_exp_f32 v69, v69
    v_exp_f32 v70, v70
    v_exp_f32 v71, v71
    v_mfma_f32_32x32x16_bf16 v[16:31], v[124:127], v[112:115], v[16:31]
    v_exp_f32 v72, v72
    ds_read_b32 v9, v11
    v_exp_f32 v73, v73
    v_exp_f32 v74, v74
    v_exp_f32 v75, v75
    v_mfma_f32_32x32x16_bf16 v[32:47], v[124:127], v[116:119], v[32:47]
    v_exp_f32 v76, v76
    v_exp_f32 v77, v77
    v_exp_f32 v78, v78
    v_exp_f32 v79, v79
    s_waitcnt lgkmcnt(0)
    v_cmp_gt_u32 vcc, 20, v9
    s_nop 0
    s_and_b32 vcc_lo, vcc_lo, 0xf0
    s_cbranch_scc1 L_ck_169
L_cko_170:
    v_smfmac_f32_32x32x32_bf16 v[96:111], v[128:131], v[64:71], v136
    v_exp_f32 v16, v16
    v_exp_f32 v17, v17
    v_exp_f32 v18, v18
    v_smfmac_f32_32x32x32_bf16 v[96:111], v[132:135], v[72:79], v136
    s_mov_b64 exec, s[76:77]
    ds_read_b128 v[128:131], v139 offset:25088
    ds_read_b128 v[132:135], v139 offset:25728
    s_mov_b64 exec, -1
    v_exp_f32 v19, v19
    v_exp_f32 v20, v20
    v_exp_f32 v21, v21
    v_exp_f32 v22, v22
    v_mfma_f32_32x32x4_2b_bf16 v[48:79], v[122:123], v[120:121], 0 cbsz:1 abid:1
    ds_read_b128 v[124:127], v137 offset:24064
    ds_read_b64 v[122:123], v138 offset:0
    v_exp_f32 v23, v23
    v_exp_f32 v24, v24
    v_exp_f32 v25, v25
    v_exp_f32 v26, v26
    v_exp_f32 v27, v27
    v_exp_f32 v28, v28
    v_exp_f32 v29, v29
    v_exp_f32 v30, v30
    v_exp_f32 v31, v31
    v_exp_f32 v32, v32
    s_waitcnt lgkmcnt(0)
    v_smfmac_f32_32x32x32_bf16 v[80:95], v[128:131], v[16:23], v136
    v_exp_f32 v33, v33
    v_exp_f32 v34, v34
    v_exp_f32 v35, v35
    v_smfmac_f32_32x32x32_bf16 v[80:95], v[132:135], v[24:31], v136
    v_exp_f32 v36, v36
    v_exp_f32 v37, v37
    v_exp_f32 v38, v38
    v_exp_f32 v39, v39
    v_mfma_f32_32x32x16_bf16 v[48:63], v[124:127], v[112:115], v[48:63]
    v_exp_f32 v40, v40
    v_exp_f32 v41, v41
    v_exp_f32 v42, v42
    v_exp_f32 v43, v43
    v_mfma_f32_32x32x16_bf16 v[64:79], v[124:127], v[116:119], v[64:79]
    v_exp_f32 v44, v44
    v_exp_f32 v45, v45
    v_exp_f32 v46, v46
    v_exp_f32 v47, v47
    v_smfmac_f32_32x32x32_bf16 v[96:111], v[128:131], v[32:39], v136
    s_nop 1
    v_exp_f32 v48, v48
    v_exp_f32 v49, v49
    v_exp_f32 v50, v50
    v_smfmac_f32_32x32x32_bf16 v[96:111], v[132:135], v[40:47], v136
    s_mov_b64 exec, s[76:77]
    ds_read_b128 v[128:131], v139 offset:26368
    ds_read_b128 v[132:135], v139 offset:27008
    s_mov_b64 exec, -1
    v_exp_f32 v51, v51
    v_exp_f32 v52, v52
    v_exp_f32 v53, v53
    v_exp_f32 v54, v54
    v_mfma_f32_32x32x4_2b_bf16 v[16:47], v[122:123], v[120:121], 0 cbsz:1 abid:0
    ds_read_b128 v[124:127], v137 offset:0
    v_exp_f32 v55, v55
    v_exp_f32 v56, v56
    v_exp_f32 v57, v57
    v_exp_f32 v58, v58
    v_exp_f32 v59, v59
    v_exp_f32 v60, v60
    v_exp_f32 v61, v61
    v_exp_f32 v62, v62
    v_exp_f32 v63, v63
    v_exp_f32 v64, v64
    s_waitcnt lgkmcnt(0)
    v_smfmac_f32_32x32x32_bf16 v[80:95], v[128:131], v[48:55], v136
    v_exp_f32 v65, v65
    v_exp_f32 v66, v66
    v_exp_f32 v67, v67
    v_smfmac_f32_32x32x32_bf16 v[80:95], v[132:135], v[56:63], v136
    v_exp_f32 v68, v68
    v_exp_f32 v69, v69
    v_exp_f32 v70, v70
    v_exp_f32 v71, v71
    v_mfma_f32_32x32x16_bf16 v[16:31], v[124:127], v[112:115], v[16:31]
    v_exp_f32 v72, v72
    v_exp_f32 v73, v73
    v_exp_f32 v74, v74
    v_exp_f32 v75, v75
    v_mfma_f32_32x32x16_bf16 v[32:47], v[124:127], v[116:119], v[32:47]
    v_exp_f32 v76, v76
    v_exp_f32 v77, v77
    v_exp_f32 v78, v78
    v_exp_f32 v79, v79
    v_smfmac_f32_32x32x32_bf16 v[96:111], v[128:131], v[64:71], v136
    s_nop 1
    v_exp_f32 v16, v16
    v_exp_f32 v17, v17
    v_exp_f32 v18, v18
    v_smfmac_f32_32x32x32_bf16 v[96:111], v[132:135], v[72:79], v136
    s_mov_b64 exec, s[76:77]
    ds_read_b128 v[128:131], v139 offset:0
    ds_read_b128 v[132:135], v139 offset:640
    s_mov_b64 exec, -1
    v_exp_f32 v19, v19
    v_exp_f32 v20, v20
    v_exp_f32 v21, v21
    v_exp_f32 v22, v22
    v_mfma_f32_32x32x4_2b_bf16 v[48:79], v[122:123], v[120:121], 0 cbsz:1 abid:1
    ds_read_b128 v[124:127], v137 offset:512
    ds_read_b64 v[122:123], v138 offset:1024
    v_exp_f32 v23, v23
    v_exp_f32 v24, v24
    v_exp_f32 v25, v25
    v_exp_f32 v26, v26
    v_exp_f32 v27, v27
    v_exp_f32 v28, v28
    v_exp_f32 v29, v29
    v_exp_f32 v30, v30
    v_exp_f32 v31, v31
    v_exp_f32 v32, v32
    s_waitcnt lgkmcnt(0)
    v_smfmac_f32_32x32x32_bf16 v[80:95], v[128:131], v[16:23], v136
    v_exp_f32 v33, v33
    v_exp_f32 v34, v34
    v_exp_f32 v35, v35
    v_smfmac_f32_32x32x32_bf16 v[80:95], v[132:135], v[24:31], v136
    v_exp_f32 v36, v36
    v_exp_f32 v37, v37
    v_exp_f32 v38, v38
    v_exp_f32 v39, v39
    v_mfma_f32_32x32x16_bf16 v[48:63], v[124:127], v[112:115], v[48:63]
    v_exp_f32 v40, v40
    v_mov_b32 v8, 22
    ds_write_b32 v10, v8
    v_exp_f32 v41, v41
    v_exp_f32 v42, v42
    v_exp_f32 v43, v43
    v_mfma_f32_32x32x16_bf16 v[64:79], v[124:127], v[116:119], v[64:79]
    v_exp_f32 v44, v44
    v_exp_f32 v45, v45
    v_exp_f32 v46, v46
    v_exp_f32 v47, v47
    v_smfmac_f32_32x32x32_bf16 v[96:111], v[128:131], v[32:39], v136
    v_exp_f32 v48, v48
    v_exp_f32 v49, v49
    v_exp_f32 v50, v50
    v_smfmac_f32_32x32x32_bf16 v[96:111], v[132:135], v[40:47], v136
    s_mov_b64 exec, s[76:77]
    ds_read_b128 v[128:131], v139 offset:1280
    ds_read_b128 v[132:135], v139 offset:1920
    s_mov_b64 exec, -1
    v_exp_f32 v51, v51
    v_exp_f32 v52, v52
    v_exp_f32 v53, v53
    v_exp_f32 v54, v54
    v_mfma_f32_32x32x4_2b_bf16 v[16:47], v[122:123], v[120:121], 0 cbsz:1 abid:0
    ds_read_b128 v[124:127], v137 offset:1024
    v_exp_f32 v55, v55
    v_exp_f32 v56, v56
    v_exp_f32 v57, v57
    v_exp_f32 v58, v58
    v_exp_f32 v59, v59
    v_exp_f32 v60, v60
    v_exp_f32 v61, v61
    v_exp_f32 v62, v62
    v_exp_f32 v63, v63
    v_exp_f32 v64, v64
    s_waitcnt lgkmcnt(0)
    v_smfmac_f32_32x32x32_bf16 v[80:95], v[128:131], v[48:55], v136
    v_exp_f32 v65, v65
    v_exp_f32 v66, v66
    v_exp_f32 v67, v67
    v_smfmac_f32_32x32x32_bf16 v[80:95], v[132:135], v[56:63], v136
    v_exp_f32 v68, v68
    v_exp_f32 v69, v69
    v_exp_f32 v70, v70
    v_exp_f32 v71, v71
    v_mfma_f32_32x32x16_bf16 v[16:31], v[124:127], v[112:115], v[16:31]
    v_exp_f32 v72, v72
    ds_read_b32 v9, v11
    v_exp_f32 v73, v73
    v_exp_f32 v74, v74
    v_exp_f32 v75, v75
    v_mfma_f32_32x32x16_bf16 v[32:47], v[124:127], v[116:119], v[32:47]
    v_exp_f32 v76, v76
    v_exp_f32 v77, v77
    v_exp_f32 v78, v78
    v_exp_f32 v79, v79
    s_waitcnt lgkmcnt(0)
    v_cmp_gt_u32 vcc, 22, v9
    s_nop 0
    s_and_b32 vcc_lo, vcc_lo, 0xf0
    s_cbranch_scc1 L_ck_171
L_cko_172:
    v_smfmac_f32_32x32x32_bf16 v[96:111], v[128:131], v[64:71], v136
    v_exp_f32 v16, v16
    v_exp_f32 v17, v17
    v_exp_f32 v18, v18
    v_smfmac_f32_32x32x32_bf16 v[96:111], v[132:135], v[72:79], v136
    s_mov_b64 exec, s[76:77]
    ds_read_b128 v[128:131], v139 offset:2560
    ds_read_b128 v[132:135], v139 offset:3200
    s_mov_b64 exec, -1
    v_exp_f32 v19, v19
    v_exp_f32 v20, v20
    v_exp_f32 v21, v21
    v_exp_f32 v22, v22
    v_mfma_f32_32x32x4_2b_bf16 v[48:79], v[122:123], v[120:121], 0 cbsz:1 abid:1
    ds_read_b128 v[124:127], v137 offset:1536
    v_exp_f32 v23, v23
    v_exp_f32 v24, v24
    v_exp_f32 v25, v25
    v_exp_f32 v26, v26
    v_exp_f32 v27, v27
    v_exp_f32 v28, v28
    v_exp_f32 v29, v29
    v_exp_f32 v30, v30
    v_exp_f32 v31, v31
    v_exp_f32 v32, v32
    s_waitcnt lgkmcnt(0)
    v_smfmac_f32_32x32x32_bf16 v[80:95], v[128:131], v[16:23], v136
    v_exp_f32 v33, v33
    v_exp_f32 v34, v34
    v_exp_f32 v35, v35
    v_smfmac_f32_32x32x32_bf16 v[80:95], v[132:135], v[24:31], v136
    v_exp_f32 v36, v36
    v_exp_f32 v37, v37
    v_exp_f32 v38, v38
    v_exp_f32 v39, v39
    v_mfma_f32_32x32x16_bf16 v[48:63], v[124:127], v[112:115], v[48:63]
    v_exp_f32 v40, v40
    v_exp_f32 v41, v41
    v_exp_f32 v42, v42
    v_exp_f32 v43, v43
    v_mfma_f32_32x32x16_bf16 v[64:79], v[124:127], v[116:119], v[64:79]
    v_exp_f32 v44, v44
    v_exp_f32 v45, v45
    v_exp_f32 v46, v46
    v_exp_f32 v47, v47
    v_smfmac_f32_32x32x32_bf16 v[96:111], v[128:131], v[32:39], v136
    s_nop 1
    v_exp_f32 v48, v48
    v_exp_f32 v49, v49
    v_exp_f32 v50, v50
    v_smfmac_f32_32x32x32_bf16 v[96:111], v[132:135], v[40:47], v136
    s_mov_b64 exec, s[76:77]
    ds_read_b128 v[128:131], v139 offset:3840
    ds_read_b128 v[132:135], v139 offset:4480
    s_mov_b64 exec, -1
    v_exp_f32 v51, v51
    v_exp_f32 v52, v52
    v_exp_f32 v53, v53
    v_exp_f32 v54, v54
    v_exp_f32 v55, v55
    v_exp_f32 v56, v56
    v_exp_f32 v57, v57
    v_exp_f32 v58, v58
    v_exp_f32 v59, v59
    v_exp_f32 v60, v60
    v_exp_f32 v61, v61
    v_exp_f32 v62, v62
    v_exp_f32 v63, v63
    v_exp_f32 v64, v64
    s_waitcnt lgkmcnt(0)
    v_smfmac_f32_32x32x32_bf16 v[80:95], v[128:131], v[48:55], v136
    v_exp_f32 v65, v65
    v_exp_f32 v66, v66
    v_exp_f32 v67, v67
    v_smfmac_f32_32x32x32_bf16 v[80:95], v[132:135], v[56:63], v136
    v_exp_f32 v68, v68
    v_exp_f32 v69, v69
    v_exp_f32 v70, v70
    v_exp_f32 v71, v71
    v_exp_f32 v72, v72
    v_exp_f32 v73, v73
    v_exp_f32 v74, v74
    v_exp_f32 v75, v75
    v_exp_f32 v76, v76
    v_exp_f32 v77, v77
    v_exp_f32 v78, v78
    v_exp_f32 v79, v79
    s_lshl_b32 s60, s84, 12
    s_xor_b32 s61, s60, 4096
    v_smfmac_f32_32x32x32_bf16 v[96:111], v[128:131], v[64:71], v136
    v_smfmac_f32_32x32x32_bf16 v[96:111], v[132:135], v[72:79], v136
    s_setprio 3
    s_add_u32 s60, s60, 134656
    s_add_u32 s61, s61, 134656
    v_add_u32 v32, s60, v1
    v_add_u32 v33, s61, v1
    s_xor_b32 s60, s31, 1
    s_lshl_b32 s63, 1, s60
    s_cmp_eq_u32 s75, 0
    s_cbranch_scc1 L_give_173
    ds_write_b128 v32, v[80:83] offset:0
    ds_write_b128 v32, v[84:87] offset:1024
    ds_write_b128 v32, v[88:91] offset:2048
    ds_write_b128 v32, v[92:95] offset:3072
    v_mov_b32 v8, 24
    ds_write_b32 v10, v8
    s_waitcnt lgkmcnt(0)
    v_mov_b32 v80, v96
    v_mov_b32 v81, v97
    v_mov_b32 v82, v98
    v_mov_b32 v83, v99
    v_mov_b32 v84, v100
    v_mov_b32 v85, v101
    v_mov_b32 v86, v102
    v_mov_b32 v87, v103
    v_mov_b32 v88, v104
    v_mov_b32 v89, v105
    v_mov_b32 v90, v106
    v_mov_b32 v91, v107
    v_mov_b32 v92, v108
    s_branch L_keep_174
L_ck_140:
L_gs_175:
    ds_read_b32 v9, v11
    s_sub_i32 s66, s66, 1
    s_cmp_lt_i32 s66, 0
    s_waitcnt lgkmcnt(0)
    s_cbranch_scc1 L_gsd_176
    v_cmp_gt_u32 vcc, 8, v9
    s_nop 0
    s_and_b32 vcc_lo, vcc_lo, 0xff
    s_cbranch_scc1 L_gs_175
L_gsd_176:
    s_branch L_cko_141
L_ck_142:
L_gs_177:
    ds_read_b32 v9, v11
    s_sub_i32 s66, s66, 1
    s_cmp_lt_i32 s66, 0
    s_waitcnt lgkmcnt(0)
    s_cbranch_scc1 L_gsd_178
    v_cmp_gt_u32 vcc, 10, v9
    s_nop 0
    s_and_b32 vcc_lo, vcc_lo, 0xff
    s_cbranch_scc1 L_gs_177
L_gsd_178:
    s_branch L_cko_143
L_ck_156:
L_gs_179:
    ds_read_b32 v9, v11
    s_sub_i32 s66, s66, 1
    s_cmp_lt_i32 s66, 0
    s_waitcnt lgkmcnt(0)
    s_cbranch_scc1 L_gsd_180
    v_cmp_gt_u32 vcc, 12, v9
    s_nop 0
    s_and_b32 vcc_lo, vcc_lo, 0xff
    s_cbranch_scc1 L_gs_179
L_gsd_180:
    s_branch L_cko_157
L_ck_159:
L_gs_181:
    ds_read_b32 v9, v11
    s_sub_i32 s66, s66, 1
    s_cmp_lt_i32 s66, 0
    s_waitcnt lgkmcnt(0)
    s_cbranch_scc1 L_gsd_182
    v_cmp_gt_u32 vcc, 14, v9
    s_nop 0
    s_and_b32 vcc_lo, vcc_lo, 0xff
    s_cbranch_scc1 L_gs_181
L_gsd_182:
    s_branch L_cko_160
L_auxs_161:
    buffer_load_dword v146, v148, s[4:7], 0 offen sc1
    buffer_load_dword v147, v149, s[4:7], 0 offen sc1
    s_sub_i32 s66, s66, 4
    s_cmp_lt_i32 s66, 0
    s_waitcnt vmcnt(0)
    s_cbranch_scc1 L_auxok_162
    v_xor_b32 v146, s30, v146
    v_xor_b32 v147, s30, v147
    v_or_b32 v146, v146, v147
    v_cmp_ne_u32 vcc, 0, v146
    s_cbranch_vccnz L_auxs_161
    s_branch L_auxok_162
L_ck_163:
L_gs_183:
    ds_read_b32 v9, v11
    s_sub_i32 s66, s66, 1
    s_cmp_lt_i32 s66, 0
    s_waitcnt lgkmcnt(0)
    s_cbranch_scc1 L_gsd_184
    v_cmp_gt_u32 vcc, 16, v9
    s_nop 0
    s_and_b32 vcc_lo, vcc_lo, 0xff
    s_cbranch_scc1 L_gs_183
L_gsd_184:
    s_branch L_cko_164
L_ck_167:
L_gs_185:
    ds_read_b32 v9, v11
    s_sub_i32 s66, s66, 1
    s_cmp_lt_i32 s66, 0
    s_waitcnt lgkmcnt(0)
    s_cbranch_scc1 L_gsd_186
    v_cmp_gt_u32 vcc, 18, v9
    s_nop 0
    s_and_b32 vcc_lo, vcc_lo, 0xff
    s_cbranch_scc1 L_gs_185
L_gsd_186:
    s_branch L_cko_168
L_ck_169:
L_gs_187:
    ds_read_b32 v9, v11
    s_sub_i32 s66, s66, 1
    s_cmp_lt_i32 s66, 0
    s_waitcnt lgkmcnt(0)
    s_cbranch_scc1 L_gsd_188
    v_cmp_gt_u32 vcc, 20, v9
    s_nop 0
    s_and_b32 vcc_lo, vcc_lo, 0xf0
    s_cbranch_scc1 L_gs_187
L_gsd_188:
    s_branch L_cko_170
L_ck_171:
L_gs_189:
    ds_read_b32 v9, v11
    s_sub_i32 s66, s66, 1
    s_cmp_lt_i32 s66, 0
    s_waitcnt lgkmcnt(0)
    s_cbranch_scc1 L_gsd_190
    v_cmp_gt_u32 vcc, 22, v9
    s_nop 0
    s_and_b32 vcc_lo, vcc_lo, 0xf0
    s_cbranch_scc1 L_gs_189
L_gsd_190:
    s_branch L_cko_172
L_give_173:
    s_nop 2
    ds_write_b128 v32, v[96:99] offset:0
    ds_write_b128 v32, v[100:103] offset:1024
    ds_write_b128 v32, v[104:107] offset:2048
    ds_write_b128 v32, v[108:111] offset:3072
    v_mov_b32 v8, 24
    ds_write_b32 v10, v8
L_keep_174:
    s_lshl_b32 s65, s55, 2
    s_add_u32 s65, s65, s84
    s_mul_i32 s60, s65, 81920
    s_add_u32 s60, s60, 13672448
    s_lshl_b32 s61, s54, 10
    s_add_u32 s61, s61, s60
    s_lshl_b32 s62, s54, 8
    s_add_u32 s60, s60, s62
    s_add_u32 s60, s60, 32768
    s_lshl_b32 s65, s65, 3
    v_lshlrev_b32 v32, 3, v0
L_gs_191:
    ds_read_b32 v9, v11
    s_sub_i32 s66, s66, 1
    s_cmp_lt_i32 s66, 0
    s_waitcnt lgkmcnt(0)
    s_cbranch_scc1 L_gsd_192
    v_cmp_gt_u32 vcc, 24, v9
    s_nop 0
    s_and_b32 vcc_lo, vcc_lo, s63
    s_cbranch_scc1 L_gs_191
L_gsd_192:
    ds_read_b128 v[28:31], v33 offset:3072
    ds_read_b128 v[16:19], v33 offset:0
    ds_read_b128 v[20:23], v33 offset:1024
    ds_read_b128 v[24:27], v33 offset:2048
    v_mov_b32 v8, 25
    ds_write_b32 v10, v8
    s_waitcnt lgkmcnt(4)
    v_add_f32 v92, v92, v28
    v_rcp_f32 v34, v92
    v_subrev_u32 v35, 528482304, v92
    v_cmp_le_u32 vcc, 1140850688, v35
    s_waitcnt lgkmcnt(1)
    v_add_f32 v80, v80, v16
    v_add_f32 v81, v81, v17
    v_add_f32 v82, v82, v18
    v_add_f32 v83, v83, v19
    v_add_f32 v84, v84, v20
    v_add_f32 v85, v85, v21
    v_add_f32 v86, v86, v22
    v_add_f32 v87, v87, v23
    v_add_f32 v88, v88, v24
    v_add_f32 v89, v89, v25
    v_add_f32 v90, v90, v26
    v_add_f32 v91, v91, v27
    s_cbranch_vccz L_safe_193
    s_call_b64 s[40:41], L_exact
    v_lshlrev_b32 v32, 3, v0
    v_rcp_f32 v34, v92
    s_nop 1
L_safe_193:
    v_mul_f32 v80, v80, v34
    v_mul_f32 v81, v81, v34
    v_mul_f32 v82, v82, v34
    v_mul_f32 v83, v83, v34
    v_mul_f32 v84, v84, v34
    v_mul_f32 v85, v85, v34
    v_mul_f32 v86, v86, v34
    v_mul_f32 v87, v87, v34
    v_mul_f32 v88, v88, v34
    v_mul_f32 v89, v89, v34
    v_mul_f32 v90, v90, v34
    v_mul_f32 v91, v91, v34
    v_cvt_pk_bf16_f32 v16, v80, v81
    v_cvt_pk_bf16_f32 v17, v82, v83
    v_cvt_pk_bf16_f32 v18, v84, v85
    v_cvt_pk_bf16_f32 v19, v86, v87
    v_cvt_pk_bf16_f32 v20, v88, v89
    v_cvt_pk_bf16_f32 v21, v90, v91
    buffer_store_dwordx4 v[16:19], v1, s[4:7], s61 offen sc1
    s_mov_b32 exec_hi, 0
    buffer_store_dwordx2 v[20:21], v32, s[4:7], s60 offen sc1
    s_mov_b64 exec, -1
    s_lshl_b32 s80, s56, 3
    s_add_u32 s80, s80, s57
    s_mul_i32 s70, s84, 14
    s_min_u32 s70, s70, 41
    s_mul_i32 s60, s57, 276480
    s_add_u32 s60, s60, 28983296
    s_lshl_b32 s61, s70, 10
    s_add_u32 s60, s60, s61
    s_add_u32 s73, s60, 221184
    s_mul_i32 s61, s85, 110592
    s_add_u32 s71, s61, s60
    s_add_u32 s72, s71, 55296
    s_xor_b32 s61, s31, 4
    s_lshl_b32 s77, 1, s61
    s_lshl_b32 s81, s80, 7
    s_add_u32 s81, s81, 294912
    s_lshr_b32 s63, s54, 3
    s_lshl_b32 s63, s63, 8
    s_add_u32 s65, s65, s63
    s_and_b32 s63, s54, 7
    s_lshl_b32 s60, s65, 7
    s_lshl_b32 s61, s63, 2
    s_add_u32 s60, s60, s61
    s_add_u32 s60, s60, 655360
    v_lshlrev_b32 v8, 7, v0
    v_mov_b32 v9, s30
    s_mov_b32 exec_lo, 255
    s_mov_b32 exec_hi, 0
    s_waitcnt vmcnt(0)
    buffer_store_dword v9, v8, s[4:7], s60 offen sc1
    s_mov_b64 exec, -1
    s_setprio 2
    s_cmp_eq_u32 s87, 7
    s_cbranch_scc1 L_w1s_194
    s_mul_i32 s60, s86, 40960
    s_add_u32 s60, s60, 26771456
    buffer_load_dwordx4 v[96:99], v1, s[4:7], s60 offen offset:0 sc1
    buffer_load_dwordx4 v[100:103], v1, s[4:7], s60 offen offset:1024 sc1
    buffer_load_dwordx4 v[104:107], v1, s[4:7], s60 offen offset:2048 sc1
    buffer_load_dwordx4 v[108:111], v1, s[4:7], s60 offen offset:3072 sc1
    s_add_u32 s60, s60, 4096
    buffer_load_dwordx4 v[112:115], v1, s[4:7], s60 offen offset:0 sc1
    buffer_load_dwordx4 v[116:119], v1, s[4:7], s60 offen offset:1024 sc1
    buffer_load_dwordx4 v[120:123], v1, s[4:7], s60 offen offset:2048 sc1
    buffer_load_dwordx4 v[124:127], v1, s[4:7], s60 offen offset:3072 sc1
    s_add_u32 s60, s60, 4096
    buffer_load_dwordx4 v[128:131], v1, s[4:7], s60 offen offset:0 sc1
    buffer_load_dwordx4 v[132:135], v1, s[4:7], s60 offen offset:1024 sc1
    buffer_load_dwordx4 v[136:139], v1, s[4:7], s60 offen offset:2048 sc1
    buffer_load_dwordx4 v[140:143], v1, s[4:7], s60 offen offset:3072 sc1
L_w1s_194:
L_attend_48:
    s_cmp_eq_u32 s85, 1
    s_cbranch_scc1 L_f1b_196
    v_lshlrev_b32 v15, 9, v13
    v_lshl_add_u32 v15, v12, 3, v15
    s_waitcnt lgkmcnt(0)
    s_cmp_lg_u64 s[32:33], s[28:29]
    s_cbranch_scc1 L_os_198
    s_cmp_lg_u64 s[34:35], s[28:29]
    s_cbranch_scc1 L_os_198
    s_cmp_lg_u64 s[36:37], s[28:29]
    s_cbranch_scc1 L_os_198
    s_cmp_lg_u64 s[38:39], s[28:29]
    s_cbranch_scc1 L_os_198
    s_branch L_oo_199
L_os_198:
L_sp_200:
    s_buffer_load_dwordx8 s[32:39], s[4:7], s82 glc
    s_sub_i32 s66, s66, 4
    s_cmp_lt_i32 s66, 0
    s_waitcnt lgkmcnt(0)
    s_cbranch_scc1 L_spd_201
    s_cmp_lg_u64 s[32:33], s[28:29]
    s_cbranch_scc1 L_sp_200
    s_cmp_lg_u64 s[34:35], s[28:29]
    s_cbranch_scc1 L_sp_200
    s_cmp_lg_u64 s[36:37], s[28:29]
    s_cbranch_scc1 L_sp_200
    s_cmp_lg_u64 s[38:39], s[28:29]
    s_cbranch_scc1 L_sp_200
L_spd_201:
L_oo_199:
L_wr_202:
    s_add_u32 s62, s41, 4096
    buffer_load_dwordx4 v[56:59], v14, s[4:7], s41 offen offset:0 sc1
    buffer_load_dwordx4 v[60:63], v14, s[4:7], s41 offen offset:2048 sc1
    buffer_load_dwordx4 v[64:67], v14, s[4:7], s62 offen offset:0 sc1
    buffer_load_dwordx4 v[68:71], v14, s[4:7], s62 offen offset:2048 sc1
    buffer_load_dwordx2 v[72:73], v15, s[4:7], s42 offen offset:0 sc1
    buffer_load_dwordx2 v[74:75], v15, s[4:7], s42 offen offset:256 sc1
    buffer_load_dwordx4 v[76:79], v14, s[4:7], s41 offen offset:256 sc1
    buffer_load_dwordx4 v[80:83], v14, s[4:7], s41 offen offset:2304 sc1
    buffer_load_dwordx4 v[84:87], v14, s[4:7], s62 offen offset:256 sc1
    buffer_load_dwordx4 v[88:91], v14, s[4:7], s62 offen offset:2304 sc1
    buffer_load_dwordx2 v[92:93], v15, s[4:7], s42 offen offset:128 sc1
    buffer_load_dwordx2 v[94:95], v15, s[4:7], s42 offen offset:384 sc1
    v_add_u32 v15, s43, v1
    s_cmp_eq_u32 s87, 7
    s_cbranch_scc1 L_wi_203
    s_mul_i32 s60, s86, 40960
    s_add_u32 s60, s60, 26771456
    buffer_load_dwordx4 v[96:99], v1, s[4:7], s60 offen offset:0 sc1
    buffer_load_dwordx4 v[100:103], v1, s[4:7], s60 offen offset:1024 sc1
    buffer_load_dwordx4 v[104:107], v1, s[4:7], s60 offen offset:2048 sc1
    buffer_load_dwordx4 v[108:111], v1, s[4:7], s60 offen offset:3072 sc1
    s_add_u32 s60, s60, 4096
    buffer_load_dwordx4 v[112:115], v1, s[4:7], s60 offen offset:0 sc1
    buffer_load_dwordx4 v[116:119], v1, s[4:7], s60 offen offset:1024 sc1
    s_branch L_wj_204
L_wi_203:
    s_add_u32 s62, s71, 0
    buffer_load_dwordx4 v[96:99], v1, s[4:7], s62 offen offset:2048 sc1
    s_add_u32 s62, s72, 0
    buffer_load_dwordx4 v[100:103], v1, s[4:7], s62 offen offset:2048 sc1
    s_add_u32 s62, s71, 0
    buffer_load_dwordx4 v[104:107], v1, s[4:7], s62 offen offset:3072 sc1
    s_add_u32 s62, s72, 0
    buffer_load_dwordx4 v[108:111], v1, s[4:7], s62 offen offset:3072 sc1
    s_add_u32 s62, s71, 4096
    buffer_load_dwordx4 v[112:115], v1, s[4:7], s62 offen offset:0 sc1
    s_add_u32 s62, s72, 4096
    buffer_load_dwordx4 v[116:119], v1, s[4:7], s62 offen offset:0 sc1
L_wj_204:
L_gs_205:
    ds_read_b32 v9, v11
    s_sub_i32 s66, s66, 1
    s_cmp_lt_i32 s66, 0
    s_waitcnt lgkmcnt(0)
    s_cbranch_scc1 L_gsd_206
    v_cmp_gt_u32 vcc, 25, v9
    s_nop 0
    s_and_b32 vcc_lo, vcc_lo, 0x0f
    s_cbranch_scc1 L_gs_205
L_gsd_206:
L_gs_207:
    ds_read_b32 v9, v11
    s_sub_i32 s66, s66, 1
    s_cmp_lt_i32 s66, 0
    s_waitcnt lgkmcnt(0)
    s_cbranch_scc1 L_gsd_208
    v_cmp_gt_u32 vcc, 20, v9
    s_nop 0
    s_and_b32 vcc_lo, vcc_lo, 0xf0
    s_cbranch_scc1 L_gs_207
L_gsd_208:
    s_waitcnt vmcnt(17)
    v_mfma_f32_16x16x32_bf16 v[16:19], v[156:159], v[56:59], 0
    v_mfma_f32_16x16x32_bf16 v[20:23], v[176:179], v[56:59], 0
    v_mfma_f32_16x16x32_bf16 v[24:27], v[196:199], v[56:59], 0
    v_mfma_f32_16x16x32_bf16 v[28:31], v[216:219], v[56:59], 0
    v_mfma_f32_16x16x32_bf16 v[32:35], v[236:239], v[56:59], 0
    s_waitcnt vmcnt(16)
    v_mfma_f32_16x16x32_bf16 v[16:19], v[160:163], v[60:63], v[16:19]
    v_mfma_f32_16x16x32_bf16 v[20:23], v[180:183], v[60:63], v[20:23]
    v_mfma_f32_16x16x32_bf16 v[24:27], v[200:203], v[60:63], v[24:27]
    v_mfma_f32_16x16x32_bf16 v[28:31], v[220:223], v[60:63], v[28:31]
    v_mfma_f32_16x16x32_bf16 v[32:35], v[240:243], v[60:63], v[32:35]
    s_waitcnt vmcnt(15)
    v_mfma_f32_16x16x32_bf16 v[16:19], v[164:167], v[64:67], v[16:19]
    s_lshl_b32 s60, s45, 1
    v_mfma_f32_16x16x32_bf16 v[20:23], v[184:187], v[64:67], v[20:23]
    s_add_u32 s60, s60, 158720
    v_mfma_f32_16x16x32_bf16 v[24:27], v[204:207], v[64:67], v[24:27]
    v_lshl_add_u32 v56, v13, 5, s60
    v_mfma_f32_16x16x32_bf16 v[28:31], v[224:227], v[64:67], v[28:31]
    v_lshlrev_b32 v57, 4, v13
    v_mfma_f32_16x16x32_bf16 v[32:35], v[244:247], v[64:67], v[32:35]
    v_add_u32 v57, 158976, v57
    s_waitcnt vmcnt(14)
    v_mfma_f32_16x16x32_bf16 v[16:19], v[168:171], v[68:71], v[16:19]
    v_mfma_f32_16x16x32_bf16 v[20:23], v[188:191], v[68:71], v[20:23]
    v_mfma_f32_16x16x32_bf16 v[24:27], v[208:211], v[68:71], v[24:27]
    v_mfma_f32_16x16x32_bf16 v[28:31], v[228:231], v[68:71], v[28:31]
    v_mfma_f32_16x16x32_bf16 v[32:35], v[248:251], v[68:71], v[32:35]
    s_waitcnt vmcnt(12)
    v_mfma_f32_16x16x32_bf16 v[16:19], v[172:175], v[72:75], v[16:19]
    v_mfma_f32_16x16x32_bf16 v[20:23], v[192:195], v[72:75], v[20:23]
    v_mfma_f32_16x16x32_bf16 v[24:27], v[212:215], v[72:75], v[24:27]
    v_mfma_f32_16x16x32_bf16 v[28:31], v[232:235], v[72:75], v[28:31]
    v_mfma_f32_16x16x32_bf16 v[32:35], v[252:255], v[72:75], v[32:35]
    s_waitcnt vmcnt(11)
    v_mfma_f32_16x16x32_bf16 v[36:39], v[156:159], v[76:79], 0
    v_lshlrev_b32 v64, 16, v2
    v_mfma_f32_16x16x32_bf16 v[40:43], v[176:179], v[76:79], 0
    v_and_b32 v65, 0xffff0000, v2
    v_mfma_f32_16x16x32_bf16 v[44:47], v[196:199], v[76:79], 0
    v_lshlrev_b32 v66, 16, v3
    v_mfma_f32_16x16x32_bf16 v[48:51], v[216:219], v[76:79], 0
    ds_write_b128 v15, v[16:19] offset:0
    v_and_b32 v67, 0xffff0000, v3
    v_mfma_f32_16x16x32_bf16 v[52:55], v[236:239], v[76:79], 0
    s_waitcnt vmcnt(10)
    v_mfma_f32_16x16x32_bf16 v[36:39], v[160:163], v[80:83], v[36:39]
    v_lshlrev_b32 v68, 16, v4
    v_mfma_f32_16x16x32_bf16 v[40:43], v[180:183], v[80:83], v[40:43]
    v_and_b32 v69, 0xffff0000, v4
    v_mfma_f32_16x16x32_bf16 v[44:47], v[200:203], v[80:83], v[44:47]
    v_lshlrev_b32 v70, 16, v5
    v_mfma_f32_16x16x32_bf16 v[48:51], v[220:223], v[80:83], v[48:51]
    ds_write_b128 v15, v[20:23] offset:1024
    v_and_b32 v71, 0xffff0000, v5
    v_mfma_f32_16x16x32_bf16 v[52:55], v[240:243], v[80:83], v[52:55]
    s_waitcnt vmcnt(9)
    v_mfma_f32_16x16x32_bf16 v[36:39], v[164:167], v[84:87], v[36:39]
    v_lshlrev_b32 v72, 16, v6
    v_mfma_f32_16x16x32_bf16 v[40:43], v[184:187], v[84:87], v[40:43]
    v_and_b32 v73, 0xffff0000, v6
    v_mfma_f32_16x16x32_bf16 v[44:47], v[204:207], v[84:87], v[44:47]
    v_lshlrev_b32 v74, 16, v7
    v_mfma_f32_16x16x32_bf16 v[48:51], v[224:227], v[84:87], v[48:51]
    ds_write_b128 v15, v[24:27] offset:7168
    v_and_b32 v75, 0xffff0000, v7
    v_mfma_f32_16x16x32_bf16 v[52:55], v[244:247], v[84:87], v[52:55]
    s_waitcnt vmcnt(8)
    v_mfma_f32_16x16x32_bf16 v[36:39], v[168:171], v[88:91], v[36:39]
    v_mfma_f32_16x16x32_bf16 v[40:43], v[188:191], v[88:91], v[40:43]
    v_mfma_f32_16x16x32_bf16 v[44:47], v[208:211], v[88:91], v[44:47]
    v_mfma_f32_16x16x32_bf16 v[48:51], v[228:231], v[88:91], v[48:51]
    ds_write_b128 v15, v[28:31] offset:8192
    v_mfma_f32_16x16x32_bf16 v[52:55], v[248:251], v[88:91], v[52:55]
    s_waitcnt vmcnt(6)
    v_mfma_f32_16x16x32_bf16 v[36:39], v[172:175], v[92:95], v[36:39]
    v_mfma_f32_16x16x32_bf16 v[40:43], v[192:195], v[92:95], v[40:43]
    v_mfma_f32_16x16x32_bf16 v[44:47], v[212:215], v[92:95], v[44:47]
    v_mfma_f32_16x16x32_bf16 v[48:51], v[232:235], v[92:95], v[48:51]
    ds_write_b128 v15, v[32:35] offset:4096
    v_mfma_f32_16x16x32_bf16 v[52:55], v[252:255], v[92:95], v[52:55]
    s_nop 2
    ds_write_b128 v15, v[36:39] offset:2048
    ds_write_b128 v15, v[40:43] offset:3072
    ds_write_b128 v15, v[44:47] offset:5120
    ds_write_b128 v15, v[48:51] offset:6144
    s_nop 0
    ds_write_b128 v15, v[52:55] offset:9216
    v_mov_b32 v8, 27
    ds_write_b32 v10, v8
    ds_read_b128 v[76:79], v56 offset:0
    ds_read_b128 v[80:83], v56 offset:16
    ds_read_b128 v[84:87], v57 offset:0
    v_mov_b32 v88, v56
    v_mov_b32 v89, v57
    v_add_u32 v90, s46, v1
    v_add_u32 v91, s47, v1
    v_lshrrev_b32 v92, 1, v14
    v_lshlrev_b32 v93, 3, v12
    v_lshl_add_u32 v93, v13, 2, v93
L_gs_209:
    ds_read_b32 v9, v11
    s_sub_i32 s66, s66, 1
    s_cmp_lt_i32 s66, 0
    s_waitcnt lgkmcnt(0)
    s_cbranch_scc1 L_gsd_210
    v_cmp_gt_u32 vcc, 27, v9
    s_nop 0
    s_and_b32 vcc_lo, vcc_lo, 0x0f
    s_cbranch_scc1 L_gs_209
L_gsd_210:
    ds_read_b128 v[16:19], v90 offset:0
    ds_read_b128 v[20:23], v90 offset:1024
    ds_read_b128 v[24:27], v91 offset:0
    ds_read_b128 v[28:31], v90 offset:10240
    ds_read_b128 v[32:35], v90 offset:11264
    ds_read_b128 v[36:39], v91 offset:10240
    ds_read_b128 v[40:43], v90 offset:20480
    ds_read_b128 v[44:47], v90 offset:21504
    ds_read_b128 v[48:51], v91 offset:20480
    ds_read_b128 v[52:55], v90 offset:30720
    ds_read_b128 v[56:59], v90 offset:31744
    ds_read_b128 v[60:63], v91 offset:30720
    s_waitcnt lgkmcnt(6)
    v_add_f32 v16, v16, v28
    v_add_f32 v17, v17, v29
    v_add_f32 v18, v18, v30
    v_add_f32 v19, v19, v31
    v_add_f32 v20, v20, v32
    v_add_f32 v21, v21, v33
    v_add_f32 v22, v22, v34
    v_add_f32 v23, v23, v35
    v_add_f32 v24, v24, v36
    v_add_f32 v25, v25, v37
    v_add_f32 v26, v26, v38
    v_add_f32 v27, v27, v39
    ds_read_b128 v[28:31], v88 offset:320
    ds_read_b128 v[32:35], v88 offset:336
    ds_read_b128 v[36:39], v89 offset:320
    s_waitcnt lgkmcnt(3)
    v_add_f32 v40, v40, v52
    v_add_f32 v41, v41, v53
    v_add_f32 v42, v42, v54
    v_add_f32 v43, v43, v55
    v_add_f32 v44, v44, v56
    v_add_f32 v45, v45, v57
    v_add_f32 v46, v46, v58
    v_add_f32 v47, v47, v59
    v_add_f32 v48, v48, v60
    v_add_f32 v49, v49, v61
    v_add_f32 v50, v50, v62
    v_add_f32 v51, v51, v63
    v_add_f32 v16, v16, v40
    v_add_f32 v17, v17, v41
    v_add_f32 v18, v18, v42
    v_add_f32 v19, v19, v43
    v_add_f32 v20, v20, v44
    v_add_f32 v21, v21, v45
    v_add_f32 v22, v22, v46
    v_add_f32 v23, v23, v47
    v_add_f32 v24, v24, v48
    v_add_f32 v25, v25, v49
    v_add_f32 v26, v26, v50
    v_add_f32 v27, v27, v51
    v_fma_f32 v16, v16, v76, v64
    v_fma_f32 v17, v17, v77, v65
    v_fma_f32 v18, v18, v78, v66
    v_fma_f32 v19, v19, v79, v67
    v_fma_f32 v20, v20, v80, v68
    v_fma_f32 v21, v21, v81, v69
    v_fma_f32 v22, v22, v82, v70
    v_fma_f32 v23, v23, v83, v71
    v_fma_f32 v24, v24, v84, v72
    v_fma_f32 v25, v25, v85, v73
    v_fma_f32 v26, v26, v86, v74
    v_fma_f32 v27, v27, v87, v75
    s_waitcnt lgkmcnt(0)
    v_mul_f32 v28, v28, v16
    v_mul_f32 v29, v29, v17
    v_mul_f32 v30, v30, v18
    v_mul_f32 v31, v31, v19
    v_mul_f32 v32, v32, v20
    v_mul_f32 v33, v33, v21
    v_mul_f32 v34, v34, v22
    v_mul_f32 v35, v35, v23
    v_mul_f32 v36, v36, v24
    v_mul_f32 v37, v37, v25
    v_mul_f32 v38, v38, v26
    v_mul_f32 v39, v39, v27
    v_cvt_pk_bf16_f32 v40, v28, v29
    v_cvt_pk_bf16_f32 v41, v30, v31
    v_cvt_pk_bf16_f32 v42, v32, v33
    v_cvt_pk_bf16_f32 v43, v34, v35
    v_cvt_pk_bf16_f32 v44, v36, v37
    v_cvt_pk_bf16_f32 v45, v38, v39
    buffer_store_dwordx4 v[40:43], v14, s[4:7], s48 offen sc1
    v_add_f32 v46, v16, v17
    v_mul_f32 v47, v16, v16
    v_fmac_f32 v47, v17, v17
    v_add_f32 v46, v46, v18
    v_fmac_f32 v47, v18, v18
    v_add_f32 v46, v46, v19
    v_fmac_f32 v47, v19, v19
    v_add_f32 v46, v46, v20
    v_fmac_f32 v47, v20, v20
    v_add_f32 v46, v46, v21
    v_fmac_f32 v47, v21, v21
    v_add_f32 v46, v46, v22
    v_fmac_f32 v47, v22, v22
    v_add_f32 v46, v46, v23
    v_fmac_f32 v47, v23, v23
    s_cmp_ge_u32 s84, 2
    s_cbranch_scc1 L_noex_211
    buffer_store_dwordx2 v[44:45], v92, s[4:7], s49 offen sc1
    v_add_f32 v46, v46, v24
    v_fmac_f32 v47, v24, v24
    v_add_f32 v46, v46, v25
    v_fmac_f32 v47, v25, v25
    v_add_f32 v46, v46, v26
    v_fmac_f32 v47, v26, v26
    v_add_f32 v46, v46, v27
    v_fmac_f32 v47, v27, v27
L_noex_211:
    v_cvt_pk_bf16_f32 v2, v16, v17
    v_cvt_pk_bf16_f32 v3, v18, v19
    v_permlane16_swap_b32 v46, v47
    v_add_f32 v46, v46, v47
    v_mov_b32 v47, v46
    v_cvt_pk_bf16_f32 v4, v20, v21
    v_cvt_pk_bf16_f32 v5, v22, v23
    v_permlane32_swap_b32 v46, v47
    v_add_f32 v46, v46, v47
    s_mov_b32 exec_hi, 0
    buffer_store_dword v46, v93, s[4:7], s50 offen sc1
    s_mov_b64 exec, -1
    v_cvt_pk_bf16_f32 v6, v24, v25
    v_cvt_pk_bf16_f32 v7, v26, v27
L_gs_212:
    ds_read_b32 v9, v11
    s_sub_i32 s66, s66, 1
    s_cmp_lt_i32 s66, 0
    s_waitcnt lgkmcnt(0)
    s_cbranch_scc1 L_gsd_213
    v_cmp_gt_u32 vcc, 24, v9
    s_nop 0
    s_and_b32 vcc_lo, vcc_lo, 0xf0
    s_cbranch_scc1 L_gs_212
L_gsd_213:
    s_mul_i32 s60, s84, 1536
    s_add_u32 s60, s60, 108032
    v_add_u32 v56, s60, v1
    v_lshl_add_u32 v57, v0, 3, s60
    ds_write_b128 v56, v[2:5]
    ds_write_b64 v57, v[6:7] offset:1024
    s_add_u32 s43, s43, 47616
    s_add_u32 s46, s46, 47616
    s_add_u32 s47, s47, 47616
    s_add_u32 s41, s41, 40960
    s_add_u32 s42, s42, 40960
    s_add_u32 s48, s48, 40960
    s_add_u32 s49, s49, 40960
    s_add_u32 s50, s50, 4096
    v_mul_u32_u24 v59, 1280, v12
    v_lshl_add_u32 v58, v13, 4, v59
    v_lshl_add_u32 v59, v13, 3, v59
    v_add_u32 v58, s45, v58
    s_waitcnt lgkmcnt(0)
    buffer_load_dwordx4 v[2:5], v58, s[8:11], s44 offen
    buffer_load_dwordx2 v[6:7], v59, s[8:11], s44 offen offset:128
    s_add_u32 s82, s82, 131072
    s_buffer_load_dwordx8 s[32:39], s[4:7], s82 glc
    s_setprio 3
    s_lshl_b32 s65, s56, 3
    s_lshl_b32 s63, s84, 8
    s_add_u32 s65, s65, s63
    s_lshl_b32 s60, s65, 7
    s_lshl_b32 s61, s57, 2
    s_add_u32 s60, s60, s61
    s_add_u32 s60, s60, 786432
    v_lshlrev_b32 v8, 7, v0
    v_mov_b32 v9, s30
    s_mov_b32 exec_lo, 255
    s_mov_b32 exec_hi, 0
    s_waitcnt vmcnt(2)
    buffer_store_dword v9, v8, s[4:7], s60 offen sc1
    s_mov_b64 exec, -1
    v_mov_b32 v8, 28
    ds_write_b32 v10, v8
    v_lshlrev_b32 v15, 9, v13
    v_lshl_add_u32 v15, v12, 3, v15
    s_waitcnt lgkmcnt(0)
    s_cmp_lg_u64 s[32:33], s[28:29]
    s_cbranch_scc1 L_os_214
    s_cmp_lg_u64 s[34:35], s[28:29]
    s_cbranch_scc1 L_os_214
    s_cmp_lg_u64 s[36:37], s[28:29]
    s_cbranch_scc1 L_os_214
    s_cmp_lg_u64 s[38:39], s[28:29]
    s_cbranch_scc1 L_os_214
    s_branch L_oo_215
L_os_214:
L_gs_216:
    ds_read_b32 v9, v11
    s_sub_i32 s66, s66, 1
    s_cmp_lt_i32 s66, 0
    s_waitcnt lgkmcnt(0)
    s_cbranch_scc1 L_gsd_217
    v_cmp_gt_u32 vcc, 26, v9
    s_nop 0
    s_and_b32 vcc_lo, vcc_lo, 0xf0
    s_cbranch_scc1 L_gs_216
L_gsd_217:
L_sp_218:
    s_buffer_load_dwordx8 s[32:39], s[4:7], s82 glc
    s_sub_i32 s66, s66, 4
    s_cmp_lt_i32 s66, 0
    s_waitcnt lgkmcnt(0)
    s_cbranch_scc1 L_spd_219
    s_cmp_lg_u64 s[32:33], s[28:29]
    s_cbranch_scc1 L_sp_218
    s_cmp_lg_u64 s[34:35], s[28:29]
    s_cbranch_scc1 L_sp_218
    s_cmp_lg_u64 s[36:37], s[28:29]
    s_cbranch_scc1 L_sp_218
    s_cmp_lg_u64 s[38:39], s[28:29]
    s_cbranch_scc1 L_sp_218
L_spd_219:
L_oo_215:
L_wr_220:
    s_add_u32 s62, s41, 4096
    buffer_load_dwordx4 v[56:59], v14, s[4:7], s41 offen offset:0 sc1
    buffer_load_dwordx4 v[60:63], v14, s[4:7], s41 offen offset:2048 sc1
    buffer_load_dwordx4 v[64:67], v14, s[4:7], s62 offen offset:0 sc1
    buffer_load_dwordx4 v[68:71], v14, s[4:7], s62 offen offset:2048 sc1
    buffer_load_dwordx2 v[72:73], v15, s[4:7], s42 offen offset:0 sc1
    buffer_load_dwordx2 v[74:75], v15, s[4:7], s42 offen offset:256 sc1
    buffer_load_dwordx4 v[76:79], v14, s[4:7], s41 offen offset:256 sc1
    buffer_load_dwordx4 v[80:83], v14, s[4:7], s41 offen offset:2304 sc1
    buffer_load_dwordx4 v[84:87], v14, s[4:7], s62 offen offset:256 sc1
    buffer_load_dwordx4 v[88:91], v14, s[4:7], s62 offen offset:2304 sc1
    buffer_load_dwordx2 v[92:93], v15, s[4:7], s42 offen offset:128 sc1
    buffer_load_dwordx2 v[94:95], v15, s[4:7], s42 offen offset:384 sc1
    v_add_u32 v15, s43, v1
L_gs_221:
    ds_read_b32 v9, v11
    s_sub_i32 s66, s66, 1
    s_cmp_lt_i32 s66, 0
    s_waitcnt lgkmcnt(0)
    s_cbranch_scc1 L_gsd_222
    v_cmp_gt_u32 vcc, 25, v9
    s_nop 0
    s_and_b32 vcc_lo, vcc_lo, 0xf0
    s_cbranch_scc1 L_gs_221
L_gsd_222:
    s_waitcnt vmcnt(11)
    v_mfma_f32_16x16x32_bf16 v[16:19], v[156:159], v[56:59], 0
    v_mfma_f32_16x16x32_bf16 v[20:23], v[176:179], v[56:59], 0
    v_mfma_f32_16x16x32_bf16 v[24:27], v[196:199], v[56:59], 0
    v_mfma_f32_16x16x32_bf16 v[28:31], v[216:219], v[56:59], 0
    v_mfma_f32_16x16x32_bf16 v[32:35], v[236:239], v[56:59], 0
    s_waitcnt vmcnt(10)
    v_mfma_f32_16x16x32_bf16 v[16:19], v[160:163], v[60:63], v[16:19]
    v_mfma_f32_16x16x32_bf16 v[20:23], v[180:183], v[60:63], v[20:23]
    v_mfma_f32_16x16x32_bf16 v[24:27], v[200:203], v[60:63], v[24:27]
    v_mfma_f32_16x16x32_bf16 v[28:31], v[220:223], v[60:63], v[28:31]
    v_mfma_f32_16x16x32_bf16 v[32:35], v[240:243], v[60:63], v[32:35]
    s_waitcnt vmcnt(9)
    v_mfma_f32_16x16x32_bf16 v[16:19], v[164:167], v[64:67], v[16:19]
    s_lshl_b32 s60, s45, 1
    v_mfma_f32_16x16x32_bf16 v[20:23], v[184:187], v[64:67], v[20:23]
    s_add_u32 s60, s60, 158720
    v_mfma_f32_16x16x32_bf16 v[24:27], v[204:207], v[64:67], v[24:27]
    v_lshl_add_u32 v56, v13, 5, s60
    v_mfma_f32_16x16x32_bf16 v[28:31], v[224:227], v[64:67], v[28:31]
    v_lshlrev_b32 v57, 4, v13
    v_mfma_f32_16x16x32_bf16 v[32:35], v[244:247], v[64:67], v[32:35]
    v_add_u32 v57, 158976, v57
    s_waitcnt vmcnt(8)
    v_mfma_f32_16x16x32_bf16 v[16:19], v[168:171], v[68:71], v[16:19]
    v_mfma_f32_16x16x32_bf16 v[20:23], v[188:191], v[68:71], v[20:23]
    v_mfma_f32_16x16x32_bf16 v[24:27], v[208:211], v[68:71], v[24:27]
    v_mfma_f32_16x16x32_bf16 v[28:31], v[228:231], v[68:71], v[28:31]
    v_mfma_f32_16x16x32_bf16 v[32:35], v[248:251], v[68:71], v[32:35]
    s_waitcnt vmcnt(6)
    v_mfma_f32_16x16x32_bf16 v[16:19], v[172:175], v[72:75], v[16:19]
    v_mfma_f32_16x16x32_bf16 v[20:23], v[192:195], v[72:75], v[20:23]
    v_mfma_f32_16x16x32_bf16 v[24:27], v[212:215], v[72:75], v[24:27]
    v_mfma_f32_16x16x32_bf16 v[28:31], v[232:235], v[72:75], v[28:31]
    v_mfma_f32_16x16x32_bf16 v[32:35], v[252:255], v[72:75], v[32:35]
    s_waitcnt vmcnt(5)
    v_mfma_f32_16x16x32_bf16 v[36:39], v[156:159], v[76:79], 0
    v_lshlrev_b32 v64, 16, v2
    v_mfma_f32_16x16x32_bf16 v[40:43], v[176:179], v[76:79], 0
    v_and_b32 v65, 0xffff0000, v2
    v_mfma_f32_16x16x32_bf16 v[44:47], v[196:199], v[76:79], 0
    v_lshlrev_b32 v66, 16, v3
    v_mfma_f32_16x16x32_bf16 v[48:51], v[216:219], v[76:79], 0
    ds_write_b128 v15, v[16:19] offset:0
    v_and_b32 v67, 0xffff0000, v3
    v_mfma_f32_16x16x32_bf16 v[52:55], v[236:239], v[76:79], 0
    s_waitcnt vmcnt(4)
    v_mfma_f32_16x16x32_bf16 v[36:39], v[160:163], v[80:83], v[36:39]
    v_lshlrev_b32 v68, 16, v4
    v_mfma_f32_16x16x32_bf16 v[40:43], v[180:183], v[80:83], v[40:43]
    v_and_b32 v69, 0xffff0000, v4
    v_mfma_f32_16x16x32_bf16 v[44:47], v[200:203], v[80:83], v[44:47]
    v_lshlrev_b32 v70, 16, v5
    v_mfma_f32_16x16x32_bf16 v[48:51], v[220:223], v[80:83], v[48:51]
    ds_write_b128 v15, v[20:23] offset:1024
    v_and_b32 v71, 0xffff0000, v5
    v_mfma_f32_16x16x32_bf16 v[52:55], v[240:243], v[80:83], v[52:55]
    s_waitcnt vmcnt(3)
    v_mfma_f32_16x16x32_bf16 v[36:39], v[164:167], v[84:87], v[36:39]
    v_lshlrev_b32 v72, 16, v6
    v_mfma_f32_16x16x32_bf16 v[40:43], v[184:187], v[84:87], v[40:43]
    v_and_b32 v73, 0xffff0000, v6
    v_mfma_f32_16x16x32_bf16 v[44:47], v[204:207], v[84:87], v[44:47]
    v_lshlrev_b32 v74, 16, v7
    v_mfma_f32_16x16x32_bf16 v[48:51], v[224:227], v[84:87], v[48:51]
    ds_write_b128 v15, v[24:27] offset:7168
    v_and_b32 v75, 0xffff0000, v7
    v_mfma_f32_16x16x32_bf16 v[52:55], v[244:247], v[84:87], v[52:55]
    s_waitcnt vmcnt(2)
    v_mfma_f32_16x16x32_bf16 v[36:39], v[168:171], v[88:91], v[36:39]
    v_mfma_f32_16x16x32_bf16 v[40:43], v[188:191], v[88:91], v[40:43]
    v_mfma_f32_16x16x32_bf16 v[44:47], v[208:211], v[88:91], v[44:47]
    v_mfma_f32_16x16x32_bf16 v[48:51], v[228:231], v[88:91], v[48:51]
    ds_write_b128 v15, v[28:31] offset:8192
    v_mfma_f32_16x16x32_bf16 v[52:55], v[248:251], v[88:91], v[52:55]
    s_waitcnt vmcnt(0)
    v_mfma_f32_16x16x32_bf16 v[36:39], v[172:175], v[92:95], v[36:39]
    v_mfma_f32_16x16x32_bf16 v[40:43], v[192:195], v[92:95], v[40:43]
    v_mfma_f32_16x16x32_bf16 v[44:47], v[212:215], v[92:95], v[44:47]
    v_mfma_f32_16x16x32_bf16 v[48:51], v[232:235], v[92:95], v[48:51]
    ds_write_b128 v15, v[32:35] offset:4096
    v_mfma_f32_16x16x32_bf16 v[52:55], v[252:255], v[92:95], v[52:55]
    s_nop 2
    ds_write_b128 v15, v[36:39] offset:2048
    ds_write_b128 v15, v[40:43] offset:3072
    ds_write_b128 v15, v[44:47] offset:5120
    ds_write_b128 v15, v[48:51] offset:6144
    s_nop 0
    ds_write_b128 v15, v[52:55] offset:9216
    v_mov_b32 v8, 29
    ds_write_b32 v10, v8
    ds_read_b128 v[76:79], v56 offset:0
    ds_read_b128 v[80:83], v56 offset:16
    ds_read_b128 v[84:87], v57 offset:0
    v_mov_b32 v88, v56
    v_mov_b32 v89, v57
    v_add_u32 v90, s46, v1
    v_add_u32 v91, s47, v1
    v_lshrrev_b32 v92, 1, v14
    v_lshlrev_b32 v93, 3, v12
    v_lshl_add_u32 v93, v13, 2, v93
L_gs_223:
    ds_read_b32 v9, v11
    s_sub_i32 s66, s66, 1
    s_cmp_lt_i32 s66, 0
    s_waitcnt lgkmcnt(0)
    s_cbranch_scc1 L_gsd_224
    v_cmp_gt_u32 vcc, 29, v9
    s_nop 0
    s_and_b32 vcc_lo, vcc_lo, 0x0f
    s_cbranch_scc1 L_gs_223
L_gsd_224:
    ds_read_b128 v[16:19], v90 offset:0
    ds_read_b128 v[20:23], v90 offset:1024
    ds_read_b128 v[24:27], v91 offset:0
    ds_read_b128 v[28:31], v90 offset:10240
    ds_read_b128 v[32:35], v90 offset:11264
    ds_read_b128 v[36:39], v91 offset:10240
    ds_read_b128 v[40:43], v90 offset:20480
    ds_read_b128 v[44:47], v90 offset:21504
    ds_read_b128 v[48:51], v91 offset:20480
    ds_read_b128 v[52:55], v90 offset:30720
    ds_read_b128 v[56:59], v90 offset:31744
    ds_read_b128 v[60:63], v91 offset:30720
    s_waitcnt lgkmcnt(6)
    v_add_f32 v16, v16, v28
    v_add_f32 v17, v17, v29
    v_add_f32 v18, v18, v30
    v_add_f32 v19, v19, v31
    v_add_f32 v20, v20, v32
    v_add_f32 v21, v21, v33
    v_add_f32 v22, v22, v34
    v_add_f32 v23, v23, v35
    v_add_f32 v24, v24, v36
    v_add_f32 v25, v25, v37
    v_add_f32 v26, v26, v38
    v_add_f32 v27, v27, v39
    ds_read_b128 v[28:31], v88 offset:320
    ds_read_b128 v[32:35], v88 offset:336
    ds_read_b128 v[36:39], v89 offset:320
    s_waitcnt lgkmcnt(3)
    v_add_f32 v40, v40, v52
    v_add_f32 v41, v41, v53
    v_add_f32 v42, v42, v54
    v_add_f32 v43, v43, v55
    v_add_f32 v44, v44, v56
    v_add_f32 v45, v45, v57
    v_add_f32 v46, v46, v58
    v_add_f32 v47, v47, v59
    v_add_f32 v48, v48, v60
    v_add_f32 v49, v49, v61
    v_add_f32 v50, v50, v62
    v_add_f32 v51, v51, v63
    v_add_f32 v16, v16, v40
    v_add_f32 v17, v17, v41
    v_add_f32 v18, v18, v42
    v_add_f32 v19, v19, v43
    v_add_f32 v20, v20, v44
    v_add_f32 v21, v21, v45
    v_add_f32 v22, v22, v46
    v_add_f32 v23, v23, v47
    v_add_f32 v24, v24, v48
    v_add_f32 v25, v25, v49
    v_add_f32 v26, v26, v50
    v_add_f32 v27, v27, v51
    v_fma_f32 v16, v16, v76, v64
    v_fma_f32 v17, v17, v77, v65
    v_fma_f32 v18, v18, v78, v66
    v_fma_f32 v19, v19, v79, v67
    v_fma_f32 v20, v20, v80, v68
    v_fma_f32 v21, v21, v81, v69
    v_fma_f32 v22, v22, v82, v70
    v_fma_f32 v23, v23, v83, v71
    v_fma_f32 v24, v24, v84, v72
    v_fma_f32 v25, v25, v85, v73
    v_fma_f32 v26, v26, v86, v74
    v_fma_f32 v27, v27, v87, v75
    s_waitcnt lgkmcnt(0)
    v_mul_f32 v28, v28, v16
    v_mul_f32 v29, v29, v17
    v_mul_f32 v30, v30, v18
    v_mul_f32 v31, v31, v19
    v_mul_f32 v32, v32, v20
    v_mul_f32 v33, v33, v21
    v_mul_f32 v34, v34, v22
    v_mul_f32 v35, v35, v23
    v_mul_f32 v36, v36, v24
    v_mul_f32 v37, v37, v25
    v_mul_f32 v38, v38, v26
    v_mul_f32 v39, v39, v27
    v_mov_b32 v8, 30
    ds_write_b32 v10, v8
    v_cvt_pk_bf16_f32 v40, v28, v29
    v_cvt_pk_bf16_f32 v41, v30, v31
    v_cvt_pk_bf16_f32 v42, v32, v33
    v_cvt_pk_bf16_f32 v43, v34, v35
    v_cvt_pk_bf16_f32 v44, v36, v37
    v_cvt_pk_bf16_f32 v45, v38, v39
    buffer_store_dwordx4 v[40:43], v14, s[4:7], s48 offen sc1
    v_add_f32 v46, v16, v17
    v_mul_f32 v47, v16, v16
    v_fmac_f32 v47, v17, v17
    v_add_f32 v46, v46, v18
    v_fmac_f32 v47, v18, v18
    v_add_f32 v46, v46, v19
    v_fmac_f32 v47, v19, v19
    v_add_f32 v46, v46, v20
    v_fmac_f32 v47, v20, v20
    v_add_f32 v46, v46, v21
    v_fmac_f32 v47, v21, v21
    v_add_f32 v46, v46, v22
    v_fmac_f32 v47, v22, v22
    v_add_f32 v46, v46, v23
    v_fmac_f32 v47, v23, v23
    s_cmp_ge_u32 s84, 2
    s_cbranch_scc1 L_noex_225
    buffer_store_dwordx2 v[44:45], v92, s[4:7], s49 offen sc1
    v_add_f32 v46, v46, v24
    v_fmac_f32 v47, v24, v24
    v_add_f32 v46, v46, v25
    v_fmac_f32 v47, v25, v25
    v_add_f32 v46, v46, v26
    v_fmac_f32 v47, v26, v26
    v_add_f32 v46, v46, v27
    v_fmac_f32 v47, v27, v27
L_noex_225:
    v_cvt_pk_bf16_f32 v2, v16, v17
    v_cvt_pk_bf16_f32 v3, v18, v19
    v_permlane16_swap_b32 v46, v47
    v_add_f32 v46, v46, v47
    v_mov_b32 v47, v46
    v_cvt_pk_bf16_f32 v4, v20, v21
    v_cvt_pk_bf16_f32 v5, v22, v23
    v_permlane32_swap_b32 v46, v47
    v_add_f32 v46, v46, v47
    s_mov_b32 exec_hi, 0
    buffer_store_dword v46, v93, s[4:7], s50 offen sc1
    s_mov_b64 exec, -1
    v_cvt_pk_bf16_f32 v6, v24, v25
    v_cvt_pk_bf16_f32 v7, v26, v27
    s_cmp_eq_u32 s87, 7
    s_cbranch_scc1 L_f1idle_195
    s_mul_i32 s68, s86, 40960
    s_add_u32 s68, s68, 26808320
    s_mul_i32 s60, s87, 21504
    v_add_u32 v8, s60, v1
    s_lshr_b32 s60, s56, 1
    s_mul_i32 s60, s60, 54
    s_add_u32 s60, s60, s86
    s_lshl_b32 s60, s60, 8
    s_add_u32 s69, s60, 1572864
    v_and_b32 v56, 3, v12
    v_lshlrev_b32 v56, 6, v56
    v_lshl_add_u32 v56, v13, 4, v56
    buffer_load_dwordx4 v[52:55], v56, s[4:7], s69 offen sc1
    buffer_load_dwordx4 v[240:243], v1, s[4:7], s68 offen offset:0 sc1
    buffer_load_dwordx4 v[244:247], v1, s[4:7], s68 offen offset:1024 sc1
    buffer_load_dwordx4 v[248:251], v1, s[4:7], s68 offen offset:2048 sc1
    buffer_load_dwordx4 v[252:255], v1, s[4:7], s68 offen offset:3072 sc1
    ds_read_b128 v[156:159], v8 offset:0
    ds_read_b128 v[160:163], v8 offset:1024
    ds_read_b128 v[164:167], v8 offset:2048
    ds_read_b128 v[168:171], v8 offset:3072
    ds_read_b128 v[172:175], v8 offset:4096
    ds_read_b128 v[176:179], v8 offset:5120
    ds_read_b128 v[180:183], v8 offset:6144
    ds_read_b128 v[184:187], v8 offset:7168
    ds_read_b128 v[188:191], v8 offset:8192
    ds_read_b128 v[192:195], v8 offset:9216
    ds_read_b128 v[196:199], v8 offset:10240
    ds_read_b128 v[200:203], v8 offset:11264
    ds_read_b128 v[204:207], v8 offset:12288
    ds_read_b128 v[208:211], v8 offset:13312
    ds_read_b128 v[212:215], v8 offset:14336
    ds_read_b128 v[216:219], v8 offset:15360
    ds_read_b128 v[220:223], v8 offset:16384
    ds_read_b128 v[224:227], v8 offset:17408
    ds_read_b128 v[228:231], v8 offset:18432
    ds_read_b128 v[232:235], v8 offset:19456
    ds_read_b128 v[236:239], v8 offset:20480
    v_lshlrev_b32 v8, 9, v13
    v_lshl_add_u32 v14, v12, 4, v8
    v_add_u32 v14, 67072, v14
    v_lshl_add_u32 v15, v12, 3, v8
    v_add_u32 v15, 99840, v15
    v_lshlrev_b32 v13, 4, v12
    v_add_u32 v13, 157632, v13
    s_mul_i32 s63, s56, 221184
    s_lshl_b32 s61, s86, 11
    s_add_u32 s63, s63, s61
    s_add_u32 s63, s63, 18759680
    s_add_u32 s64, s63, 110592
    s_mul_i32 s60, s84, 14336
    v_add_u32 v12, s60, v1
    s_lshl_b32 s65, s56, 3
    s_lshl_b32 s62, s84, 8
    s_add_u32 s62, s62, s65
    s_lshl_b32 s60, s62, 7
    s_lshl_b32 s61, s57, 2
    s_add_u32 s60, s60, s61
    s_add_u32 s60, s60, 917504
    v_lshlrev_b32 v8, 7, v0
    v_mov_b32 v9, s30
    s_mov_b32 exec_lo, 255
    s_mov_b32 exec_hi, 0
    s_waitcnt vmcnt(5)
    buffer_store_dword v9, v8, s[4:7], s60 offen sc1
    s_mov_b64 exec, -1
    v_mov_b32 v8, 31
    ds_write_b32 v10, v8
    s_setprio 2
    buffer_load_dwordx4 v[80:83], v1, s[4:7], s71 offen offset:0 sc1
    buffer_load_dwordx4 v[84:87], v1, s[4:7], s72 offen offset:0 sc1
    buffer_load_dwordx4 v[88:91], v1, s[4:7], s71 offen offset:1024 sc1
    buffer_load_dwordx4 v[92:95], v1, s[4:7], s72 offen offset:1024 sc1
    s_waitcnt vmcnt(8)
    v_mov_b32 v57, 0x0c0c0400
L_uva_226:
    v_perm_b32 v58, v53, v52, v57
    v_perm_b32 v59, v55, v54, v57
    v_lshl_or_b32 v58, v59, 16, v58
    v_cmp_ne_u32 vcc, s30, v58
    s_cbranch_vccz L_uvg_227
    buffer_load_dwordx4 v[52:55], v56, s[4:7], s69 offen sc1
    s_sub_i32 s66, s66, 4
    s_cmp_ge_i32 s66, 0
    s_waitcnt vmcnt(0)
    s_cbranch_scc1 L_uva_226
L_uvg_227:
    v_and_b32 v52, 0xffffff00, v52
    v_and_b32 v53, 0xffffff00, v53
    v_and_b32 v54, 0xffffff00, v54
    v_and_b32 v55, 0xffffff00, v55
    v_mov_b32_dpp v64, v52 quad_perm:[0,0,0,0] row_mask:0xf bank_mask:0xf
    v_mov_b32_dpp v65, v53 quad_perm:[0,0,0,0] row_mask:0xf bank_mask:0xf
    v_mov_b32_dpp v66, v54 quad_perm:[0,0,0,0] row_mask:0xf bank_mask:0xf
    v_mov_b32_dpp v67, v55 quad_perm:[0,0,0,0] row_mask:0xf bank_mask:0xf
    v_mov_b32_dpp v68, v52 quad_perm:[1,1,1,1] row_mask:0xf bank_mask:0xf
    v_mov_b32_dpp v69, v53 quad_perm:[1,1,1,1] row_mask:0xf bank_mask:0xf
    v_mov_b32_dpp v70, v54 quad_perm:[1,1,1,1] row_mask:0xf bank_mask:0xf
    v_mov_b32_dpp v71, v55 quad_perm:[1,1,1,1] row_mask:0xf bank_mask:0xf
    v_mov_b32_dpp v72, v52 quad_perm:[2,2,2,2] row_mask:0xf bank_mask:0xf
    v_mov_b32_dpp v73, v53 quad_perm:[2,2,2,2] row_mask:0xf bank_mask:0xf
    v_mov_b32_dpp v74, v54 quad_perm:[2,2,2,2] row_mask:0xf bank_mask:0xf
    v_mov_b32_dpp v75, v55 quad_perm:[2,2,2,2] row_mask:0xf bank_mask:0xf
    v_mov_b32_dpp v76, v52 quad_perm:[3,3,3,3] row_mask:0xf bank_mask:0xf
    v_mov_b32_dpp v77, v53 quad_perm:[3,3,3,3] row_mask:0xf bank_mask:0xf
    v_mov_b32_dpp v78, v54 quad_perm:[3,3,3,3] row_mask:0xf bank_mask:0xf
    v_mov_b32_dpp v79, v55 quad_perm:[3,3,3,3] row_mask:0xf bank_mask:0xf
L_gs_228:
    ds_read_b32 v9, v11
    s_sub_i32 s66, s66, 1
    s_cmp_lt_i32 s66, 0
    s_waitcnt lgkmcnt(0)
    s_cbranch_scc1 L_gsd_229
    v_cmp_gt_u32 vcc, 33, v9
    s_nop 0
    s_and_b32 vcc_lo, vcc_lo, 0xf0
    s_cbranch_scc1 L_gs_228
L_gsd_229:
    ds_read_b128 v[32:35], v14 offset:0
    ds_read_b128 v[36:39], v14 offset:256
    ds_read_b128 v[40:43], v14 offset:2048
    ds_read_b128 v[44:47], v14 offset:2304
    ds_read_b128 v[48:51], v14 offset:4096
    ds_read_b128 v[52:55], v14 offset:4352
    s_waitcnt lgkmcnt(4)
    v_mfma_f32_16x16x32_bf16 v[16:19], v[96:99], v[32:35], 0
    ds_read_b128 v[56:59], v14 offset:6144
    v_mfma_f32_16x16x32_bf16 v[20:23], v[100:103], v[32:35], 0
    ds_read_b128 v[60:63], v14 offset:6400
    v_mfma_f32_16x16x32_bf16 v[24:27], v[96:99], v[36:39], 0
    v_mfma_f32_16x16x32_bf16 v[28:31], v[100:103], v[36:39], 0
    s_waitcnt lgkmcnt(4)
    v_mfma_f32_16x16x32_bf16 v[16:19], v[104:107], v[40:43], v[16:19]
    ds_read_b128 v[32:35], v14 offset:8192
    v_mfma_f32_16x16x32_bf16 v[20:23], v[108:111], v[40:43], v[20:23]
    ds_read_b128 v[36:39], v14 offset:8448
    v_mfma_f32_16x16x32_bf16 v[24:27], v[104:107], v[44:47], v[24:27]
    v_mfma_f32_16x16x32_bf16 v[28:31], v[108:111], v[44:47], v[28:31]
    s_waitcnt lgkmcnt(4)
    v_mfma_f32_16x16x32_bf16 v[16:19], v[112:115], v[48:51], v[16:19]
    ds_read_b128 v[40:43], v14 offset:10240
    v_mfma_f32_16x16x32_bf16 v[20:23], v[116:119], v[48:51], v[20:23]
    ds_read_b128 v[44:47], v14 offset:10496
    v_mfma_f32_16x16x32_bf16 v[24:27], v[112:115], v[52:55], v[24:27]
    v_mfma_f32_16x16x32_bf16 v[28:31], v[116:119], v[52:55], v[28:31]
    s_waitcnt lgkmcnt(4)
    v_mfma_f32_16x16x32_bf16 v[16:19], v[120:123], v[56:59], v[16:19]
    ds_read_b128 v[48:51], v14 offset:12288
    v_mfma_f32_16x16x32_bf16 v[20:23], v[124:127], v[56:59], v[20:23]
    ds_read_b128 v[52:55], v14 offset:12544
    v_mfma_f32_16x16x32_bf16 v[24:27], v[120:123], v[60:63], v[24:27]
    v_mfma_f32_16x16x32_bf16 v[28:31], v[124:127], v[60:63], v[28:31]
    s_waitcnt lgkmcnt(4)
    v_mfma_f32_16x16x32_bf16 v[16:19], v[128:131], v[32:35], v[16:19]
    ds_read_b128 v[56:59], v14 offset:14336
    v_mfma_f32_16x16x32_bf16 v[20:23], v[132:135], v[32:35], v[20:23]
    ds_read_b128 v[60:63], v14 offset:14592
    v_mfma_f32_16x16x32_bf16 v[24:27], v[128:131], v[36:39], v[24:27]
    v_mfma_f32_16x16x32_bf16 v[28:31], v[132:135], v[36:39], v[28:31]
    s_waitcnt lgkmcnt(4)
    v_mfma_f32_16x16x32_bf16 v[16:19], v[136:139], v[40:43], v[16:19]
    ds_read_b128 v[32:35], v14 offset:16384
    v_mfma_f32_16x16x32_bf16 v[20:23], v[140:143], v[40:43], v[20:23]
    ds_read_b128 v[36:39], v14 offset:16640
    v_mfma_f32_16x16x32_bf16 v[24:27], v[136:139], v[44:47], v[24:27]
    v_mfma_f32_16x16x32_bf16 v[28:31], v[140:143], v[44:47], v[28:31]
    s_waitcnt lgkmcnt(4)
    v_mfma_f32_16x16x32_bf16 v[16:19], v[144:147], v[48:51], v[16:19]
    ds_read_b128 v[40:43], v14 offset:18432
    v_mfma_f32_16x16x32_bf16 v[20:23], v[148:151], v[48:51], v[20:23]
    ds_read_b128 v[44:47], v14 offset:18688
    v_mfma_f32_16x16x32_bf16 v[24:27], v[144:147], v[52:55], v[24:27]
    v_mfma_f32_16x16x32_bf16 v[28:31], v[148:151], v[52:55], v[28:31]
    s_waitcnt lgkmcnt(4)
    v_mfma_f32_16x16x32_bf16 v[16:19], v[152:155], v[56:59], v[16:19]
    ds_read_b128 v[48:51], v14 offset:20480
    v_mfma_f32_16x16x32_bf16 v[20:23], v[156:159], v[56:59], v[20:23]
    ds_read_b128 v[52:55], v14 offset:20736
    v_mfma_f32_16x16x32_bf16 v[24:27], v[152:155], v[60:63], v[24:27]
    v_mfma_f32_16x16x32_bf16 v[28:31], v[156:159], v[60:63], v[28:31]
    s_waitcnt lgkmcnt(4)
    v_mfma_f32_16x16x32_bf16 v[16:19], v[160:163], v[32:35], v[16:19]
    ds_read_b128 v[56:59], v14 offset:22528
    v_mfma_f32_16x16x32_bf16 v[20:23], v[164:167], v[32:35], v[20:23]
    ds_read_b128 v[60:63], v14 offset:22784
    v_mfma_f32_16x16x32_bf16 v[24:27], v[160:163], v[36:39], v[24:27]
    v_mfma_f32_16x16x32_bf16 v[28:31], v[164:167], v[36:39], v[28:31]
    s_waitcnt lgkmcnt(4)
    v_mfma_f32_16x16x32_bf16 v[16:19], v[168:171], v[40:43], v[16:19]
    ds_read_b128 v[32:35], v14 offset:24576
    v_mfma_f32_16x16x32_bf16 v[20:23], v[172:175], v[40:43], v[20:23]
    ds_read_b128 v[36:39], v14 offset:24832
    v_mfma_f32_16x16x32_bf16 v[24:27], v[168:171], v[44:47], v[24:27]
    v_mfma_f32_16x16x32_bf16 v[28:31], v[172:175], v[44:47], v[28:31]
    s_waitcnt lgkmcnt(4)
    v_mfma_f32_16x16x32_bf16 v[16:19], v[176:179], v[48:51], v[16:19]
    ds_read_b128 v[40:43], v14 offset:26624
    v_mfma_f32_16x16x32_bf16 v[20:23], v[180:183], v[48:51], v[20:23]
    ds_read_b128 v[44:47], v14 offset:26880
    v_mfma_f32_16x16x32_bf16 v[24:27], v[176:179], v[52:55], v[24:27]
    v_mfma_f32_16x16x32_bf16 v[28:31], v[180:183], v[52:55], v[28:31]
    s_waitcnt lgkmcnt(4)
    v_mfma_f32_16x16x32_bf16 v[16:19], v[184:187], v[56:59], v[16:19]
    ds_read_b128 v[48:51], v14 offset:28672
    v_mfma_f32_16x16x32_bf16 v[20:23], v[188:191], v[56:59], v[20:23]
    ds_read_b128 v[52:55], v14 offset:28928
    v_mfma_f32_16x16x32_bf16 v[24:27], v[184:187], v[60:63], v[24:27]
    v_mfma_f32_16x16x32_bf16 v[28:31], v[188:191], v[60:63], v[28:31]
    s_waitcnt lgkmcnt(4)
    v_mfma_f32_16x16x32_bf16 v[16:19], v[192:195], v[32:35], v[16:19]
    ds_read_b128 v[56:59], v14 offset:30720
    v_mfma_f32_16x16x32_bf16 v[20:23], v[196:199], v[32:35], v[20:23]
    ds_read_b128 v[60:63], v14 offset:30976
    v_mfma_f32_16x16x32_bf16 v[24:27], v[192:195], v[36:39], v[24:27]
    v_mfma_f32_16x16x32_bf16 v[28:31], v[196:199], v[36:39], v[28:31]
    s_waitcnt lgkmcnt(4)
    v_mfma_f32_16x16x32_bf16 v[16:19], v[200:203], v[40:43], v[16:19]
    ds_read_b64 v[32:33], v15 offset:0
    v_mfma_f32_16x16x32_bf16 v[20:23], v[204:207], v[40:43], v[20:23]
    ds_read_b64 v[34:35], v15 offset:256
    v_mfma_f32_16x16x32_bf16 v[24:27], v[200:203], v[44:47], v[24:27]
    ds_read_b64 v[36:37], v15 offset:128
    v_mfma_f32_16x16x32_bf16 v[28:31], v[204:207], v[44:47], v[28:31]
    ds_read_b64 v[38:39], v15 offset:384
    s_waitcnt lgkmcnt(6)
    v_mfma_f32_16x16x32_bf16 v[16:19], v[208:211], v[48:51], v[16:19]
    ds_read_b64 v[40:41], v15 offset:2048
    v_mfma_f32_16x16x32_bf16 v[20:23], v[212:215], v[48:51], v[20:23]
    ds_read_b64 v[42:43], v15 offset:2304
    v_mfma_f32_16x16x32_bf16 v[24:27], v[208:211], v[52:55], v[24:27]
    ds_read_b64 v[44:45], v15 offset:2176
    v_mfma_f32_16x16x32_bf16 v[28:31], v[212:215], v[52:55], v[28:31]
    ds_read_b64 v[46:47], v15 offset:2432
    s_waitcnt lgkmcnt(8)
    v_mfma_f32_16x16x32_bf16 v[16:19], v[216:219], v[56:59], v[16:19]
    ds_read_b64 v[48:49], v15 offset:4096
    v_mfma_f32_16x16x32_bf16 v[20:23], v[220:223], v[56:59], v[20:23]
    ds_read_b64 v[50:51], v15 offset:4352
    v_mfma_f32_16x16x32_bf16 v[24:27], v[216:219], v[60:63], v[24:27]
    ds_read_b64 v[52:53], v15 offset:4224
    v_mfma_f32_16x16x32_bf16 v[28:31], v[220:223], v[60:63], v[28:31]
    ds_read_b64 v[54:55], v15 offset:4480
    s_waitcnt lgkmcnt(8)
    v_mfma_f32_16x16x32_bf16 v[16:19], v[224:227], v[32:35], v[16:19]
    ds_read_b64 v[56:57], v15 offset:6144
    v_mfma_f32_16x16x32_bf16 v[20:23], v[228:231], v[32:35], v[20:23]
    ds_read_b64 v[58:59], v15 offset:6400
    v_mfma_f32_16x16x32_bf16 v[24:27], v[224:227], v[36:39], v[24:27]
    ds_read_b64 v[60:61], v15 offset:6272
    v_mfma_f32_16x16x32_bf16 v[28:31], v[228:231], v[36:39], v[28:31]
    ds_read_b64 v[62:63], v15 offset:6528
    s_waitcnt lgkmcnt(8)
    v_mfma_f32_16x16x32_bf16 v[16:19], v[232:235], v[40:43], v[16:19]
    v_mfma_f32_16x16x32_bf16 v[20:23], v[236:239], v[40:43], v[20:23]
    v_mfma_f32_16x16x32_bf16 v[24:27], v[232:235], v[44:47], v[24:27]
    v_mfma_f32_16x16x32_bf16 v[28:31], v[236:239], v[44:47], v[28:31]
    s_waitcnt vmcnt(4)
    s_waitcnt lgkmcnt(4)
    v_mfma_f32_16x16x32_bf16 v[16:19], v[240:243], v[48:51], v[16:19]
    v_mfma_f32_16x16x32_bf16 v[20:23], v[244:247], v[48:51], v[20:23]
    ds_read_b128 v[32:35], v13 offset:0
    v_mfma_f32_16x16x32_bf16 v[24:27], v[240:243], v[52:55], v[24:27]
    ds_read_b128 v[36:39], v13 offset:256
    v_mfma_f32_16x16x32_bf16 v[28:31], v[244:247], v[52:55], v[28:31]
    s_waitcnt lgkmcnt(2)
    v_mfma_f32_16x16x32_bf16 v[16:19], v[248:251], v[56:59], v[16:19]
    v_mfma_f32_16x16x32_bf16 v[20:23], v[252:255], v[56:59], v[20:23]
    v_mfma_f32_16x16x32_bf16 v[24:27], v[248:251], v[60:63], v[24:27]
    v_mfma_f32_16x16x32_bf16 v[28:31], v[252:255], v[60:63], v[28:31]
    v_add_u32 v14, 47616, v14
    v_add_u32 v15, 47616, v15
    s_waitcnt lgkmcnt(0)
    s_nop 1
    v_fmac_f32 v16, v64, v32
    v_fmac_f32 v17, v65, v32
    v_fmac_f32 v18, v66, v32
    v_fmac_f32 v19, v67, v32
    v_fmac_f32 v20, v68, v32
    v_fmac_f32 v21, v69, v32
    v_fmac_f32 v22, v70, v32
    v_fmac_f32 v23, v71, v32
    v_fma_f32 v16, v16, v34, v72
    v_fma_f32 v17, v17, v34, v73
    v_fma_f32 v18, v18, v34, v74
    v_fma_f32 v19, v19, v34, v75
    v_fma_f32 v20, v20, v34, v76
    v_fma_f32 v21, v21, v34, v77
    v_fma_f32 v22, v22, v34, v78
    v_fma_f32 v23, v23, v34, v79
    v_cvt_pk_bf16_f32 v40, v16, v17
    v_cvt_pk_bf16_f32 v41, v18, v19
    v_cvt_pk_bf16_f32 v42, v20, v21
    v_cvt_pk_bf16_f32 v43, v22, v23
    v_pk_max_i16 v40, v40, 0
    v_pk_max_i16 v41, v41, 0
    v_pk_max_i16 v42, v42, 0
    v_pk_max_i16 v43, v43, 0
    buffer_store_dwordx4 v[40:43], v14, s[4:7], s63 offen offset:0 sc1
    v_fmac_f32 v24, v64, v36
    v_fmac_f32 v25, v65, v36
    v_fmac_f32 v26, v66, v36
    v_fmac_f32 v27, v67, v36
    v_fmac_f32 v28, v68, v36
    v_fmac_f32 v29, v69, v36
    v_fmac_f32 v30, v70, v36
    v_fmac_f32 v31, v71, v36
    v_fma_f32 v24, v24, v38, v72
    v_fma_f32 v25, v25, v38, v73
    v_fma_f32 v26, v26, v38, v74
    v_fma_f32 v27, v27, v38, v75
    v_fma_f32 v28, v28, v38, v76
    v_fma_f32 v29, v29, v38, v77
    v_fma_f32 v30, v30, v38, v78
    v_fma_f32 v31, v31, v38, v79
    v_cvt_pk_bf16_f32 v44, v24, v25
    v_cvt_pk_bf16_f32 v45, v26, v27
    v_cvt_pk_bf16_f32 v46, v28, v29
    v_cvt_pk_bf16_f32 v47, v30, v31
    v_pk_max_i16 v44, v44, 0
    v_pk_max_i16 v45, v45, 0
    v_pk_max_i16 v46, v46, 0
    v_pk_max_i16 v47, v47, 0
    buffer_store_dwordx4 v[44:47], v14, s[4:7], s63 offen offset:256 sc1
    s_setprio 0
    s_waitcnt vmcnt(0)
    v_mov_b32 v8, 36
    ds_write_b32 v10, v8
L_gs_230:
    ds_read_b32 v9, v11
    s_sub_i32 s66, s66, 1
    s_cmp_lt_i32 s66, 0
    s_waitcnt lgkmcnt(0)
    s_cbranch_scc1 L_gsd_231
    v_cmp_gt_u32 vcc, 33, v9
    s_nop 0
    s_and_b32 vcc_lo, vcc_lo, 8
    s_cbranch_scc1 L_gs_230
L_gsd_231:
L_gs_232:
    ds_read_b32 v9, v11
    s_sub_i32 s66, s66, 1
    s_cmp_lt_i32 s66, 0
    s_waitcnt lgkmcnt(0)
    s_cbranch_scc1 L_gsd_233
    v_cmp_gt_u32 vcc, 43, v9
    s_nop 0
    s_and_b32 vcc_lo, vcc_lo, 0xf0
    s_cbranch_scc1 L_gs_232
L_gsd_233:
    ds_read_b128 v[32:35], v14 offset:0
    ds_read_b128 v[36:39], v14 offset:256
    ds_read_b128 v[40:43], v14 offset:2048
    ds_read_b128 v[44:47], v14 offset:2304
    ds_read_b128 v[48:51], v14 offset:4096
    ds_read_b128 v[52:55], v14 offset:4352
    s_waitcnt lgkmcnt(4)
    v_mfma_f32_16x16x32_bf16 v[16:19], v[96:99], v[32:35], 0
    ds_read_b128 v[56:59], v14 offset:6144
    v_mfma_f32_16x16x32_bf16 v[20:23], v[100:103], v[32:35], 0
    ds_read_b128 v[60:63], v14 offset:6400
    v_mfma_f32_16x16x32_bf16 v[24:27], v[96:99], v[36:39], 0
    v_mfma_f32_16x16x32_bf16 v[28:31], v[100:103], v[36:39], 0
    s_waitcnt lgkmcnt(4)
    v_mfma_f32_16x16x32_bf16 v[16:19], v[104:107], v[40:43], v[16:19]
    ds_read_b128 v[32:35], v14 offset:8192
    v_mfma_f32_16x16x32_bf16 v[20:23], v[108:111], v[40:43], v[20:23]
    ds_read_b128 v[36:39], v14 offset:8448
    v_mfma_f32_16x16x32_bf16 v[24:27], v[104:107], v[44:47], v[24:27]
    v_mfma_f32_16x16x32_bf16 v[28:31], v[108:111], v[44:47], v[28:31]
    s_waitcnt lgkmcnt(4)
    v_mfma_f32_16x16x32_bf16 v[16:19], v[112:115], v[48:51], v[16:19]
    ds_read_b128 v[40:43], v14 offset:10240
    v_mfma_f32_16x16x32_bf16 v[20:23], v[116:119], v[48:51], v[20:23]
    ds_read_b128 v[44:47], v14 offset:10496
    v_mfma_f32_16x16x32_bf16 v[24:27], v[112:115], v[52:55], v[24:27]
    v_mfma_f32_16x16x32_bf16 v[28:31], v[116:119], v[52:55], v[28:31]
    s_waitcnt lgkmcnt(4)
    v_mfma_f32_16x16x32_bf16 v[16:19], v[120:123], v[56:59], v[16:19]
    ds_read_b128 v[48:51], v14 offset:12288
    v_mfma_f32_16x16x32_bf16 v[20:23], v[124:127], v[56:59], v[20:23]
    ds_read_b128 v[52:55], v14 offset:12544
    v_mfma_f32_16x16x32_bf16 v[24:27], v[120:123], v[60:63], v[24:27]
    v_mfma_f32_16x16x32_bf16 v[28:31], v[124:127], v[60:63], v[28:31]
    s_waitcnt lgkmcnt(4)
    v_mfma_f32_16x16x32_bf16 v[16:19], v[128:131], v[32:35], v[16:19]
    ds_read_b128 v[56:59], v14 offset:14336
    v_mfma_f32_16x16x32_bf16 v[20:23], v[132:135], v[32:35], v[20:23]
    ds_read_b128 v[60:63], v14 offset:14592
    v_mfma_f32_16x16x32_bf16 v[24:27], v[128:131], v[36:39], v[24:27]
    v_mfma_f32_16x16x32_bf16 v[28:31], v[132:135], v[36:39], v[28:31]
    s_waitcnt lgkmcnt(4)
    v_mfma_f32_16x16x32_bf16 v[16:19], v[136:139], v[40:43], v[16:19]
    ds_read_b128 v[32:35], v14 offset:16384
    v_mfma_f32_16x16x32_bf16 v[20:23], v[140:143], v[40:43], v[20:23]
    ds_read_b128 v[36:39], v14 offset:16640
    v_mfma_f32_16x16x32_bf16 v[24:27], v[136:139], v[44:47], v[24:27]
    v_mfma_f32_16x16x32_bf16 v[28:31], v[140:143], v[44:47], v[28:31]
    s_waitcnt lgkmcnt(4)
    v_mfma_f32_16x16x32_bf16 v[16:19], v[144:147], v[48:51], v[16:19]
    ds_read_b128 v[40:43], v14 offset:18432
    v_mfma_f32_16x16x32_bf16 v[20:23], v[148:151], v[48:51], v[20:23]
    ds_read_b128 v[44:47], v14 offset:18688
    v_mfma_f32_16x16x32_bf16 v[24:27], v[144:147], v[52:55], v[24:27]
    v_mfma_f32_16x16x32_bf16 v[28:31], v[148:151], v[52:55], v[28:31]
    s_waitcnt lgkmcnt(4)
    v_mfma_f32_16x16x32_bf16 v[16:19], v[152:155], v[56:59], v[16:19]
    ds_read_b128 v[48:51], v14 offset:20480
    v_mfma_f32_16x16x32_bf16 v[20:23], v[156:159], v[56:59], v[20:23]
    ds_read_b128 v[52:55], v14 offset:20736
    v_mfma_f32_16x16x32_bf16 v[24:27], v[152:155], v[60:63], v[24:27]
    v_mfma_f32_16x16x32_bf16 v[28:31], v[156:159], v[60:63], v[28:31]
    s_waitcnt lgkmcnt(4)
    v_mfma_f32_16x16x32_bf16 v[16:19], v[160:163], v[32:35], v[16:19]
    ds_read_b128 v[56:59], v14 offset:22528
    v_mfma_f32_16x16x32_bf16 v[20:23], v[164:167], v[32:35], v[20:23]
    ds_read_b128 v[60:63], v14 offset:22784
    v_mfma_f32_16x16x32_bf16 v[24:27], v[160:163], v[36:39], v[24:27]
    v_mfma_f32_16x16x32_bf16 v[28:31], v[164:167], v[36:39], v[28:31]
    s_waitcnt lgkmcnt(4)
    v_mfma_f32_16x16x32_bf16 v[16:19], v[168:171], v[40:43], v[16:19]
    ds_read_b128 v[32:35], v14 offset:24576
    v_mfma_f32_16x16x32_bf16 v[20:23], v[172:175], v[40:43], v[20:23]
    ds_read_b128 v[36:39], v14 offset:24832
    v_mfma_f32_16x16x32_bf16 v[24:27], v[168:171], v[44:47], v[24:27]
    v_mfma_f32_16x16x32_bf16 v[28:31], v[172:175], v[44:47], v[28:31]
    s_waitcnt lgkmcnt(4)
    v_mfma_f32_16x16x32_bf16 v[16:19], v[176:179], v[48:51], v[16:19]
    ds_read_b128 v[40:43], v14 offset:26624
    v_mfma_f32_16x16x32_bf16 v[20:23], v[180:183], v[48:51], v[20:23]
    ds_read_b128 v[44:47], v14 offset:26880
    v_mfma_f32_16x16x32_bf16 v[24:27], v[176:179], v[52:55], v[24:27]
    v_mfma_f32_16x16x32_bf16 v[28:31], v[180:183], v[52:55], v[28:31]
    s_waitcnt lgkmcnt(4)
    v_mfma_f32_16x16x32_bf16 v[16:19], v[184:187], v[56:59], v[16:19]
    ds_read_b128 v[48:51], v14 offset:28672
    v_mfma_f32_16x16x32_bf16 v[20:23], v[188:191], v[56:59], v[20:23]
    ds_read_b128 v[52:55], v14 offset:28928
    v_mfma_f32_16x16x32_bf16 v[24:27], v[184:187], v[60:63], v[24:27]
    v_mfma_f32_16x16x32_bf16 v[28:31], v[188:191], v[60:63], v[28:31]
    s_waitcnt lgkmcnt(4)
    v_mfma_f32_16x16x32_bf16 v[16:19], v[192:195], v[32:35], v[16:19]
    ds_read_b128 v[56:59], v14 offset:30720
    v_mfma_f32_16x16x32_bf16 v[20:23], v[196:199], v[32:35], v[20:23]
    ds_read_b128 v[60:63], v14 offset:30976
    v_mfma_f32_16x16x32_bf16 v[24:27], v[192:195], v[36:39], v[24:27]
    v_mfma_f32_16x16x32_bf16 v[28:31], v[196:199], v[36:39], v[28:31]
    s_waitcnt lgkmcnt(4)
    v_mfma_f32_16x16x32_bf16 v[16:19], v[200:203], v[40:43], v[16:19]
    ds_read_b64 v[32:33], v15 offset:0
    v_mfma_f32_16x16x32_bf16 v[20:23], v[204:207], v[40:43], v[20:23]
    ds_read_b64 v[34:35], v15 offset:256
    ds_read_b128 v[192:195], v12 offset:0
    v_mfma_f32_16x16x32_bf16 v[24:27], v[200:203], v[44:47], v[24:27]
    ds_read_b64 v[36:37], v15 offset:128
    ds_read_b128 v[196:199], v12 offset:1024
    v_mfma_f32_16x16x32_bf16 v[28:31], v[204:207], v[44:47], v[28:31]
    ds_read_b64 v[38:39], v15 offset:384
    s_waitcnt lgkmcnt(8)
    v_mfma_f32_16x16x32_bf16 v[16:19], v[208:211], v[48:51], v[16:19]
    ds_read_b64 v[40:41], v15 offset:2048
    v_mfma_f32_16x16x32_bf16 v[20:23], v[212:215], v[48:51], v[20:23]
    ds_read_b64 v[42:43], v15 offset:2304
    ds_read_b128 v[200:203], v12 offset:2048
    v_mfma_f32_16x16x32_bf16 v[24:27], v[208:211], v[52:55], v[24:27]
    ds_read_b64 v[44:45], v15 offset:2176
    ds_read_b128 v[204:207], v12 offset:3072
    v_mfma_f32_16x16x32_bf16 v[28:31], v[212:215], v[52:55], v[28:31]
    ds_read_b64 v[46:47], v15 offset:2432
    s_waitcnt lgkmcnt(12)
    v_mfma_f32_16x16x32_bf16 v[16:19], v[216:219], v[56:59], v[16:19]
    ds_read_b64 v[48:49], v15 offset:4096
    v_mfma_f32_16x16x32_bf16 v[20:23], v[220:223], v[56:59], v[20:23]
    ds_read_b64 v[50:51], v15 offset:4352
    ds_read_b128 v[208:211], v12 offset:4096
    v_mfma_f32_16x16x32_bf16 v[24:27], v[216:219], v[60:63], v[24:27]
    ds_read_b64 v[52:53], v15 offset:4224
    ds_read_b128 v[212:215], v12 offset:5120
    v_mfma_f32_16x16x32_bf16 v[28:31], v[220:223], v[60:63], v[28:31]
    ds_read_b64 v[54:55], v15 offset:4480
    s_waitcnt lgkmcnt(12)
    v_mfma_f32_16x16x32_bf16 v[16:19], v[224:227], v[32:35], v[16:19]
    ds_read_b64 v[56:57], v15 offset:6144
    v_mfma_f32_16x16x32_bf16 v[20:23], v[228:231], v[32:35], v[20:23]
    ds_read_b64 v[58:59], v15 offset:6400
    ds_read_b128 v[216:219], v12 offset:6144
    v_mfma_f32_16x16x32_bf16 v[24:27], v[224:227], v[36:39], v[24:27]
    ds_read_b64 v[60:61], v15 offset:6272
    ds_read_b128 v[220:223], v12 offset:7168
    v_mfma_f32_16x16x32_bf16 v[28:31], v[228:231], v[36:39], v[28:31]
    ds_read_b64 v[62:63], v15 offset:6528
    s_waitcnt lgkmcnt(12)
    v_mfma_f32_16x16x32_bf16 v[16:19], v[232:235], v[40:43], v[16:19]
    v_mfma_f32_16x16x32_bf16 v[20:23], v[236:239], v[40:43], v[20:23]
    ds_read_b128 v[224:227], v12 offset:8192
    v_mfma_f32_16x16x32_bf16 v[24:27], v[232:235], v[44:47], v[24:27]
    ds_read_b128 v[228:231], v12 offset:9216
    v_mfma_f32_16x16x32_bf16 v[28:31], v[236:239], v[44:47], v[28:31]
    s_waitcnt lgkmcnt(8)
    v_mfma_f32_16x16x32_bf16 v[16:19], v[240:243], v[48:51], v[16:19]
    v_mfma_f32_16x16x32_bf16 v[20:23], v[244:247], v[48:51], v[20:23]
    ds_read_b128 v[32:35], v13 offset:512
    v_mfma_f32_16x16x32_bf16 v[24:27], v[240:243], v[52:55], v[24:27]
    ds_read_b128 v[36:39], v13 offset:768
    v_mfma_f32_16x16x32_bf16 v[28:31], v[244:247], v[52:55], v[28:31]
    ds_read_b128 v[232:235], v12 offset:10240
    s_waitcnt lgkmcnt(5)
    v_mfma_f32_16x16x32_bf16 v[16:19], v[248:251], v[56:59], v[16:19]
    v_mfma_f32_16x16x32_bf16 v[20:23], v[252:255], v[56:59], v[20:23]
    ds_read_b128 v[236:239], v12 offset:11264
    v_mfma_f32_16x16x32_bf16 v[24:27], v[248:251], v[60:63], v[24:27]
    ds_read_b128 v[240:243], v12 offset:12288
    v_mfma_f32_16x16x32_bf16 v[28:31], v[252:255], v[60:63], v[28:31]
    ds_read_b128 v[244:247], v12 offset:13312
    s_waitcnt lgkmcnt(4)
    s_nop 0
    v_fmac_f32 v16, v64, v32
    v_fmac_f32 v17, v65, v32
    v_fmac_f32 v18, v66, v32
    v_fmac_f32 v19, v67, v32
    v_fmac_f32 v20, v68, v32
    v_fmac_f32 v21, v69, v32
    v_fmac_f32 v22, v70, v32
    v_fmac_f32 v23, v71, v32
    v_fma_f32 v16, v16, v34, v72
    v_fma_f32 v17, v17, v34, v73
    v_fma_f32 v18, v18, v34, v74
    v_fma_f32 v19, v19, v34, v75
    v_fma_f32 v20, v20, v34, v76
    v_fma_f32 v21, v21, v34, v77
    v_fma_f32 v22, v22, v34, v78
    v_fma_f32 v23, v23, v34, v79
    v_cvt_pk_bf16_f32 v40, v16, v17
    v_cvt_pk_bf16_f32 v41, v18, v19
    v_cvt_pk_bf16_f32 v42, v20, v21
    v_cvt_pk_bf16_f32 v43, v22, v23
    v_pk_max_i16 v40, v40, 0
    v_pk_max_i16 v41, v41, 0
    v_pk_max_i16 v42, v42, 0
    v_pk_max_i16 v43, v43, 0
    buffer_store_dwordx4 v[40:43], v14, s[4:7], s64 offen offset:0 sc1
    v_fmac_f32 v24, v64, v36
    v_fmac_f32 v25, v65, v36
    v_fmac_f32 v26, v66, v36
    v_fmac_f32 v27, v67, v36
    v_fmac_f32 v28, v68, v36
    v_fmac_f32 v29, v69, v36
    v_fmac_f32 v30, v70, v36
    v_fmac_f32 v31, v71, v36
    v_fma_f32 v24, v24, v38, v72
    v_fma_f32 v25, v25, v38, v73
    v_fma_f32 v26, v26, v38, v74
    v_fma_f32 v27, v27, v38, v75
    v_fma_f32 v28, v28, v38, v76
    v_fma_f32 v29, v29, v38, v77
    v_fma_f32 v30, v30, v38, v78
    v_fma_f32 v31, v31, v38, v79
    v_cvt_pk_bf16_f32 v44, v24, v25
    v_cvt_pk_bf16_f32 v45, v26, v27
    v_cvt_pk_bf16_f32 v46, v28, v29
    v_cvt_pk_bf16_f32 v47, v30, v31
    v_pk_max_i16 v44, v44, 0
    v_pk_max_i16 v45, v45, 0
    v_pk_max_i16 v46, v46, 0
    v_pk_max_i16 v47, v47, 0
    buffer_store_dwordx4 v[44:47], v14, s[4:7], s64 offen offset:256 sc1
    v_mov_b32 v8, 59
    ds_write_b32 v10, v8
    s_branch L_f1join_197
L_f1idle_195:
    s_mul_i32 s60, s84, 14336
    v_add_u32 v12, s60, v1
    s_lshl_b32 s65, s56, 3
    s_lshl_b32 s62, s84, 8
    s_add_u32 s62, s62, s65
    s_lshl_b32 s60, s62, 7
    s_lshl_b32 s61, s57, 2
    s_add_u32 s60, s60, s61
    s_add_u32 s60, s60, 917504
    v_lshlrev_b32 v8, 7, v0
    v_mov_b32 v9, s30
    s_mov_b32 exec_lo, 255
    s_mov_b32 exec_hi, 0
    s_waitcnt vmcnt(0)
    buffer_store_dword v9, v8, s[4:7], s60 offen sc1
    s_mov_b64 exec, -1
    v_mov_b32 v8, 31
    ds_write_b32 v10, v8
    s_cmp_lg_u32 s31, 3
    s_cbranch_scc1 L_f1idle_195_w
L_gs_234:
    ds_read_b32 v9, v11
    s_sub_i32 s66, s66, 1
    s_cmp_lt_i32 s66, 0
    s_waitcnt lgkmcnt(0)
    s_cbranch_scc1 L_gsd_235
    v_cmp_gt_u32 vcc, 31, v9
    s_nop 0
    s_and_b32 vcc_lo, vcc_lo, 0x0f
    s_cbranch_scc1 L_gs_234
L_gsd_235:
    s_mul_i32 s60, s57, 276480
    s_add_u32 s60, s60, 29204480
    s_mov_b32 m0, 0
    s_add_u32 s61, s60, 0
    buffer_load_dwordx4 v1, s[4:7], s61 offen offset:0 sc1 lds
    buffer_load_dwordx4 v1, s[4:7], s61 offen offset:1024 sc1 lds
    buffer_load_dwordx4 v1, s[4:7], s61 offen offset:2048 sc1 lds
    buffer_load_dwordx4 v1, s[4:7], s61 offen offset:3072 sc1 lds
    s_mov_b32 m0, 4096
    s_add_u32 s61, s60, 4096
    buffer_load_dwordx4 v1, s[4:7], s61 offen offset:0 sc1 lds
    buffer_load_dwordx4 v1, s[4:7], s61 offen offset:1024 sc1 lds
    buffer_load_dwordx4 v1, s[4:7], s61 offen offset:2048 sc1 lds
    buffer_load_dwordx4 v1, s[4:7], s61 offen offset:3072 sc1 lds
    s_mov_b32 m0, 8192
    s_add_u32 s61, s60, 8192
    buffer_load_dwordx4 v1, s[4:7], s61 offen offset:0 sc1 lds
    buffer_load_dwordx4 v1, s[4:7], s61 offen offset:1024 sc1 lds
    buffer_load_dwordx4 v1, s[4:7], s61 offen offset:2048 sc1 lds
    buffer_load_dwordx4 v1, s[4:7], s61 offen offset:3072 sc1 lds
    s_mov_b32 m0, 12288
    s_add_u32 s61, s60, 12288
    buffer_load_dwordx4 v1, s[4:7], s61 offen offset:0 sc1 lds
    buffer_load_dwordx4 v1, s[4:7], s61 offen offset:1024 sc1 lds
    s_mov_b32 m0, 14336
    s_add_u32 s61, s60, 14336
    buffer_load_dwordx4 v1, s[4:7], s61 offen offset:0 sc1 lds
    buffer_load_dwordx4 v1, s[4:7], s61 offen offset:1024 sc1 lds
    buffer_load_dwordx4 v1, s[4:7], s61 offen offset:2048 sc1 lds
    buffer_load_dwordx4 v1, s[4:7], s61 offen offset:3072 sc1 lds
    s_mov_b32 m0, 18432
    s_add_u32 s61, s60, 18432
    buffer_load_dwordx4 v1, s[4:7], s61 offen offset:0 sc1 lds
    buffer_load_dwordx4 v1, s[4:7], s61 offen offset:1024 sc1 lds
    buffer_load_dwordx4 v1, s[4:7], s61 offen offset:2048 sc1 lds
    buffer_load_dwordx4 v1, s[4:7], s61 offen offset:3072 sc1 lds
    s_mov_b32 m0, 22528
    s_add_u32 s61, s60, 22528
    buffer_load_dwordx4 v1, s[4:7], s61 offen offset:0 sc1 lds
    buffer_load_dwordx4 v1, s[4:7], s61 offen offset:1024 sc1 lds
    buffer_load_dwordx4 v1, s[4:7], s61 offen offset:2048 sc1 lds
    buffer_load_dwordx4 v1, s[4:7], s61 offen offset:3072 sc1 lds
    s_mov_b32 m0, 26624
    s_add_u32 s61, s60, 26624
    buffer_load_dwordx4 v1, s[4:7], s61 offen offset:0 sc1 lds
    buffer_load_dwordx4 v1, s[4:7], s61 offen offset:1024 sc1 lds
    s_mov_b32 m0, 28672
    s_add_u32 s61, s60, 28672
    buffer_load_dwordx4 v1, s[4:7], s61 offen offset:0 sc1 lds
    buffer_load_dwordx4 v1, s[4:7], s61 offen offset:1024 sc1 lds
    buffer_load_dwordx4 v1, s[4:7], s61 offen offset:2048 sc1 lds
    buffer_load_dwordx4 v1, s[4:7], s61 offen offset:3072 sc1 lds
    s_mov_b32 m0, 32768
    s_add_u32 s61, s60, 32768
    buffer_load_dwordx4 v1, s[4:7], s61 offen offset:0 sc1 lds
    buffer_load_dwordx4 v1, s[4:7], s61 offen offset:1024 sc1 lds
    buffer_load_dwordx4 v1, s[4:7], s61 offen offset:2048 sc1 lds
    buffer_load_dwordx4 v1, s[4:7], s61 offen offset:3072 sc1 lds
    s_mov_b32 m0, 36864
    s_add_u32 s61, s60, 36864
    buffer_load_dwordx4 v1, s[4:7], s61 offen offset:0 sc1 lds
    buffer_load_dwordx4 v1, s[4:7], s61 offen offset:1024 sc1 lds
    buffer_load_dwordx4 v1, s[4:7], s61 offen offset:2048 sc1 lds
    buffer_load_dwordx4 v1, s[4:7], s61 offen offset:3072 sc1 lds
    s_mov_b32 m0, 40960
    s_add_u32 s61, s60, 40960
    buffer_load_dwordx4 v1, s[4:7], s61 offen offset:0 sc1 lds
    s_mov_b32 m0, 43008
    s_add_u32 s61, s60, 41984
    buffer_load_dwordx4 v1, s[4:7], s61 offen offset:0 sc1 lds
    buffer_load_dwordx4 v1, s[4:7], s61 offen offset:1024 sc1 lds
    buffer_load_dwordx4 v1, s[4:7], s61 offen offset:2048 sc1 lds
    buffer_load_dwordx4 v1, s[4:7], s61 offen offset:3072 sc1 lds
    s_mov_b32 m0, 47104
    s_add_u32 s61, s60, 46080
    buffer_load_dwordx4 v1, s[4:7], s61 offen offset:0 sc1 lds
    buffer_load_dwordx4 v1, s[4:7], s61 offen offset:1024 sc1 lds
    buffer_load_dwordx4 v1, s[4:7], s61 offen offset:2048 sc1 lds
    buffer_load_dwordx4 v1, s[4:7], s61 offen offset:3072 sc1 lds
    s_mov_b32 m0, 51200
    s_add_u32 s61, s60, 50176
    buffer_load_dwordx4 v1, s[4:7], s61 offen offset:0 sc1 lds
    buffer_load_dwordx4 v1, s[4:7], s61 offen offset:1024 sc1 lds
    buffer_load_dwordx4 v1, s[4:7], s61 offen offset:2048 sc1 lds
    buffer_load_dwordx4 v1, s[4:7], s61 offen offset:3072 sc1 lds
    s_mov_b32 m0, 55296
    s_add_u32 s61, s60, 54272
    buffer_load_dwordx4 v1, s[4:7], s61 offen offset:0 sc1 lds
    s_waitcnt vmcnt(0)
    v_mov_b32 v8, 33
    ds_write_b32 v10, v8
L_gs_236:
    ds_read_b32 v9, v11
    s_sub_i32 s66, s66, 1
    s_cmp_lt_i32 s66, 0
    s_waitcnt lgkmcnt(0)
    s_cbranch_scc1 L_gsd_237
    v_cmp_gt_u32 vcc, 42, v9
    s_nop 0
    s_and_b32 vcc_lo, vcc_lo, 0xf0
    s_cbranch_scc1 L_gs_236
L_gsd_237:
L_f1idle_195_w:
    v_mov_b32 v8, 36
    ds_write_b32 v10, v8
    s_add_u32 s62, s71, 0
    buffer_load_dwordx4 v[80:83], v1, s[4:7], s62 offen offset:0 sc1
    s_add_u32 s62, s72, 0
    buffer_load_dwordx4 v[84:87], v1, s[4:7], s62 offen offset:0 sc1
    s_add_u32 s62, s71, 0
    buffer_load_dwordx4 v[88:91], v1, s[4:7], s62 offen offset:1024 sc1
    s_add_u32 s62, s72, 0
    buffer_load_dwordx4 v[92:95], v1, s[4:7], s62 offen offset:1024 sc1
    s_add_u32 s62, s72, 8192
    buffer_load_dwordx4 v[156:159], v1, s[4:7], s62 offen offset:1024 sc1
    s_add_u32 s62, s71, 8192
    buffer_load_dwordx4 v[160:163], v1, s[4:7], s62 offen offset:2048 sc1
    s_add_u32 s62, s72, 8192
    buffer_load_dwordx4 v[164:167], v1, s[4:7], s62 offen offset:2048 sc1
    s_add_u32 s62, s71, 8192
    buffer_load_dwordx4 v[168:171], v1, s[4:7], s62 offen offset:3072 sc1
    s_add_u32 s62, s72, 8192
    buffer_load_dwordx4 v[172:175], v1, s[4:7], s62 offen offset:3072 sc1
    s_add_u32 s62, s71, 12288
    buffer_load_dwordx4 v[176:179], v1, s[4:7], s62 offen offset:0 sc1
    s_add_u32 s62, s72, 12288
    buffer_load_dwordx4 v[180:183], v1, s[4:7], s62 offen offset:0 sc1
    s_add_u32 s62, s71, 12288
    buffer_load_dwordx4 v[184:187], v1, s[4:7], s62 offen offset:1024 sc1
    s_add_u32 s62, s72, 12288
    buffer_load_dwordx4 v[188:191], v1, s[4:7], s62 offen offset:1024 sc1
    s_cmp_lg_u32 s31, 3
    s_cbranch_scc1 L_f1idle_195_e
L_gs_238:
    ds_read_b32 v9, v11
    s_sub_i32 s66, s66, 1
    s_cmp_lt_i32 s66, 0
    s_waitcnt lgkmcnt(0)
    s_cbranch_scc1 L_gsd_239
    v_cmp_gt_u32 vcc, 36, v9
    s_nop 0
    s_and_b32 vcc_lo, vcc_lo, 0xff
    s_cbranch_scc1 L_gs_238
L_gsd_239:
    s_lshl_b32 s60, s65, 7
    s_lshl_b32 s61, s57, 2
    s_add_u32 s60, s60, s61
    s_add_u32 s60, s60, 294912
    v_lshlrev_b32 v8, 7, v0
    v_mov_b32 v9, s30
    s_mov_b32 exec_lo, 255
    s_mov_b32 exec_hi, 0
    buffer_store_dword v9, v8, s[4:7], s60 offen sc1
    s_mov_b64 exec, -1
L_f1idle_195_e:
    s_cmp_lg_u32 s31, 3
    s_cbranch_scc1 L_f1idle_195_f
    s_waitcnt vmcnt(0)
L_sp_240:
    s_buffer_load_dwordx8 s[32:39], s[4:7], s81 glc
    s_sub_i32 s66, s66, 4
    s_cmp_lt_i32 s66, 0
    s_waitcnt lgkmcnt(0)
    s_cbranch_scc1 L_spd_241
    s_cmp_lg_u64 s[32:33], s[28:29]
    s_cbranch_scc1 L_sp_240
    s_cmp_lg_u64 s[34:35], s[28:29]
    s_cbranch_scc1 L_sp_240
    s_cmp_lg_u64 s[36:37], s[28:29]
    s_cbranch_scc1 L_sp_240
    s_cmp_lg_u64 s[38:39], s[28:29]
    s_cbranch_scc1 L_sp_240
L_spd_241:
    v_mov_b32 v8, 37
    ds_write_b32 v10, v8
L_f1idle_195_f:
L_gs_242:
    ds_read_b32 v9, v11
    s_sub_i32 s66, s66, 1
    s_cmp_lt_i32 s66, 0
    s_waitcnt lgkmcnt(0)
    s_cbranch_scc1 L_gsd_243
    v_cmp_gt_u32 vcc, 33, v9
    s_nop 0
    s_and_b32 vcc_lo, vcc_lo, 8
    s_cbranch_scc1 L_gs_242
L_gsd_243:
    ds_read_b128 v[192:195], v12 offset:0
    ds_read_b128 v[196:199], v12 offset:1024
    ds_read_b128 v[200:203], v12 offset:2048
    ds_read_b128 v[204:207], v12 offset:3072
    ds_read_b128 v[208:211], v12 offset:4096
    ds_read_b128 v[212:215], v12 offset:5120
    ds_read_b128 v[216:219], v12 offset:6144
    ds_read_b128 v[220:223], v12 offset:7168
    ds_read_b128 v[224:227], v12 offset:8192
    ds_read_b128 v[228:231], v12 offset:9216
    ds_read_b128 v[232:235], v12 offset:10240
    ds_read_b128 v[236:239], v12 offset:11264
    ds_read_b128 v[240:243], v12 offset:12288
    ds_read_b128 v[244:247], v12 offset:13312
    v_mov_b32 v8, 59
    ds_write_b32 v10, v8
    s_branch L_f1join_197
L_f1b_196:
    s_waitcnt vmcnt(12)
    v_mov_b32 v8, 26
    ds_write_b32 v10, v8
    s_setprio 1
    v_and_b32 v14, 1, v0
    v_mul_u32_u24 v14, 1280, v14
    v_sub_u32 v14, 161280, v14
    v_and_b32 v15, 1, v13
    v_lshl_add_u32 v15, v15, 4, v14
    v_lshl_add_u32 v14, v13, 4, v14
    v_lshrrev_b32 v8, 1, v13
    v_mul_u32_u24 v8, 160, v8
    v_add_u32 v15, v15, v8
    ds_read_b128 v[16:19], v14 offset:480
    ds_read_b128 v[20:23], v14 offset:544
    ds_read_b128 v[24:27], v14 offset:640
    ds_read_b128 v[28:31], v14 offset:704
    ds_read_b128 v[32:35], v14 offset:800
    ds_read_b128 v[36:39], v14 offset:864
    ds_read_b128 v[40:43], v14 offset:960
    s_waitcnt lgkmcnt(6)
    v_mfma_f32_16x16x32_bf16 v[64:67], v[144:147], v[16:19], 0
    v_mfma_f32_16x16x32_bf16 v[68:71], v[148:151], v[16:19], 0
    s_waitcnt lgkmcnt(5)
    v_mfma_f32_16x16x32_bf16 v[64:67], v[152:155], v[20:23], v[64:67]
    v_mfma_f32_16x16x32_bf16 v[68:71], v[156:159], v[20:23], v[68:71]
    s_waitcnt lgkmcnt(4)
    v_mfma_f32_16x16x32_bf16 v[64:67], v[160:163], v[24:27], v[64:67]
    v_mfma_f32_16x16x32_bf16 v[68:71], v[164:167], v[24:27], v[68:71]
    s_waitcnt lgkmcnt(3)
    v_mfma_f32_16x16x32_bf16 v[64:67], v[168:171], v[28:31], v[64:67]
    v_mfma_f32_16x16x32_bf16 v[68:71], v[172:175], v[28:31], v[68:71]
    s_waitcnt lgkmcnt(2)
    v_mfma_f32_16x16x32_bf16 v[64:67], v[176:179], v[32:35], v[64:67]
    v_mfma_f32_16x16x32_bf16 v[68:71], v[180:183], v[32:35], v[68:71]
    s_waitcnt lgkmcnt(1)
    v_mfma_f32_16x16x32_bf16 v[64:67], v[184:187], v[36:39], v[64:67]
    v_mfma_f32_16x16x32_bf16 v[68:71], v[188:191], v[36:39], v[68:71]
    s_waitcnt lgkmcnt(0)
    v_mfma_f32_16x16x32_bf16 v[64:67], v[192:195], v[40:43], v[64:67]
    v_mfma_f32_16x16x32_bf16 v[68:71], v[196:199], v[40:43], v[68:71]
    ds_read_b128 v[16:19], v14 offset:1024
    ds_read_b128 v[20:23], v14 offset:1120
    ds_read_b128 v[24:27], v14 offset:1184
    ds_read_b128 v[28:31], v15 offset:128
    ds_read_b128 v[32:35], v15 offset:448
    ds_read_b128 v[36:39], v15 offset:768
    ds_read_b128 v[40:43], v15 offset:1088
    s_waitcnt lgkmcnt(6)
    v_mfma_f32_16x16x32_bf16 v[64:67], v[200:203], v[16:19], v[64:67]
    v_mfma_f32_16x16x32_bf16 v[68:71], v[204:207], v[16:19], v[68:71]
    s_waitcnt lgkmcnt(5)
    v_mfma_f32_16x16x32_bf16 v[64:67], v[208:211], v[20:23], v[64:67]
    v_mfma_f32_16x16x32_bf16 v[68:71], v[212:215], v[20:23], v[68:71]
    s_waitcnt lgkmcnt(4)
    v_mfma_f32_16x16x32_bf16 v[64:67], v[216:219], v[24:27], v[64:67]
    v_mfma_f32_16x16x32_bf16 v[68:71], v[220:223], v[24:27], v[68:71]
    s_waitcnt lgkmcnt(3)
    v_mfma_f32_16x16x32_bf16 v[64:67], v[224:227], v[28:31], v[64:67]
    v_mfma_f32_16x16x32_bf16 v[68:71], v[228:231], v[28:31], v[68:71]
    s_waitcnt lgkmcnt(2)
    v_mfma_f32_16x16x32_bf16 v[64:67], v[232:235], v[32:35], v[64:67]
    v_mfma_f32_16x16x32_bf16 v[68:71], v[236:239], v[32:35], v[68:71]
    s_waitcnt lgkmcnt(1)
    v_mfma_f32_16x16x32_bf16 v[64:67], v[240:243], v[36:39], v[64:67]
    v_mfma_f32_16x16x32_bf16 v[68:71], v[244:247], v[36:39], v[68:71]
    s_waitcnt lgkmcnt(0)
    v_mfma_f32_16x16x32_bf16 v[64:67], v[248:251], v[40:43], v[64:67]
    v_mfma_f32_16x16x32_bf16 v[68:71], v[252:255], v[40:43], v[68:71]
    ds_read_b128 v[16:19], v14 offset:0
    ds_read_b128 v[20:23], v14 offset:64
    ds_read_b128 v[24:27], v14 offset:160
    ds_read_b128 v[28:31], v14 offset:224
    ds_read_b128 v[32:35], v14 offset:320
    ds_read_b128 v[36:39], v14 offset:384
    s_waitcnt vmcnt(0)
    s_waitcnt lgkmcnt(5)
    v_mfma_f32_16x16x32_bf16 v[64:67], v[96:99], v[16:19], v[64:67]
    v_mfma_f32_16x16x32_bf16 v[68:71], v[100:103], v[16:19], v[68:71]
    s_waitcnt lgkmcnt(4)
    v_mfma_f32_16x16x32_bf16 v[64:67], v[104:107], v[20:23], v[64:67]
    v_mfma_f32_16x16x32_bf16 v[68:71], v[108:111], v[20:23], v[68:71]
    s_waitcnt lgkmcnt(3)
    v_mfma_f32_16x16x32_bf16 v[64:67], v[112:115], v[24:27], v[64:67]
    v_mfma_f32_16x16x32_bf16 v[68:71], v[116:119], v[24:27], v[68:71]
    s_waitcnt lgkmcnt(2)
    v_mfma_f32_16x16x32_bf16 v[64:67], v[120:123], v[28:31], v[64:67]
    v_mfma_f32_16x16x32_bf16 v[68:71], v[124:127], v[28:31], v[68:71]
    s_waitcnt lgkmcnt(1)
    v_mfma_f32_16x16x32_bf16 v[64:67], v[128:131], v[32:35], v[64:67]
    v_mfma_f32_16x16x32_bf16 v[68:71], v[132:135], v[32:35], v[68:71]
    s_waitcnt lgkmcnt(0)
    v_mfma_f32_16x16x32_bf16 v[64:67], v[136:139], v[36:39], v[64:67]
    v_mfma_f32_16x16x32_bf16 v[68:71], v[140:143], v[36:39], v[68:71]
    s_lshr_b32 s60, s56, 1
    s_mul_i32 s60, s60, 54
    s_add_u32 s60, s60, s86
    s_lshl_b32 s60, s60, 8
    s_add_u32 s69, s60, 1572864
    v_and_b32 v56, 3, v12
    v_lshlrev_b32 v56, 7, v56
    v_lshl_add_u32 v56, v13, 4, v56
    s_bfe_u32 s61, s30, 524288
    v_add_u32 v64, 0x80, v64
    v_and_b32 v64, 0xffffff00, v64
    v_or_b32 v16, s61, v64
    s_bfe_u32 s61, s30, 524296
    v_add_u32 v65, 0x80, v65
    v_and_b32 v65, 0xffffff00, v65
    v_or_b32 v17, s61, v65
    s_bfe_u32 s61, s30, 524304
    v_add_u32 v66, 0x80, v66
    v_and_b32 v66, 0xffffff00, v66
    v_or_b32 v18, s61, v66
    s_bfe_u32 s61, s30, 524312
    v_add_u32 v67, 0x80, v67
    v_and_b32 v67, 0xffffff00, v67
    v_or_b32 v19, s61, v67
    s_bfe_u32 s61, s30, 524288
    v_add_u32 v68, 0x80, v68
    v_and_b32 v68, 0xffffff00, v68
    v_or_b32 v20, s61, v68
    s_bfe_u32 s61, s30, 524296
    v_add_u32 v69, 0x80, v69
    v_and_b32 v69, 0xffffff00, v69
    v_or_b32 v21, s61, v69
    s_bfe_u32 s61, s30, 524304
    v_add_u32 v70, 0x80, v70
    v_and_b32 v70, 0xffffff00, v70
    v_or_b32 v22, s61, v70
    s_bfe_u32 s61, s30, 524312
    v_add_u32 v71, 0x80, v71
    v_and_b32 v71, 0xffffff00, v71
    v_or_b32 v23, s61, v71
    s_mov_b32 exec_lo, 0x30003
    s_mov_b32 exec_hi, 0x30003
    buffer_store_dwordx4 v[16:19], v56, s[4:7], s69 offen offset:0 sc1
    buffer_store_dwordx4 v[20:23], v56, s[4:7], s69 offen offset:64 sc1
    s_mov_b64 exec, -1
    v_mov_b32_dpp v72, v64 quad_perm:[1,1,3,3] row_mask:0xf bank_mask:0xf
    v_mov_b32_dpp v73, v65 quad_perm:[1,1,3,3] row_mask:0xf bank_mask:0xf
    v_mov_b32_dpp v74, v66 quad_perm:[1,1,3,3] row_mask:0xf bank_mask:0xf
    v_mov_b32_dpp v75, v67 quad_perm:[1,1,3,3] row_mask:0xf bank_mask:0xf
    v_mov_b32_dpp v76, v68 quad_perm:[1,1,3,3] row_mask:0xf bank_mask:0xf
    v_mov_b32_dpp v77, v69 quad_perm:[1,1,3,3] row_mask:0xf bank_mask:0xf
    v_mov_b32_dpp v78, v70 quad_perm:[1,1,3,3] row_mask:0xf bank_mask:0xf
    v_mov_b32_dpp v79, v71 quad_perm:[1,1,3,3] row_mask:0xf bank_mask:0xf
    v_mov_b32_dpp v64, v64 quad_perm:[0,0,2,2] row_mask:0xf bank_mask:0xf
    v_mov_b32_dpp v65, v65 quad_perm:[0,0,2,2] row_mask:0xf bank_mask:0xf
    v_mov_b32_dpp v66, v66 quad_perm:[0,0,2,2] row_mask:0xf bank_mask:0xf
    v_mov_b32_dpp v67, v67 quad_perm:[0,0,2,2] row_mask:0xf bank_mask:0xf
    v_mov_b32_dpp v68, v68 quad_perm:[0,0,2,2] row_mask:0xf bank_mask:0xf
    v_mov_b32_dpp v69, v69 quad_perm:[0,0,2,2] row_mask:0xf bank_mask:0xf
    v_mov_b32_dpp v70, v70 quad_perm:[0,0,2,2] row_mask:0xf bank_mask:0xf
    v_mov_b32_dpp v71, v71 quad_perm:[0,0,2,2] row_mask:0xf bank_mask:0xf
    v_lshlrev_b32 v8, 9, v13
    v_lshl_add_u32 v14, v12, 4, v8
    v_add_u32 v14, 67072, v14
    v_lshl_add_u32 v15, v12, 3, v8
    v_add_u32 v15, 99840, v15
    v_lshlrev_b32 v13, 4, v12
    v_add_u32 v13, 157632, v13
    s_mul_i32 s63, s56, 221184
    s_lshl_b32 s61, s86, 11
    s_add_u32 s63, s63, s61
    s_add_u32 s63, s63, 18759680
    s_add_u32 s64, s63, 110592
    s_mul_i32 s60, s84, 14336
    v_add_u32 v12, s60, v1
    buffer_load_dwordx4 v[80:83], v1, s[4:7], s71 offen offset:0 sc1
    buffer_load_dwordx4 v[84:87], v1, s[4:7], s72 offen offset:0 sc1
    buffer_load_dwordx4 v[88:91], v1, s[4:7], s71 offen offset:1024 sc1
    buffer_load_dwordx4 v[92:95], v1, s[4:7], s72 offen offset:1024 sc1
    s_lshl_b32 s60, s80, 7
    s_add_u32 s60, s60, 229376
    s_mul_i32 s68, s56, 81920
    s_lshl_b32 s61, s84, 10
    s_add_u32 s68, s68, s61
    s_add_u32 s68, s68, 16252928
    s_add_u32 m0, s61, 67072
    s_lshl_b32 s61, s56, 13
    s_add_u32 s61, s61, 1310720
    s_lshl_b32 s62, s84, 15
    s_add_u32 s60, s60, s62
    s_add_u32 s60, s60, 557056
    s_add_u32 s40, s60, 131072
L_gs_246:
    ds_read_b32 v9, v11
    s_sub_i32 s66, s66, 1
    s_cmp_lt_i32 s66, 0
    s_waitcnt lgkmcnt(0)
    s_cbranch_scc1 L_gsd_247
    v_cmp_gt_u32 vcc, 28, v9
    s_nop 0
    s_and_b32 vcc_lo, vcc_lo, 0x0f
    s_cbranch_scc1 L_gs_246
L_gsd_247:
L_sp_248:
    s_buffer_load_dwordx8 s[32:39], s[4:7], s60 glc
    s_sub_i32 s66, s66, 4
    s_cmp_lt_i32 s66, 0
    s_waitcnt lgkmcnt(0)
    s_cbranch_scc1 L_spd_249
    s_cmp_lg_u64 s[32:33], s[28:29]
    s_cbranch_scc1 L_sp_248
    s_cmp_lg_u64 s[34:35], s[28:29]
    s_cbranch_scc1 L_sp_248
    s_cmp_lg_u64 s[36:37], s[28:29]
    s_cbranch_scc1 L_sp_248
    s_cmp_lg_u64 s[38:39], s[28:29]
    s_cbranch_scc1 L_sp_248
L_spd_249:
    v_mov_b32 v8, 31
    ds_write_b32 v10, v8
L_gs_250:
    ds_read_b32 v9, v11
    s_sub_i32 s66, s66, 1
    s_cmp_lt_i32 s66, 0
    s_waitcnt lgkmcnt(0)
    s_cbranch_scc1 L_gsd_251
    v_cmp_gt_u32 vcc, 31, v9
    s_nop 0
    s_and_b32 vcc_lo, vcc_lo, 0xf0
    s_cbranch_scc1 L_gs_250
L_gsd_251:
    s_cmp_lg_u32 s31, 7
    s_cbranch_scc1 L_n7_244
    buffer_load_dwordx4 v[16:19], v1, s[4:7], s61 offen offset:0 sc1
    buffer_load_dwordx4 v[20:23], v1, s[4:7], s61 offen offset:1024 sc1
    buffer_load_dwordx4 v[24:27], v1, s[4:7], s61 offen offset:2048 sc1
    buffer_load_dwordx4 v[28:31], v1, s[4:7], s61 offen offset:3072 sc1
L_n7_244:
    buffer_load_dwordx4 v1, s[4:7], s68 offen sc1 lds
    s_add_u32 m0, m0, 4096
    s_add_u32 s68, s68, 4096
    buffer_load_dwordx4 v1, s[4:7], s68 offen sc1 lds
    s_add_u32 m0, m0, 4096
    s_add_u32 s68, s68, 4096
    buffer_load_dwordx4 v1, s[4:7], s68 offen sc1 lds
    s_add_u32 m0, m0, 4096
    s_add_u32 s68, s68, 4096
    buffer_load_dwordx4 v1, s[4:7], s68 offen sc1 lds
    s_add_u32 m0, m0, 4096
    s_add_u32 s68, s68, 4096
    buffer_load_dwordx4 v1, s[4:7], s68 offen sc1 lds
    s_add_u32 m0, m0, 4096
    s_add_u32 s68, s68, 4096
    buffer_load_dwordx4 v1, s[4:7], s68 offen sc1 lds
    s_add_u32 m0, m0, 4096
    s_add_u32 s68, s68, 4096
    buffer_load_dwordx4 v1, s[4:7], s68 offen sc1 lds
    s_add_u32 m0, m0, 4096
    s_add_u32 s68, s68, 4096
    buffer_load_dwordx4 v1, s[4:7], s68 offen sc1 lds
    s_add_u32 m0, m0, 4096
    s_add_u32 s68, s68, 4096
    buffer_load_dwordx4 v1, s[4:7], s68 offen sc1 lds
    s_add_u32 m0, m0, 4096
    s_add_u32 s68, s68, 4096
    buffer_load_dwordx4 v1, s[4:7], s68 offen sc1 lds
    s_add_u32 m0, m0, 4096
    s_add_u32 s68, s68, 4096
    s_waitcnt vmcnt(7)
    v_mov_b32 v8, 32
    ds_write_b32 v10, v8
    s_cmp_lg_u32 s31, 7
    s_cbranch_scc1 L_n8_245
    v_add_f32 v16, v16, v20
    v_add_f32 v17, v17, v21
    v_add_f32 v18, v18, v22
    v_add_f32 v19, v19, v23
    v_add_f32 v24, v24, v28
    v_add_f32 v25, v25, v29
    v_add_f32 v26, v26, v30
    v_add_f32 v27, v27, v31
    v_permlane32_swap_b32 v16, v24
    v_permlane32_swap_b32 v17, v25
    v_permlane32_swap_b32 v18, v26
    v_permlane32_swap_b32 v19, v27
    v_add_f32 v16, v16, v24
    v_add_f32 v17, v17, v25
    v_add_f32 v18, v18, v26
    v_add_f32 v19, v19, v27
    v_and_b32 v24, 7, v0
    v_lshlrev_b32 v24, 5, v24
    v_permlane16_swap_b32 v16, v18
    v_permlane16_swap_b32 v17, v19
    v_add_f32 v16, v16, v18
    v_add_f32 v17, v17, v19
    v_and_b32 v25, 16, v0
    v_add_u32 v24, v24, v25
    v_add_f32_dpp v16, v16, v16 row_ror:8 row_mask:0xf bank_mask:0xf
    v_add_f32_dpp v17, v17, v17 row_ror:8 row_mask:0xf bank_mask:0xf
    v_and_b32 v25, 32, v0
    v_lshl_add_u32 v24, v25, 3, v24
    v_mul_f32 v16, 0xbacccccd, v16
    v_mul_f32 v17, 0x3acccccd, v17
    v_fma_f32 v17, -v16, v16, v17
    v_max_f32 v17, 0, v17
    v_add_f32 v17, 0x3727c5ac, v17
    v_rsq_f32 v18, v17
    v_add_u32 v24, 157632, v24
    ds_write_b128 v24, v[16:19]
L_n8_245:
L_gs_252:
    ds_read_b32 v9, v11
    s_sub_i32 s66, s66, 1
    s_cmp_lt_i32 s66, 0
    s_waitcnt lgkmcnt(0)
    s_cbranch_scc1 L_gsd_253
    v_cmp_gt_u32 vcc, 32, v9
    s_nop 0
    s_and_b32 vcc_lo, vcc_lo, 0xf0
    s_cbranch_scc1 L_gs_252
L_gsd_253:
L_gs_254:
    ds_read_b32 v9, v11
    s_sub_i32 s66, s66, 1
    s_cmp_lt_i32 s66, 0
    s_waitcnt lgkmcnt(0)
    s_cbranch_scc1 L_gsd_255
    v_cmp_gt_u32 vcc, 30, v9
    s_nop 0
    s_and_b32 vcc_lo, vcc_lo, s77
    s_cbranch_scc1 L_gs_254
L_gsd_255:
    s_setprio 3
    ds_read_b128 v[32:35], v14 offset:0
    ds_read_b128 v[36:39], v14 offset:256
    ds_read_b128 v[40:43], v14 offset:2048
    ds_read_b128 v[44:47], v14 offset:2304
    ds_read_b128 v[48:51], v14 offset:4096
    ds_read_b128 v[52:55], v14 offset:4352
    s_waitcnt lgkmcnt(4)
    v_mfma_f32_16x16x32_bf16 v[16:19], v[96:99], v[32:35], 0
    ds_read_b128 v[56:59], v14 offset:6144
    v_mfma_f32_16x16x32_bf16 v[20:23], v[100:103], v[32:35], 0
    ds_read_b128 v[60:63], v14 offset:6400
    v_mfma_f32_16x16x32_bf16 v[24:27], v[96:99], v[36:39], 0
    v_mfma_f32_16x16x32_bf16 v[28:31], v[100:103], v[36:39], 0
    s_waitcnt vmcnt(0)
    v_mov_b32 v8, 33
    ds_write_b32 v10, v8
    s_waitcnt lgkmcnt(5)
    v_mfma_f32_16x16x32_bf16 v[16:19], v[104:107], v[40:43], v[16:19]
    ds_read_b128 v[32:35], v14 offset:8192
    v_mfma_f32_16x16x32_bf16 v[20:23], v[108:111], v[40:43], v[20:23]
    ds_read_b128 v[36:39], v14 offset:8448
    v_mfma_f32_16x16x32_bf16 v[24:27], v[104:107], v[44:47], v[24:27]
    v_mfma_f32_16x16x32_bf16 v[28:31], v[108:111], v[44:47], v[28:31]
    ds_read_b32 v9, v11
    s_waitcnt lgkmcnt(6)
    v_mfma_f32_16x16x32_bf16 v[16:19], v[112:115], v[48:51], v[16:19]
    ds_read_b128 v[40:43], v14 offset:10240
    v_mfma_f32_16x16x32_bf16 v[20:23], v[116:119], v[48:51], v[20:23]
    ds_read_b128 v[44:47], v14 offset:10496
    v_mfma_f32_16x16x32_bf16 v[24:27], v[112:115], v[52:55], v[24:27]
    v_mfma_f32_16x16x32_bf16 v[28:31], v[116:119], v[52:55], v[28:31]
    s_waitcnt lgkmcnt(6)
    v_mfma_f32_16x16x32_bf16 v[16:19], v[120:123], v[56:59], v[16:19]
    s_waitcnt lgkmcnt(2)
    v_cmp_gt_u32 vcc, 33, v9
    s_nop 0
    s_and_b32 vcc_lo, vcc_lo, 0xf0
    s_cbranch_scc1 L_ck_256
L_cko_257:
    v_mfma_f32_16x16x32_bf16 v[20:23], v[124:127], v[56:59], v[20:23]
    ds_read_b128 v[48:51], v14 offset:12288
    v_mfma_f32_16x16x32_bf16 v[24:27], v[120:123], v[60:63], v[24:27]
    ds_read_b128 v[52:55], v14 offset:12544
    v_mfma_f32_16x16x32_bf16 v[28:31], v[124:127], v[60:63], v[28:31]
    v_mfma_f32_16x16x32_bf16 v[16:19], v[128:131], v[32:35], v[16:19]
    ds_read_b128 v[56:59], v14 offset:14336
    v_mfma_f32_16x16x32_bf16 v[20:23], v[132:135], v[32:35], v[20:23]
    ds_read_b128 v[60:63], v14 offset:14592
    v_mfma_f32_16x16x32_bf16 v[24:27], v[128:131], v[36:39], v[24:27]
    v_mfma_f32_16x16x32_bf16 v[28:31], v[132:135], v[36:39], v[28:31]
    s_waitcnt lgkmcnt(4)
    v_mfma_f32_16x16x32_bf16 v[16:19], v[136:139], v[40:43], v[16:19]
    ds_read_b128 v[32:35], v14 offset:16384
    v_mfma_f32_16x16x32_bf16 v[20:23], v[140:143], v[40:43], v[20:23]
    ds_read_b128 v[36:39], v14 offset:16640
    v_mfma_f32_16x16x32_bf16 v[24:27], v[136:139], v[44:47], v[24:27]
    v_mfma_f32_16x16x32_bf16 v[28:31], v[140:143], v[44:47], v[28:31]
    s_waitcnt lgkmcnt(4)
    v_mfma_f32_16x16x32_bf16 v[16:19], v[144:147], v[48:51], v[16:19]
    ds_read_b128 v[40:43], v14 offset:18432
    v_mfma_f32_16x16x32_bf16 v[20:23], v[148:151], v[48:51], v[20:23]
    ds_read_b128 v[44:47], v14 offset:18688
    v_mfma_f32_16x16x32_bf16 v[24:27], v[144:147], v[52:55], v[24:27]
    v_mfma_f32_16x16x32_bf16 v[28:31], v[148:151], v[52:55], v[28:31]
    s_waitcnt lgkmcnt(4)
    v_mfma_f32_16x16x32_bf16 v[16:19], v[152:155], v[56:59], v[16:19]
    ds_read_b128 v[48:51], v14 offset:20480
    v_mfma_f32_16x16x32_bf16 v[20:23], v[156:159], v[56:59], v[20:23]
    ds_read_b128 v[52:55], v14 offset:20736
    v_mfma_f32_16x16x32_bf16 v[24:27], v[152:155], v[60:63], v[24:27]
    v_mfma_f32_16x16x32_bf16 v[28:31], v[156:159], v[60:63], v[28:31]
    s_waitcnt lgkmcnt(4)
    v_mfma_f32_16x16x32_bf16 v[16:19], v[160:163], v[32:35], v[16:19]
    ds_read_b128 v[56:59], v14 offset:22528
    v_mfma_f32_16x16x32_bf16 v[20:23], v[164:167], v[32:35], v[20:23]
    ds_read_b128 v[60:63], v14 offset:22784
    v_mfma_f32_16x16x32_bf16 v[24:27], v[160:163], v[36:39], v[24:27]
    v_mfma_f32_16x16x32_bf16 v[28:31], v[164:167], v[36:39], v[28:31]
    s_waitcnt lgkmcnt(4)
    v_mfma_f32_16x16x32_bf16 v[16:19], v[168:171], v[40:43], v[16:19]
    ds_read_b128 v[32:35], v14 offset:24576
    v_mfma_f32_16x16x32_bf16 v[20:23], v[172:175], v[40:43], v[20:23]
    ds_read_b128 v[36:39], v14 offset:24832
    v_mfma_f32_16x16x32_bf16 v[24:27], v[168:171], v[44:47], v[24:27]
    v_mfma_f32_16x16x32_bf16 v[28:31], v[172:175], v[44:47], v[28:31]
    s_waitcnt lgkmcnt(4)
    v_mfma_f32_16x16x32_bf16 v[16:19], v[176:179], v[48:51], v[16:19]
    ds_read_b128 v[40:43], v14 offset:26624
    v_mfma_f32_16x16x32_bf16 v[20:23], v[180:183], v[48:51], v[20:23]
    ds_read_b128 v[44:47], v14 offset:26880
    v_mfma_f32_16x16x32_bf16 v[24:27], v[176:179], v[52:55], v[24:27]
    v_mfma_f32_16x16x32_bf16 v[28:31], v[180:183], v[52:55], v[28:31]
    s_waitcnt lgkmcnt(4)
    v_mfma_f32_16x16x32_bf16 v[16:19], v[184:187], v[56:59], v[16:19]
    ds_read_b128 v[48:51], v14 offset:28672
    v_mfma_f32_16x16x32_bf16 v[20:23], v[188:191], v[56:59], v[20:23]
    ds_read_b128 v[52:55], v14 offset:28928
    v_mfma_f32_16x16x32_bf16 v[24:27], v[184:187], v[60:63], v[24:27]
    v_mfma_f32_16x16x32_bf16 v[28:31], v[188:191], v[60:63], v[28:31]
    s_waitcnt lgkmcnt(4)
    v_mfma_f32_16x16x32_bf16 v[16:19], v[192:195], v[32:35], v[16:19]
    ds_read_b128 v[56:59], v14 offset:30720
    v_mfma_f32_16x16x32_bf16 v[20:23], v[196:199], v[32:35], v[20:23]
    ds_read_b128 v[60:63], v14 offset:30976
    v_mfma_f32_16x16x32_bf16 v[24:27], v[192:195], v[36:39], v[24:27]
    v_mfma_f32_16x16x32_bf16 v[28:31], v[196:199], v[36:39], v[28:31]
    s_waitcnt lgkmcnt(4)
    v_mfma_f32_16x16x32_bf16 v[16:19], v[200:203], v[40:43], v[16:19]
    ds_read_b64 v[32:33], v15 offset:0
    v_mfma_f32_16x16x32_bf16 v[20:23], v[204:207], v[40:43], v[20:23]
    ds_read_b64 v[34:35], v15 offset:256
    v_mfma_f32_16x16x32_bf16 v[24:27], v[200:203], v[44:47], v[24:27]
    ds_read_b64 v[36:37], v15 offset:128
    v_mfma_f32_16x16x32_bf16 v[28:31], v[204:207], v[44:47], v[28:31]
    ds_read_b64 v[38:39], v15 offset:384
    s_waitcnt lgkmcnt(6)
    v_mfma_f32_16x16x32_bf16 v[16:19], v[208:211], v[48:51], v[16:19]
    ds_read_b64 v[40:41], v15 offset:2048
    v_mfma_f32_16x16x32_bf16 v[20:23], v[212:215], v[48:51], v[20:23]
    ds_read_b64 v[42:43], v15 offset:2304
    v_mfma_f32_16x16x32_bf16 v[24:27], v[208:211], v[52:55], v[24:27]
    ds_read_b64 v[44:45], v15 offset:2176
    v_mfma_f32_16x16x32_bf16 v[28:31], v[212:215], v[52:55], v[28:31]
    ds_read_b64 v[46:47], v15 offset:2432
    s_waitcnt lgkmcnt(8)
    v_mfma_f32_16x16x32_bf16 v[16:19], v[216:219], v[56:59], v[16:19]
    ds_read_b64 v[48:49], v15 offset:4096
    v_mfma_f32_16x16x32_bf16 v[20:23], v[220:223], v[56:59], v[20:23]
    ds_read_b64 v[50:51], v15 offset:4352
    v_mfma_f32_16x16x32_bf16 v[24:27], v[216:219], v[60:63], v[24:27]
    ds_read_b64 v[52:53], v15 offset:4224
    v_mfma_f32_16x16x32_bf16 v[28:31], v[220:223], v[60:63], v[28:31]
    ds_read_b64 v[54:55], v15 offset:4480
    s_waitcnt lgkmcnt(8)
    v_mfma_f32_16x16x32_bf16 v[16:19], v[224:227], v[32:35], v[16:19]
    ds_read_b64 v[56:57], v15 offset:6144
    v_mfma_f32_16x16x32_bf16 v[20:23], v[228:231], v[32:35], v[20:23]
    ds_read_b64 v[58:59], v15 offset:6400
    v_mfma_f32_16x16x32_bf16 v[24:27], v[224:227], v[36:39], v[24:27]
    ds_read_b64 v[60:61], v15 offset:6272
    v_mfma_f32_16x16x32_bf16 v[28:31], v[228:231], v[36:39], v[28:31]
    ds_read_b64 v[62:63], v15 offset:6528
    s_waitcnt lgkmcnt(8)
    v_mfma_f32_16x16x32_bf16 v[16:19], v[232:235], v[40:43], v[16:19]
    v_mfma_f32_16x16x32_bf16 v[20:23], v[236:239], v[40:43], v[20:23]
    v_mfma_f32_16x16x32_bf16 v[24:27], v[232:235], v[44:47], v[24:27]
    v_mfma_f32_16x16x32_bf16 v[28:31], v[236:239], v[44:47], v[28:31]
    s_waitcnt lgkmcnt(4)
    v_mfma_f32_16x16x32_bf16 v[16:19], v[240:243], v[48:51], v[16:19]
    v_mfma_f32_16x16x32_bf16 v[20:23], v[244:247], v[48:51], v[20:23]
    ds_read_b128 v[32:35], v13 offset:0
    v_mfma_f32_16x16x32_bf16 v[24:27], v[240:243], v[52:55], v[24:27]
    ds_read_b128 v[36:39], v13 offset:256
    v_mfma_f32_16x16x32_bf16 v[28:31], v[244:247], v[52:55], v[28:31]
    s_waitcnt lgkmcnt(2)
    v_mfma_f32_16x16x32_bf16 v[16:19], v[248:251], v[56:59], v[16:19]
    v_mfma_f32_16x16x32_bf16 v[20:23], v[252:255], v[56:59], v[20:23]
    v_mfma_f32_16x16x32_bf16 v[24:27], v[248:251], v[60:63], v[24:27]
    v_mfma_f32_16x16x32_bf16 v[28:31], v[252:255], v[60:63], v[28:31]
    v_add_u32 v14, 47616, v14
    v_add_u32 v15, 47616, v15
    s_waitcnt lgkmcnt(0)
    s_buffer_load_dwordx8 s[32:39], s[4:7], s40 glc
    s_nop 0
    v_fmac_f32 v16, v64, v32
    v_fmac_f32 v17, v65, v32
    v_fmac_f32 v18, v66, v32
    v_fmac_f32 v19, v67, v32
    v_fmac_f32 v20, v68, v32
    v_fmac_f32 v21, v69, v32
    v_fmac_f32 v22, v70, v32
    v_fmac_f32 v23, v71, v32
    v_fma_f32 v16, v16, v34, v72
    v_fma_f32 v17, v17, v34, v73
    v_fma_f32 v18, v18, v34, v74
    v_fma_f32 v19, v19, v34, v75
    v_fma_f32 v20, v20, v34, v76
    v_fma_f32 v21, v21, v34, v77
    v_fma_f32 v22, v22, v34, v78
    v_fma_f32 v23, v23, v34, v79
    v_cvt_pk_bf16_f32 v40, v16, v17
    v_cvt_pk_bf16_f32 v41, v18, v19
    v_cvt_pk_bf16_f32 v42, v20, v21
    v_cvt_pk_bf16_f32 v43, v22, v23
    v_pk_max_i16 v40, v40, 0
    v_pk_max_i16 v41, v41, 0
    v_pk_max_i16 v42, v42, 0
    v_pk_max_i16 v43, v43, 0
    buffer_store_dwordx4 v[40:43], v14, s[4:7], s63 offen offset:0 sc1
    v_fmac_f32 v24, v64, v36
    v_fmac_f32 v25, v65, v36
    v_fmac_f32 v26, v66, v36
    v_fmac_f32 v27, v67, v36
    v_fmac_f32 v28, v68, v36
    v_fmac_f32 v29, v69, v36
    v_fmac_f32 v30, v70, v36
    v_fmac_f32 v31, v71, v36
    v_fma_f32 v24, v24, v38, v72
    v_fma_f32 v25, v25, v38, v73
    v_fma_f32 v26, v26, v38, v74
    v_fma_f32 v27, v27, v38, v75
    v_fma_f32 v28, v28, v38, v76
    v_fma_f32 v29, v29, v38, v77
    v_fma_f32 v30, v30, v38, v78
    v_fma_f32 v31, v31, v38, v79
    v_cvt_pk_bf16_f32 v44, v24, v25
    v_cvt_pk_bf16_f32 v45, v26, v27
    v_cvt_pk_bf16_f32 v46, v28, v29
    v_cvt_pk_bf16_f32 v47, v30, v31
    v_pk_max_i16 v44, v44, 0
    v_pk_max_i16 v45, v45, 0
    v_pk_max_i16 v46, v46, 0
    v_pk_max_i16 v47, v47, 0
    buffer_store_dwordx4 v[44:47], v14, s[4:7], s63 offen offset:256 sc1
    s_mul_i32 s60, s84, 1536
    s_add_u32 s60, s60, 108032
    v_add_u32 v48, s60, v1
    v_lshl_add_u32 v49, v0, 3, s60
    ds_read_b128 v[2:5], v48
    ds_read_b64 v[6:7], v49 offset:1024
    s_lshl_b32 s60, s80, 7
    s_add_u32 s60, s60, 262144
    s_mul_i32 s68, s56, 81920
    s_lshl_b32 s61, s84, 10
    s_add_u32 s68, s68, s61
    s_add_u32 s68, s68, 16293888
    s_add_u32 m0, s61, 114688
    s_lshl_b32 s61, s56, 13
    s_add_u32 s61, s61, 1314816
    s_waitcnt lgkmcnt(0)
    s_cmp_lg_u64 s[32:33], s[28:29]
    s_cbranch_scc1 L_ys_260
    s_cmp_lg_u64 s[34:35], s[28:29]
    s_cbranch_scc1 L_ys_260
    s_cmp_lg_u64 s[36:37], s[28:29]
    s_cbranch_scc1 L_ys_260
    s_cmp_lg_u64 s[38:39], s[28:29]
    s_cbranch_scc1 L_ys_260
    s_branch L_yo_261
L_ys_260:
L_gs_262:
    ds_read_b32 v9, v11
    s_sub_i32 s66, s66, 1
    s_cmp_lt_i32 s66, 0
    s_waitcnt lgkmcnt(0)
    s_cbranch_scc1 L_gsd_263
    v_cmp_gt_u32 vcc, 31, v9
    s_nop 0
    s_and_b32 vcc_lo, vcc_lo, 0x0f
    s_cbranch_scc1 L_gs_262
L_gsd_263:
L_sp_264:
    s_buffer_load_dwordx8 s[32:39], s[4:7], s40 glc
    s_sub_i32 s66, s66, 4
    s_cmp_lt_i32 s66, 0
    s_waitcnt lgkmcnt(0)
    s_cbranch_scc1 L_spd_265
    s_cmp_lg_u64 s[32:33], s[28:29]
    s_cbranch_scc1 L_sp_264
    s_cmp_lg_u64 s[34:35], s[28:29]
    s_cbranch_scc1 L_sp_264
    s_cmp_lg_u64 s[36:37], s[28:29]
    s_cbranch_scc1 L_sp_264
    s_cmp_lg_u64 s[38:39], s[28:29]
    s_cbranch_scc1 L_sp_264
L_spd_265:
L_yo_261:
    v_mov_b32 v8, 35
    ds_write_b32 v10, v8
L_gs_266:
    ds_read_b32 v9, v11
    s_sub_i32 s66, s66, 1
    s_cmp_lt_i32 s66, 0
    s_waitcnt lgkmcnt(0)
    s_cbranch_scc1 L_gsd_267
    v_cmp_gt_u32 vcc, 35, v9
    s_nop 0
    s_and_b32 vcc_lo, vcc_lo, 0xf0
    s_cbranch_scc1 L_gs_266
L_gsd_267:
    s_cmp_lg_u32 s31, 7
    s_cbranch_scc1 L_n7_258
    buffer_load_dwordx4 v[16:19], v1, s[4:7], s61 offen offset:0 sc1
    buffer_load_dwordx4 v[20:23], v1, s[4:7], s61 offen offset:1024 sc1
    buffer_load_dwordx4 v[24:27], v1, s[4:7], s61 offen offset:2048 sc1
    buffer_load_dwordx4 v[28:31], v1, s[4:7], s61 offen offset:3072 sc1
L_n7_258:
    buffer_load_dwordx4 v1, s[4:7], s68 offen sc1 lds
    s_add_u32 m0, m0, 4096
    s_add_u32 s68, s68, 4096
    buffer_load_dwordx4 v1, s[4:7], s68 offen sc1 lds
    s_add_u32 m0, m0, 4096
    s_add_u32 s68, s68, 4096
    buffer_load_dwordx4 v1, s[4:7], s68 offen sc1 lds
    s_add_u32 m0, m0, 4096
    s_add_u32 s68, s68, 4096
    buffer_load_dwordx4 v1, s[4:7], s68 offen sc1 lds
    s_add_u32 m0, m0, 4096
    s_add_u32 s68, s68, 4096
    buffer_load_dwordx4 v1, s[4:7], s68 offen sc1 lds
    s_add_u32 m0, m0, 4096
    s_add_u32 s68, s68, 4096
    buffer_load_dwordx4 v1, s[4:7], s68 offen sc1 lds
    s_add_u32 m0, m0, 4096
    s_add_u32 s68, s68, 4096
    buffer_load_dwordx4 v1, s[4:7], s68 offen sc1 lds
    s_add_u32 m0, m0, 4096
    s_add_u32 s68, s68, 4096
    buffer_load_dwordx4 v1, s[4:7], s68 offen sc1 lds
    s_add_u32 m0, m0, 4096
    s_add_u32 s68, s68, 4096
    buffer_load_dwordx4 v1, s[4:7], s68 offen sc1 lds
    s_add_u32 m0, m0, 4096
    s_add_u32 s68, s68, 4096
    buffer_load_dwordx4 v1, s[4:7], s68 offen sc1 lds
    s_add_u32 m0, m0, 4096
    s_add_u32 s68, s68, 4096
    s_waitcnt vmcnt(7)
    v_mov_b32 v8, 42
    ds_write_b32 v10, v8
    s_cmp_lg_u32 s31, 7
    s_cbranch_scc1 L_n8_259
    v_add_f32 v16, v16, v20
    v_add_f32 v17, v17, v21
    v_add_f32 v18, v18, v22
    v_add_f32 v19, v19, v23
    v_add_f32 v24, v24, v28
    v_add_f32 v25, v25, v29
    v_add_f32 v26, v26, v30
    v_add_f32 v27, v27, v31
    v_permlane32_swap_b32 v16, v24
    v_permlane32_swap_b32 v17, v25
    v_permlane32_swap_b32 v18, v26
    v_permlane32_swap_b32 v19, v27
    v_add_f32 v16, v16, v24
    v_add_f32 v17, v17, v25
    v_add_f32 v18, v18, v26
    v_add_f32 v19, v19, v27
    v_and_b32 v24, 7, v0
    v_lshlrev_b32 v24, 5, v24
    v_permlane16_swap_b32 v16, v18
    v_permlane16_swap_b32 v17, v19
    v_add_f32 v16, v16, v18
    v_add_f32 v17, v17, v19
    v_and_b32 v25, 16, v0
    v_add_u32 v24, v24, v25
    v_add_f32_dpp v16, v16, v16 row_ror:8 row_mask:0xf bank_mask:0xf
    v_add_f32_dpp v17, v17, v17 row_ror:8 row_mask:0xf bank_mask:0xf
    v_and_b32 v25, 32, v0
    v_lshl_add_u32 v24, v25, 3, v24
    v_mul_f32 v16, 0xbacccccd, v16
    v_mul_f32 v17, 0x3acccccd, v17
    v_fma_f32 v17, -v16, v16, v17
    v_max_f32 v17, 0, v17
    v_add_f32 v17, 0x3727c5ac, v17
    v_rsq_f32 v18, v17
    v_add_u32 v24, 158144, v24
    ds_write_b128 v24, v[16:19]
L_n8_259:
L_gs_268:
    ds_read_b32 v9, v11
    s_sub_i32 s66, s66, 1
    s_cmp_lt_i32 s66, 0
    s_waitcnt lgkmcnt(0)
    s_cbranch_scc1 L_gsd_269
    v_cmp_gt_u32 vcc, 42, v9
    s_nop 0
    s_and_b32 vcc_lo, vcc_lo, 0xf0
    s_cbranch_scc1 L_gs_268
L_gsd_269:
    s_setprio 1
    ds_read_b128 v[32:35], v14 offset:0
    ds_read_b128 v[36:39], v14 offset:256
    ds_read_b128 v[40:43], v14 offset:2048
    ds_read_b128 v[44:47], v14 offset:2304
    ds_read_b128 v[48:51], v14 offset:4096
    ds_read_b128 v[52:55], v14 offset:4352
    s_waitcnt lgkmcnt(4)
    v_mfma_f32_16x16x32_bf16 v[16:19], v[96:99], v[32:35], 0
    ds_read_b128 v[56:59], v14 offset:6144
    v_mfma_f32_16x16x32_bf16 v[20:23], v[100:103], v[32:35], 0
    ds_read_b128 v[60:63], v14 offset:6400
    v_mfma_f32_16x16x32_bf16 v[24:27], v[96:99], v[36:39], 0
    v_mfma_f32_16x16x32_bf16 v[28:31], v[100:103], v[36:39], 0
    s_waitcnt vmcnt(0)
    v_mov_b32 v8, 43
    ds_write_b32 v10, v8
    s_waitcnt lgkmcnt(5)
    v_mfma_f32_16x16x32_bf16 v[16:19], v[104:107], v[40:43], v[16:19]
    ds_read_b128 v[32:35], v14 offset:8192
    v_mfma_f32_16x16x32_bf16 v[20:23], v[108:111], v[40:43], v[20:23]
    ds_read_b128 v[36:39], v14 offset:8448
    buffer_load_dwordx4 v[96:99], v1, s[4:7], s71 offen offset:2048 sc1
    v_mfma_f32_16x16x32_bf16 v[24:27], v[104:107], v[44:47], v[24:27]
    v_mfma_f32_16x16x32_bf16 v[28:31], v[108:111], v[44:47], v[28:31]
    ds_read_b32 v9, v11
    s_waitcnt lgkmcnt(6)
    v_mfma_f32_16x16x32_bf16 v[16:19], v[112:115], v[48:51], v[16:19]
    ds_read_b128 v[40:43], v14 offset:10240
    v_mfma_f32_16x16x32_bf16 v[20:23], v[116:119], v[48:51], v[20:23]
    ds_read_b128 v[44:47], v14 offset:10496
    buffer_load_dwordx4 v[100:103], v1, s[4:7], s72 offen offset:2048 sc1
    v_mfma_f32_16x16x32_bf16 v[24:27], v[112:115], v[52:55], v[24:27]
    v_mfma_f32_16x16x32_bf16 v[28:31], v[116:119], v[52:55], v[28:31]
    s_waitcnt lgkmcnt(6)
    v_mfma_f32_16x16x32_bf16 v[16:19], v[120:123], v[56:59], v[16:19]
    s_waitcnt lgkmcnt(2)
    v_cmp_gt_u32 vcc, 43, v9
    s_nop 0
    s_and_b32 vcc_lo, vcc_lo, 0xf0
    s_cbranch_scc1 L_ck_270
L_cko_271:
    v_mfma_f32_16x16x32_bf16 v[20:23], v[124:127], v[56:59], v[20:23]
    ds_read_b128 v[48:51], v14 offset:12288
    buffer_load_dwordx4 v[104:107], v1, s[4:7], s71 offen offset:3072 sc1
    v_mfma_f32_16x16x32_bf16 v[24:27], v[120:123], v[60:63], v[24:27]
    ds_read_b128 v[52:55], v14 offset:12544
    v_mfma_f32_16x16x32_bf16 v[28:31], v[124:127], v[60:63], v[28:31]
    v_mfma_f32_16x16x32_bf16 v[16:19], v[128:131], v[32:35], v[16:19]
    ds_read_b128 v[56:59], v14 offset:14336
    v_mfma_f32_16x16x32_bf16 v[20:23], v[132:135], v[32:35], v[20:23]
    ds_read_b128 v[60:63], v14 offset:14592
    buffer_load_dwordx4 v[108:111], v1, s[4:7], s72 offen offset:3072 sc1
    v_mfma_f32_16x16x32_bf16 v[24:27], v[128:131], v[36:39], v[24:27]
    v_mfma_f32_16x16x32_bf16 v[28:31], v[132:135], v[36:39], v[28:31]
    s_waitcnt lgkmcnt(4)
    v_mfma_f32_16x16x32_bf16 v[16:19], v[136:139], v[40:43], v[16:19]
    ds_read_b128 v[32:35], v14 offset:16384
    v_mfma_f32_16x16x32_bf16 v[20:23], v[140:143], v[40:43], v[20:23]
    ds_read_b128 v[36:39], v14 offset:16640
    s_add_u32 s71, s71, 4096
    v_mfma_f32_16x16x32_bf16 v[24:27], v[136:139], v[44:47], v[24:27]
    buffer_load_dwordx4 v[112:115], v1, s[4:7], s71 offen offset:0 sc1
    v_mfma_f32_16x16x32_bf16 v[28:31], v[140:143], v[44:47], v[28:31]
    s_waitcnt lgkmcnt(4)
    v_mfma_f32_16x16x32_bf16 v[16:19], v[144:147], v[48:51], v[16:19]
    ds_read_b128 v[40:43], v14 offset:18432
    v_mfma_f32_16x16x32_bf16 v[20:23], v[148:151], v[48:51], v[20:23]
    ds_read_b128 v[44:47], v14 offset:18688
    s_add_u32 s72, s72, 4096
    v_mfma_f32_16x16x32_bf16 v[24:27], v[144:147], v[52:55], v[24:27]
    buffer_load_dwordx4 v[116:119], v1, s[4:7], s72 offen offset:0 sc1
    v_mfma_f32_16x16x32_bf16 v[28:31], v[148:151], v[52:55], v[28:31]
    s_waitcnt lgkmcnt(4)
    v_mfma_f32_16x16x32_bf16 v[16:19], v[152:155], v[56:59], v[16:19]
    ds_read_b128 v[48:51], v14 offset:20480
    v_mfma_f32_16x16x32_bf16 v[20:23], v[156:159], v[56:59], v[20:23]
    ds_read_b128 v[52:55], v14 offset:20736
    buffer_load_dwordx4 v[120:123], v1, s[4:7], s71 offen offset:1024 sc1
    v_mfma_f32_16x16x32_bf16 v[24:27], v[152:155], v[60:63], v[24:27]
    v_mfma_f32_16x16x32_bf16 v[28:31], v[156:159], v[60:63], v[28:31]
    s_waitcnt lgkmcnt(4)
    v_mfma_f32_16x16x32_bf16 v[16:19], v[160:163], v[32:35], v[16:19]
    ds_read_b128 v[56:59], v14 offset:22528
    v_mfma_f32_16x16x32_bf16 v[20:23], v[164:167], v[32:35], v[20:23]
    ds_read_b128 v[60:63], v14 offset:22784
    buffer_load_dwordx4 v[124:127], v1, s[4:7], s72 offen offset:1024 sc1
    v_mfma_f32_16x16x32_bf16 v[24:27], v[160:163], v[36:39], v[24:27]
    v_mfma_f32_16x16x32_bf16 v[28:31], v[164:167], v[36:39], v[28:31]
    s_waitcnt lgkmcnt(4)
    v_mfma_f32_16x16x32_bf16 v[16:19], v[168:171], v[40:43], v[16:19]
    ds_read_b128 v[32:35], v14 offset:24576
    v_mfma_f32_16x16x32_bf16 v[20:23], v[172:175], v[40:43], v[20:23]
    ds_read_b128 v[36:39], v14 offset:24832
    buffer_load_dwordx4 v[128:131], v1, s[4:7], s71 offen offset:2048 sc1
    v_mfma_f32_16x16x32_bf16 v[24:27], v[168:171], v[44:47], v[24:27]
    v_mfma_f32_16x16x32_bf16 v[28:31], v[172:175], v[44:47], v[28:31]
    s_waitcnt lgkmcnt(4)
    v_mfma_f32_16x16x32_bf16 v[16:19], v[176:179], v[48:51], v[16:19]
    ds_read_b128 v[40:43], v14 offset:26624
    v_mfma_f32_16x16x32_bf16 v[20:23], v[180:183], v[48:51], v[20:23]
    ds_read_b128 v[44:47], v14 offset:26880
    buffer_load_dwordx4 v[132:135], v1, s[4:7], s72 offen offset:2048 sc1
    v_mfma_f32_16x16x32_bf16 v[24:27], v[176:179], v[52:55], v[24:27]
    v_mfma_f32_16x16x32_bf16 v[28:31], v[180:183], v[52:55], v[28:31]
    ds_read_b32 v9, v11
    s_waitcnt lgkmcnt(5)
    v_mfma_f32_16x16x32_bf16 v[16:19], v[184:187], v[56:59], v[16:19]
    ds_read_b128 v[48:51], v14 offset:28672
    v_mfma_f32_16x16x32_bf16 v[20:23], v[188:191], v[56:59], v[20:23]
    ds_read_b128 v[52:55], v14 offset:28928
    buffer_load_dwordx4 v[136:139], v1, s[4:7], s71 offen offset:3072 sc1
    v_mfma_f32_16x16x32_bf16 v[24:27], v[184:187], v[60:63], v[24:27]
    v_mfma_f32_16x16x32_bf16 v[28:31], v[188:191], v[60:63], v[28:31]
    s_waitcnt lgkmcnt(5)
    v_mfma_f32_16x16x32_bf16 v[16:19], v[192:195], v[32:35], v[16:19]
    s_waitcnt lgkmcnt(2)
    v_cmp_gt_u32 vcc, 33, v9
    s_nop 0
    s_and_b32 vcc_lo, vcc_lo, 8
    s_cbranch_scc1 L_ck_272
L_cko_273:
    v_mfma_f32_16x16x32_bf16 v[20:23], v[196:199], v[32:35], v[20:23]
    ds_read_b128 v[56:59], v14 offset:30720
    buffer_load_dwordx4 v[140:143], v1, s[4:7], s72 offen offset:3072 sc1
    v_mfma_f32_16x16x32_bf16 v[24:27], v[192:195], v[36:39], v[24:27]
    ds_read_b128 v[60:63], v14 offset:30976
    v_mfma_f32_16x16x32_bf16 v[28:31], v[196:199], v[36:39], v[28:31]
    v_mfma_f32_16x16x32_bf16 v[16:19], v[200:203], v[40:43], v[16:19]
    ds_read_b64 v[32:33], v15 offset:0
    v_mfma_f32_16x16x32_bf16 v[20:23], v[204:207], v[40:43], v[20:23]
    ds_read_b64 v[34:35], v15 offset:256
    s_add_u32 s71, s71, 4096
    v_mfma_f32_16x16x32_bf16 v[24:27], v[200:203], v[44:47], v[24:27]
    ds_read_b64 v[36:37], v15 offset:128
    buffer_load_dwordx4 v[144:147], v1, s[4:7], s71 offen offset:0 sc1
    v_mfma_f32_16x16x32_bf16 v[28:31], v[204:207], v[44:47], v[28:31]
    ds_read_b64 v[38:39], v15 offset:384
    ds_read_b128 v[192:195], v12 offset:0
    s_waitcnt lgkmcnt(7)
    v_mfma_f32_16x16x32_bf16 v[16:19], v[208:211], v[48:51], v[16:19]
    ds_read_b64 v[40:41], v15 offset:2048
    v_mfma_f32_16x16x32_bf16 v[20:23], v[212:215], v[48:51], v[20:23]
    ds_read_b64 v[42:43], v15 offset:2304
    ds_read_b128 v[196:199], v12 offset:1024
    v_mfma_f32_16x16x32_bf16 v[24:27], v[208:211], v[52:55], v[24:27]
    ds_read_b64 v[44:45], v15 offset:2176
    s_add_u32 s72, s72, 4096
    v_mfma_f32_16x16x32_bf16 v[28:31], v[212:215], v[52:55], v[28:31]
    ds_read_b64 v[46:47], v15 offset:2432
    buffer_load_dwordx4 v[148:151], v1, s[4:7], s72 offen offset:0 sc1
    s_waitcnt lgkmcnt(10)
    v_mfma_f32_16x16x32_bf16 v[16:19], v[216:219], v[56:59], v[16:19]
    ds_read_b64 v[48:49], v15 offset:4096
    v_mfma_f32_16x16x32_bf16 v[20:23], v[220:223], v[56:59], v[20:23]
    ds_read_b64 v[50:51], v15 offset:4352
    ds_read_b128 v[200:203], v12 offset:2048
    v_mfma_f32_16x16x32_bf16 v[24:27], v[216:219], v[60:63], v[24:27]
    ds_read_b64 v[52:53], v15 offset:4224
    ds_read_b128 v[204:207], v12 offset:3072
    v_mfma_f32_16x16x32_bf16 v[28:31], v[220:223], v[60:63], v[28:31]
    ds_read_b64 v[54:55], v15 offset:4480
    buffer_load_dwordx4 v[152:155], v1, s[4:7], s71 offen offset:1024 sc1
    s_waitcnt lgkmcnt(12)
    v_mfma_f32_16x16x32_bf16 v[16:19], v[224:227], v[32:35], v[16:19]
    ds_read_b64 v[56:57], v15 offset:6144
    v_mfma_f32_16x16x32_bf16 v[20:23], v[228:231], v[32:35], v[20:23]
    ds_read_b64 v[58:59], v15 offset:6400
    ds_read_b128 v[208:211], v12 offset:4096
    v_mfma_f32_16x16x32_bf16 v[24:27], v[224:227], v[36:39], v[24:27]
    ds_read_b64 v[60:61], v15 offset:6272
    ds_read_b128 v[212:215], v12 offset:5120
    v_mfma_f32_16x16x32_bf16 v[28:31], v[228:231], v[36:39], v[28:31]
    ds_read_b64 v[62:63], v15 offset:6528
    buffer_load_dwordx4 v[156:159], v1, s[4:7], s72 offen offset:1024 sc1
    s_waitcnt lgkmcnt(12)
    v_mfma_f32_16x16x32_bf16 v[16:19], v[232:235], v[40:43], v[16:19]
    v_mfma_f32_16x16x32_bf16 v[20:23], v[236:239], v[40:43], v[20:23]
    ds_read_b128 v[216:219], v12 offset:6144
    v_mfma_f32_16x16x32_bf16 v[24:27], v[232:235], v[44:47], v[24:27]
    ds_read_b128 v[220:223], v12 offset:7168
    v_mfma_f32_16x16x32_bf16 v[28:31], v[236:239], v[44:47], v[28:31]
    buffer_load_dwordx4 v[160:163], v1, s[4:7], s71 offen offset:2048 sc1
    s_waitcnt lgkmcnt(8)
    v_mfma_f32_16x16x32_bf16 v[16:19], v[240:243], v[48:51], v[16:19]
    v_mfma_f32_16x16x32_bf16 v[20:23], v[244:247], v[48:51], v[20:23]
    ds_read_b128 v[224:227], v12 offset:8192
    v_mfma_f32_16x16x32_bf16 v[24:27], v[240:243], v[52:55], v[24:27]
    ds_read_b128 v[228:231], v12 offset:9216
    v_mfma_f32_16x16x32_bf16 v[28:31], v[244:247], v[52:55], v[28:31]
    ds_read_b128 v[32:35], v13 offset:512
    s_waitcnt lgkmcnt(5)
    v_mfma_f32_16x16x32_bf16 v[16:19], v[248:251], v[56:59], v[16:19]
    v_mfma_f32_16x16x32_bf16 v[20:23], v[252:255], v[56:59], v[20:23]
    ds_read_b128 v[36:39], v13 offset:768
    v_mfma_f32_16x16x32_bf16 v[24:27], v[248:251], v[60:63], v[24:27]
    buffer_load_dwordx4 v[164:167], v1, s[4:7], s72 offen offset:2048 sc1
    v_mfma_f32_16x16x32_bf16 v[28:31], v[252:255], v[60:63], v[28:31]
    ds_read_b128 v[232:235], v12 offset:10240
    ds_read_b128 v[236:239], v12 offset:11264
    buffer_load_dwordx4 v[168:171], v1, s[4:7], s71 offen offset:3072 sc1
    ds_read_b128 v[240:243], v12 offset:12288
    ds_read_b128 v[244:247], v12 offset:13312
    buffer_load_dwordx4 v[172:175], v1, s[4:7], s72 offen offset:3072 sc1
    v_mov_b32 v8, 59
    ds_write_b32 v10, v8
    s_waitcnt lgkmcnt(5)
    v_fmac_f32 v16, v64, v32
    v_fmac_f32 v17, v65, v32
    v_fmac_f32 v18, v66, v32
    v_fmac_f32 v19, v67, v32
    v_fmac_f32 v20, v68, v32
    v_fmac_f32 v21, v69, v32
    v_fmac_f32 v22, v70, v32
    v_fmac_f32 v23, v71, v32
    v_fma_f32 v16, v16, v34, v72
    v_fma_f32 v17, v17, v34, v73
    v_fma_f32 v18, v18, v34, v74
    v_fma_f32 v19, v19, v34, v75
    v_fma_f32 v20, v20, v34, v76
    v_fma_f32 v21, v21, v34, v77
    v_fma_f32 v22, v22, v34, v78
    v_fma_f32 v23, v23, v34, v79
    v_cvt_pk_bf16_f32 v40, v16, v17
    v_cvt_pk_bf16_f32 v41, v18, v19
    v_cvt_pk_bf16_f32 v42, v20, v21
    v_cvt_pk_bf16_f32 v43, v22, v23
    v_pk_max_i16 v40, v40, 0
    v_pk_max_i16 v41, v41, 0
    v_pk_max_i16 v42, v42, 0
    v_pk_max_i16 v43, v43, 0
    buffer_store_dwordx4 v[40:43], v14, s[4:7], s64 offen offset:0 sc1
    v_fmac_f32 v24, v64, v36
    v_fmac_f32 v25, v65, v36
    v_fmac_f32 v26, v66, v36
    v_fmac_f32 v27, v67, v36
    v_fmac_f32 v28, v68, v36
    v_fmac_f32 v29, v69, v36
    v_fmac_f32 v30, v70, v36
    v_fmac_f32 v31, v71, v36
    v_fma_f32 v24, v24, v38, v72
    v_fma_f32 v25, v25, v38, v73
    v_fma_f32 v26, v26, v38, v74
    v_fma_f32 v27, v27, v38, v75
    v_fma_f32 v28, v28, v38, v76
    v_fma_f32 v29, v29, v38, v77
    v_fma_f32 v30, v30, v38, v78
    v_fma_f32 v31, v31, v38, v79
    v_cvt_pk_bf16_f32 v44, v24, v25
    v_cvt_pk_bf16_f32 v45, v26, v27
    v_cvt_pk_bf16_f32 v46, v28, v29
    v_cvt_pk_bf16_f32 v47, v30, v31
    v_pk_max_i16 v44, v44, 0
    v_pk_max_i16 v45, v45, 0
    v_pk_max_i16 v46, v46, 0
    v_pk_max_i16 v47, v47, 0
    buffer_store_dwordx4 v[44:47], v14, s[4:7], s64 offen offset:256 sc1
    s_branch L_f1join_197
L_ck_256:
L_gs_274:
    ds_read_b32 v9, v11
    s_sub_i32 s66, s66, 1
    s_cmp_lt_i32 s66, 0
    s_waitcnt lgkmcnt(0)
    s_cbranch_scc1 L_gsd_275
    v_cmp_gt_u32 vcc, 33, v9
    s_nop 0
    s_and_b32 vcc_lo, vcc_lo, 0xf0
    s_cbranch_scc1 L_gs_274
L_gsd_275:
    s_branch L_cko_257
L_ck_270:
L_gs_276:
    ds_read_b32 v9, v11
    s_sub_i32 s66, s66, 1
    s_cmp_lt_i32 s66, 0
    s_waitcnt lgkmcnt(0)
    s_cbranch_scc1 L_gsd_277
    v_cmp_gt_u32 vcc, 43, v9
    s_nop 0
    s_and_b32 vcc_lo, vcc_lo, 0xf0
    s_cbranch_scc1 L_gs_276
L_gsd_277:
    s_branch L_cko_271
L_ck_272:
L_gs_278:
    ds_read_b32 v9, v11
    s_sub_i32 s66, s66, 1
    s_cmp_lt_i32 s66, 0
    s_waitcnt lgkmcnt(0)
    s_cbranch_scc1 L_gsd_279
    v_cmp_gt_u32 vcc, 33, v9
    s_nop 0
    s_and_b32 vcc_lo, vcc_lo, 8
    s_cbranch_scc1 L_gs_278
L_gsd_279:
    s_branch L_cko_273
L_f1join_197:
    v_and_b32 v12, 15, v0
    v_lshrrev_b32 v13, 4, v0
    s_lshl_b32 s69, s84, 11
    s_lshl_b32 s60, s85, 8
    s_add_u32 s60, s60, s69
    s_add_u32 s60, s60, 57344
    v_lshlrev_b32 v14, 9, v13
    v_lshl_add_u32 v14, v12, 4, v14
    v_add_u32 v14, s60, v14
    v_xor_b32 v15, 256, v14
    s_mul_i32 s60, s84, 10240
    s_mul_i32 s61, s85, 5120
    s_add_u32 s60, s60, s61
    s_add_u32 s60, s60, 114688
    v_add_u32 v12, s60, v1
    s_mul_i32 s68, s56, 221184
    s_lshl_b32 s61, s70, 11
    s_add_u32 s68, s68, s61
    s_add_u32 s68, s68, 18874368
    s_add_u32 s63, s81, 32768
    s_cmp_eq_u32 s85, 0
    s_cbranch_scc1 L_f2f_280
    s_setprio 1
    s_cmp_lt_u32 s84, 2
    s_cselect_b32 s75, 2048, 0
    s_add_u32 s76, s68, 110592
L_gs_282:
    ds_read_b32 v9, v11
    s_sub_i32 s66, s66, 1
    s_cmp_lt_i32 s66, 0
    s_waitcnt lgkmcnt(0)
    s_cbranch_scc1 L_gsd_283
    v_cmp_gt_u32 vcc, 37, v9
    s_nop 0
    s_and_b32 vcc_lo, vcc_lo, 8
    s_cbranch_scc1 L_gs_282
L_gsd_283:
    s_add_u32 m0, s69, 57344
    s_nop 0
    buffer_load_dwordx4 v1, s[4:7], s68 offen offset:0 sc1 lds
    buffer_load_dwordx4 v1, s[4:7], s68 offen offset:1024 sc1 lds
    s_add_u32 m0, s69, 65536
    s_add_u32 s68, s68, 2048
    buffer_load_dwordx4 v1, s[4:7], s68 offen offset:0 sc1 lds
    buffer_load_dwordx4 v1, s[4:7], s68 offen offset:1024 sc1 lds
    s_waitcnt vmcnt(4)
    v_mov_b32 v8, 60
    ds_write_b32 v10, v8
    s_add_u32 m0, s69, 73728
    s_add_u32 s68, s68, 2048
    buffer_load_dwordx4 v1, s[4:7], s68 offen offset:0 sc1 lds
    buffer_load_dwordx4 v1, s[4:7], s68 offen offset:1024 sc1 lds
    s_add_u32 m0, s69, 81920
    s_add_u32 s68, s68, 2048
    buffer_load_dwordx4 v1, s[4:7], s68 offen offset:0 sc1 lds
    buffer_load_dwordx4 v1, s[4:7], s68 offen offset:1024 sc1 lds
L_gs_284:
    ds_read_b32 v9, v11
    s_sub_i32 s66, s66, 1
    s_cmp_lt_i32 s66, 0
    s_waitcnt lgkmcnt(0)
    s_cbranch_scc1 L_gsd_285
    v_cmp_gt_u32 vcc, 59, v9
    s_nop 0
    s_and_b32 vcc_lo, vcc_lo, 0x0f
    s_cbranch_scc1 L_gs_284
L_gsd_285:
    s_add_u32 m0, s69, 90112
    s_add_u32 s68, s68, 2048
    buffer_load_dwordx4 v1, s[4:7], s68 offen offset:0 sc1 lds
    buffer_load_dwordx4 v1, s[4:7], s68 offen offset:1024 sc1 lds
    s_add_u32 m0, s69, 98304
    s_add_u32 s68, s68, 2048
    buffer_load_dwordx4 v1, s[4:7], s68 offen offset:0 sc1 lds
    buffer_load_dwordx4 v1, s[4:7], s68 offen offset:1024 sc1 lds
    s_add_u32 m0, s69, 106496
    s_add_u32 s68, s68, 2048
    buffer_load_dwordx4 v1, s[4:7], s68 offen offset:0 sc1 lds
    buffer_load_dwordx4 v1, s[4:7], s68 offen offset:1024 sc1 lds
    s_add_u32 s71, s71, 4096
    buffer_load_dwordx4 v[176:179], v1, s[4:7], s71 offen offset:0 sc1
    s_add_u32 s72, s72, 4096
    buffer_load_dwordx4 v[180:183], v1, s[4:7], s72 offen offset:0 sc1
    buffer_load_dwordx4 v[184:187], v1, s[4:7], s71 offen offset:1024 sc1
    buffer_load_dwordx4 v[188:191], v1, s[4:7], s72 offen offset:1024 sc1
    s_lshr_b32 s60, s84, 1
    s_and_b32 s61, s84, 1
    s_xor_b32 s62, s60, s61
    s_lshl_b32 s62, s62, 11
    s_mul_i32 s78, s60, 5120
    s_add_u32 s78, s78, s62
    s_mul_i32 s79, s61, 5120
    s_add_u32 s79, s79, 4096
    s_xor_b32 s62, s85, 1
    s_lshl_b32 s64, s56, 1
    s_add_u32 s64, s64, s62
    s_lshl_b32 s64, s64, 1
    s_and_b32 s65, s84, 1
    s_add_u32 s64, s64, s65
    s_lshl_b32 s64, s64, 4
    s_lshr_b32 s65, s84, 1
    s_lshl_b32 s65, s65, 6
    s_mul_i32 s64, s64, 1280
    s_mul_i32 s60, s57, 160
    s_add_u32 s64, s64, s60
    s_mul_i32 s60, s85, 57344
    s_add_u32 s60, s60, 57344
    s_add_u32 s78, s78, s60
    s_add_u32 s79, s79, s60
    s_waitcnt vmcnt(10)
    v_mov_b32 v8, 68
    ds_write_b32 v10, v8
L_gs_286:
    ds_read_b32 v9, v11
    s_sub_i32 s66, s66, 1
    s_cmp_lt_i32 s66, 0
    s_waitcnt lgkmcnt(0)
    s_cbranch_scc1 L_gsd_287
    v_cmp_gt_u32 vcc, 59, v9
    s_nop 0
    s_and_b32 vcc_lo, vcc_lo, 0xff
    s_cbranch_scc1 L_gs_286
L_gsd_287:
    ds_read_b128 v[56:59], v14 offset:0
    ds_read_b128 v[60:63], v15 offset:0
    ds_read_b128 v[64:67], v14 offset:8192
    ds_read_b128 v[68:71], v15 offset:8192
    s_waitcnt lgkmcnt(2)
    v_mfma_f32_16x16x32_bf16 v[16:19], v[80:83], v[56:59], 0
    v_mfma_f32_16x16x32_bf16 v[20:23], v[84:87], v[56:59], 0
    ds_read_b128 v[72:75], v14 offset:16384
    s_add_u32 m0, s69, 0
    v_mfma_f32_16x16x32_bf16 v[32:35], v[192:195], v[56:59], 0
    ds_read_b128 v[76:79], v15 offset:16384
    s_add_u32 s68, s68, 2048
    v_mfma_f32_16x16x32_bf16 v[24:27], v[80:83], v[60:63], 0
    buffer_load_dwordx4 v1, s[4:7], s68 offen offset:0 sc1 lds
    buffer_load_dwordx4 v1, s[4:7], s68 offen offset:1024 sc1 lds
    v_mfma_f32_16x16x32_bf16 v[28:31], v[84:87], v[60:63], 0
    s_waitcnt lgkmcnt(2)
    v_mfma_f32_16x16x32_bf16 v[16:19], v[88:91], v[64:67], v[16:19]
    s_waitcnt vmcnt(10)
    v_mfma_f32_16x16x32_bf16 v[20:23], v[92:95], v[64:67], v[20:23]
    ds_read_b128 v[56:59], v14 offset:24576
    s_add_u32 m0, s69, 8192
    v_mfma_f32_16x16x32_bf16 v[32:35], v[196:199], v[64:67], v[32:35]
    ds_read_b128 v[60:63], v15 offset:24576
    s_add_u32 s68, s68, 2048
    v_mfma_f32_16x16x32_bf16 v[24:27], v[88:91], v[68:71], v[24:27]
    buffer_load_dwordx4 v1, s[4:7], s68 offen offset:0 sc1 lds
    buffer_load_dwordx4 v1, s[4:7], s68 offen offset:1024 sc1 lds
    v_mfma_f32_16x16x32_bf16 v[28:31], v[92:95], v[68:71], v[28:31]
    s_waitcnt lgkmcnt(2)
    v_mfma_f32_16x16x32_bf16 v[16:19], v[96:99], v[72:75], v[16:19]
    s_waitcnt vmcnt(10)
    v_mov_b32 v8, 70
    ds_write_b32 v10, v8
    v_mfma_f32_16x16x32_bf16 v[20:23], v[100:103], v[72:75], v[20:23]
    ds_read_b128 v[64:67], v14 offset:32768
    s_add_u32 m0, s69, 16384
    v_mfma_f32_16x16x32_bf16 v[32:35], v[200:203], v[72:75], v[32:35]
    ds_read_b128 v[68:71], v15 offset:32768
    s_add_u32 s68, s68, 2048
    v_mfma_f32_16x16x32_bf16 v[24:27], v[96:99], v[76:79], v[24:27]
    buffer_load_dwordx4 v1, s[4:7], s68 offen offset:0 sc1 lds
    buffer_load_dwordx4 v1, s[4:7], s68 offen offset:1024 sc1 lds
    v_mfma_f32_16x16x32_bf16 v[28:31], v[100:103], v[76:79], v[28:31]
    s_waitcnt lgkmcnt(3)
    v_mfma_f32_16x16x32_bf16 v[16:19], v[104:107], v[56:59], v[16:19]
    s_waitcnt vmcnt(10)
    v_mfma_f32_16x16x32_bf16 v[20:23], v[108:111], v[56:59], v[20:23]
    ds_read_b128 v[72:75], v14 offset:40960
    s_add_u32 m0, s69, 24576
    v_mfma_f32_16x16x32_bf16 v[32:35], v[204:207], v[56:59], v[32:35]
    ds_read_b128 v[76:79], v15 offset:40960
    s_add_u32 s68, s68, 2048
    v_mfma_f32_16x16x32_bf16 v[24:27], v[104:107], v[60:63], v[24:27]
    buffer_load_dwordx4 v1, s[4:7], s68 offen offset:0 sc1 lds
    buffer_load_dwordx4 v1, s[4:7], s68 offen offset:1024 sc1 lds
    v_mfma_f32_16x16x32_bf16 v[28:31], v[108:111], v[60:63], v[28:31]
    s_waitcnt lgkmcnt(2)
    v_mfma_f32_16x16x32_bf16 v[16:19], v[112:115], v[64:67], v[16:19]
    s_waitcnt vmcnt(6)
    v_mov_b32 v8, 72
    ds_write_b32 v10, v8
    v_mfma_f32_16x16x32_bf16 v[20:23], v[116:119], v[64:67], v[20:23]
    ds_read_b128 v[56:59], v14 offset:49152
    s_add_u32 m0, s69, 32768
    v_mfma_f32_16x16x32_bf16 v[32:35], v[208:211], v[64:67], v[32:35]
    ds_read_b128 v[60:63], v15 offset:49152
    s_add_u32 s68, s68, 2048
    v_mfma_f32_16x16x32_bf16 v[24:27], v[112:115], v[68:71], v[24:27]
    buffer_load_dwordx4 v1, s[4:7], s68 offen offset:0 sc1 lds
    buffer_load_dwordx4 v1, s[4:7], s68 offen offset:1024 sc1 lds
    v_mfma_f32_16x16x32_bf16 v[28:31], v[116:119], v[68:71], v[28:31]
    s_waitcnt lgkmcnt(3)
    v_mfma_f32_16x16x32_bf16 v[16:19], v[120:123], v[72:75], v[16:19]
    v_add_u32 v14, 4294909952, v14
    v_add_u32 v15, 4294909952, v15
    s_waitcnt vmcnt(6)
    v_mfma_f32_16x16x32_bf16 v[20:23], v[124:127], v[72:75], v[20:23]
    ds_read_b128 v[64:67], v14 offset:0
    s_add_u32 m0, s69, 40960
    v_mfma_f32_16x16x32_bf16 v[32:35], v[212:215], v[72:75], v[32:35]
    ds_read_b128 v[68:71], v15 offset:0
    s_add_u32 s68, s68, 2048
    v_mfma_f32_16x16x32_bf16 v[24:27], v[120:123], v[76:79], v[24:27]
    buffer_load_dwordx4 v1, s[4:7], s68 offen offset:0 sc1 lds
    buffer_load_dwordx4 v1, s[4:7], s68 offen offset:1024 sc1 lds
    v_mfma_f32_16x16x32_bf16 v[28:31], v[124:127], v[76:79], v[28:31]
    ds_read_b32 v9, v11
    s_waitcnt lgkmcnt(3)
    v_mfma_f32_16x16x32_bf16 v[16:19], v[128:131], v[56:59], v[16:19]
    s_waitcnt vmcnt(6)
    v_mov_b32 v8, 74
    ds_write_b32 v10, v8
    v_mfma_f32_16x16x32_bf16 v[20:23], v[132:135], v[56:59], v[20:23]
    ds_read_b128 v[72:75], v14 offset:8192
    s_add_u32 m0, s69, 49152
    v_mfma_f32_16x16x32_bf16 v[32:35], v[216:219], v[56:59], v[32:35]
    ds_read_b128 v[76:79], v15 offset:8192
    s_add_u32 s68, s68, s75
    v_mfma_f32_16x16x32_bf16 v[24:27], v[128:131], v[60:63], v[24:27]
    buffer_load_dwordx4 v1, s[4:7], s68 offen offset:0 sc1 lds
    buffer_load_dwordx4 v1, s[4:7], s68 offen offset:1024 sc1 lds
    v_mfma_f32_16x16x32_bf16 v[28:31], v[132:135], v[60:63], v[28:31]
    s_or_b32 s62, s77, 8
    s_mov_b32 s68, s76
    s_waitcnt lgkmcnt(3)
    v_cmp_gt_u32 vcc, 68, v9
    s_nop 0
    s_and_b32 vcc_lo, vcc_lo, s62
    s_cbranch_scc1 L_ck_288
L_cko_289:
    v_mfma_f32_16x16x32_bf16 v[16:19], v[136:139], v[64:67], v[16:19]
    s_waitcnt vmcnt(6)
    v_mfma_f32_16x16x32_bf16 v[20:23], v[140:143], v[64:67], v[20:23]
    ds_read_b128 v[56:59], v14 offset:16384
    s_add_u32 m0, s69, 57344
    v_mfma_f32_16x16x32_bf16 v[32:35], v[220:223], v[64:67], v[32:35]
    ds_read_b128 v[60:63], v15 offset:16384
    s_nop 0
    v_mfma_f32_16x16x32_bf16 v[24:27], v[136:139], v[68:71], v[24:27]
    buffer_load_dwordx4 v1, s[4:7], s68 offen offset:0 sc1 lds
    buffer_load_dwordx4 v1, s[4:7], s68 offen offset:1024 sc1 lds
    v_mfma_f32_16x16x32_bf16 v[28:31], v[140:143], v[68:71], v[28:31]
    s_waitcnt lgkmcnt(2)
    v_mfma_f32_16x16x32_bf16 v[16:19], v[144:147], v[72:75], v[16:19]
    s_waitcnt vmcnt(6)
    v_mov_b32 v8, 76
    ds_write_b32 v10, v8
    v_mfma_f32_16x16x32_bf16 v[20:23], v[148:151], v[72:75], v[20:23]
    ds_read_b128 v[64:67], v14 offset:24576
    s_add_u32 m0, s69, 65536
    v_mfma_f32_16x16x32_bf16 v[32:35], v[224:227], v[72:75], v[32:35]
    ds_read_b128 v[68:71], v15 offset:24576
    s_add_u32 s68, s68, 2048
    v_mfma_f32_16x16x32_bf16 v[24:27], v[144:147], v[76:79], v[24:27]
    buffer_load_dwordx4 v1, s[4:7], s68 offen offset:0 sc1 lds
    buffer_load_dwordx4 v1, s[4:7], s68 offen offset:1024 sc1 lds
    v_mfma_f32_16x16x32_bf16 v[28:31], v[148:151], v[76:79], v[28:31]
    s_cmp_lt_u32 s84, 2
    s_cbranch_scc1 L_z13_290
    v_mov_b32 v184, 0
    v_mov_b32 v185, 0
    v_mov_b32 v186, 0
    v_mov_b32 v187, 0
    v_mov_b32 v188, 0
    v_mov_b32 v189, 0
    v_mov_b32 v190, 0
    v_mov_b32 v191, 0
    v_mov_b32 v244, 0
    v_mov_b32 v245, 0
    v_mov_b32 v246, 0
    v_mov_b32 v247, 0
L_z13_290:
    s_waitcnt lgkmcnt(3)
    v_mfma_f32_16x16x32_bf16 v[16:19], v[152:155], v[56:59], v[16:19]
    s_waitcnt vmcnt(6)
    v_mfma_f32_16x16x32_bf16 v[20:23], v[156:159], v[56:59], v[20:23]
    ds_read_b128 v[72:75], v14 offset:32768
    s_add_u32 m0, s69, 73728
    v_mfma_f32_16x16x32_bf16 v[32:35], v[228:231], v[56:59], v[32:35]
    ds_read_b128 v[76:79], v15 offset:32768
    s_add_u32 s68, s68, 2048
    v_mfma_f32_16x16x32_bf16 v[24:27], v[152:155], v[60:63], v[24:27]
    buffer_load_dwordx4 v1, s[4:7], s68 offen offset:0 sc1 lds
    buffer_load_dwordx4 v1, s[4:7], s68 offen offset:1024 sc1 lds
    v_mfma_f32_16x16x32_bf16 v[28:31], v[156:159], v[60:63], v[28:31]
    ds_read_b32 v9, v11
    s_waitcnt lgkmcnt(3)
    v_mfma_f32_16x16x32_bf16 v[16:19], v[160:163], v[64:67], v[16:19]
    s_waitcnt vmcnt(6)
    v_mov_b32 v8, 78
    ds_write_b32 v10, v8
    v_mfma_f32_16x16x32_bf16 v[20:23], v[164:167], v[64:67], v[20:23]
    ds_read_b128 v[56:59], v14 offset:40960
    s_add_u32 m0, s69, 81920
    v_mfma_f32_16x16x32_bf16 v[32:35], v[232:235], v[64:67], v[32:35]
    ds_read_b128 v[60:63], v15 offset:40960
    s_add_u32 s68, s68, 2048
    v_mfma_f32_16x16x32_bf16 v[24:27], v[160:163], v[68:71], v[24:27]
    buffer_load_dwordx4 v1, s[4:7], s68 offen offset:0 sc1 lds
    buffer_load_dwordx4 v1, s[4:7], s68 offen offset:1024 sc1 lds
    v_mfma_f32_16x16x32_bf16 v[28:31], v[164:167], v[68:71], v[28:31]
    s_waitcnt lgkmcnt(3)
    v_cmp_gt_u32 vcc, 74, v9
    s_nop 0
    s_and_b32 vcc_lo, vcc_lo, s77
    s_cbranch_scc1 L_ck_291
L_cko_292:
    v_mfma_f32_16x16x32_bf16 v[16:19], v[168:171], v[72:75], v[16:19]
    s_waitcnt vmcnt(6)
    v_mfma_f32_16x16x32_bf16 v[20:23], v[172:175], v[72:75], v[20:23]
    ds_read_b128 v[64:67], v14 offset:49152
    s_add_u32 m0, s69, 90112
    v_mfma_f32_16x16x32_bf16 v[32:35], v[236:239], v[72:75], v[32:35]
    ds_read_b128 v[68:71], v15 offset:49152
    s_add_u32 s68, s68, 2048
    v_mfma_f32_16x16x32_bf16 v[24:27], v[168:171], v[76:79], v[24:27]
    buffer_load_dwordx4 v1, s[4:7], s68 offen offset:0 sc1 lds
    buffer_load_dwordx4 v1, s[4:7], s68 offen offset:1024 sc1 lds
    v_mfma_f32_16x16x32_bf16 v[28:31], v[172:175], v[76:79], v[28:31]
    s_waitcnt lgkmcnt(2)
    v_mfma_f32_16x16x32_bf16 v[16:19], v[176:179], v[56:59], v[16:19]
    v_add_u32 v14, 57344, v14
    v_add_u32 v15, 57344, v15
    s_waitcnt vmcnt(6)
    v_mov_b32 v8, 80
    ds_write_b32 v10, v8
    v_mfma_f32_16x16x32_bf16 v[20:23], v[180:183], v[56:59], v[20:23]
    ds_read_b128 v[72:75], v14 offset:0
    s_add_u32 m0, s69, 98304
    v_mfma_f32_16x16x32_bf16 v[32:35], v[240:243], v[56:59], v[32:35]
    ds_read_b128 v[76:79], v15 offset:0
    s_add_u32 s68, s68, 2048
    v_mfma_f32_16x16x32_bf16 v[24:27], v[176:179], v[60:63], v[24:27]
    buffer_load_dwordx4 v1, s[4:7], s68 offen offset:0 sc1 lds
    buffer_load_dwordx4 v1, s[4:7], s68 offen offset:1024 sc1 lds
    v_mfma_f32_16x16x32_bf16 v[28:31], v[180:183], v[60:63], v[28:31]
    s_waitcnt lgkmcnt(3)
    v_mfma_f32_16x16x32_bf16 v[16:19], v[184:187], v[64:67], v[16:19]
    s_waitcnt vmcnt(6)
    v_mfma_f32_16x16x32_bf16 v[20:23], v[188:191], v[64:67], v[20:23]
    ds_read_b128 v[56:59], v14 offset:8192
    s_add_u32 m0, s69, 106496
    v_mfma_f32_16x16x32_bf16 v[32:35], v[244:247], v[64:67], v[32:35]
    ds_read_b128 v[60:63], v15 offset:8192
    s_add_u32 s68, s68, 2048
    v_mfma_f32_16x16x32_bf16 v[24:27], v[184:187], v[68:71], v[24:27]
    buffer_load_dwordx4 v1, s[4:7], s68 offen offset:0 sc1 lds
    buffer_load_dwordx4 v1, s[4:7], s68 offen offset:1024 sc1 lds
    v_mfma_f32_16x16x32_bf16 v[28:31], v[188:191], v[68:71], v[28:31]
    s_waitcnt lgkmcnt(2)
    v_mfma_f32_16x16x32_bf16 v[36:39], v[80:83], v[72:75], 0
    s_waitcnt vmcnt(6)
    v_mov_b32 v8, 82
    ds_write_b32 v10, v8
    v_mfma_f32_16x16x32_bf16 v[40:43], v[84:87], v[72:75], 0
    ds_read_b128 v[64:67], v14 offset:16384
    s_add_u32 m0, s69, 0
    v_mfma_f32_16x16x32_bf16 v[52:55], v[192:195], v[72:75], 0
    ds_read_b128 v[68:71], v15 offset:16384
    s_add_u32 s68, s68, 2048
    v_mfma_f32_16x16x32_bf16 v[44:47], v[80:83], v[76:79], 0
    buffer_load_dwordx4 v1, s[4:7], s68 offen offset:0 sc1 lds
    buffer_load_dwordx4 v1, s[4:7], s68 offen offset:1024 sc1 lds
    v_mfma_f32_16x16x32_bf16 v[48:51], v[84:87], v[76:79], 0
    s_waitcnt lgkmcnt(3)
    v_mfma_f32_16x16x32_bf16 v[36:39], v[88:91], v[56:59], v[36:39]
    s_waitcnt vmcnt(6)
    v_mfma_f32_16x16x32_bf16 v[40:43], v[92:95], v[56:59], v[40:43]
    ds_read_b128 v[72:75], v14 offset:24576
    s_add_u32 m0, s69, 8192
    v_mfma_f32_16x16x32_bf16 v[52:55], v[196:199], v[56:59], v[52:55]
    ds_read_b128 v[76:79], v15 offset:24576
    s_add_u32 s68, s68, 2048
    v_mfma_f32_16x16x32_bf16 v[44:47], v[88:91], v[60:63], v[44:47]
    buffer_load_dwordx4 v1, s[4:7], s68 offen offset:0 sc1 lds
    buffer_load_dwordx4 v1, s[4:7], s68 offen offset:1024 sc1 lds
    v_mfma_f32_16x16x32_bf16 v[48:51], v[92:95], v[60:63], v[48:51]
    ds_read_b32 v9, v11
    s_waitcnt lgkmcnt(3)
    v_mfma_f32_16x16x32_bf16 v[36:39], v[96:99], v[64:67], v[36:39]
    s_waitcnt vmcnt(6)
    v_mov_b32 v8, 84
    ds_write_b32 v10, v8
    v_mfma_f32_16x16x32_bf16 v[40:43], v[100:103], v[64:67], v[40:43]
    ds_read_b128 v[56:59], v14 offset:32768
    s_add_u32 m0, s69, 16384
    v_mfma_f32_16x16x32_bf16 v[52:55], v[200:203], v[64:67], v[52:55]
    ds_read_b128 v[60:63], v15 offset:32768
    s_add_u32 s68, s68, 2048
    v_mfma_f32_16x16x32_bf16 v[44:47], v[96:99], v[68:71], v[44:47]
    buffer_load_dwordx4 v1, s[4:7], s68 offen offset:0 sc1 lds
    buffer_load_dwordx4 v1, s[4:7], s68 offen offset:1024 sc1 lds
    v_mfma_f32_16x16x32_bf16 v[48:51], v[100:103], v[68:71], v[48:51]
    s_waitcnt lgkmcnt(3)
    v_cmp_gt_u32 vcc, 78, v9
    s_nop 0
    s_and_b32 vcc_lo, vcc_lo, s77
    s_cbranch_scc1 L_ck_293
L_cko_294:
    v_mfma_f32_16x16x32_bf16 v[36:39], v[104:107], v[72:75], v[36:39]
    s_waitcnt vmcnt(6)
    v_mfma_f32_16x16x32_bf16 v[40:43], v[108:111], v[72:75], v[40:43]
    ds_read_b128 v[64:67], v14 offset:40960
    s_add_u32 m0, s69, 24576
    v_mfma_f32_16x16x32_bf16 v[52:55], v[204:207], v[72:75], v[52:55]
    ds_read_b128 v[68:71], v15 offset:40960
    s_add_u32 s68, s68, 2048
    v_mfma_f32_16x16x32_bf16 v[44:47], v[104:107], v[76:79], v[44:47]
    buffer_load_dwordx4 v1, s[4:7], s68 offen offset:0 sc1 lds
    buffer_load_dwordx4 v1, s[4:7], s68 offen offset:1024 sc1 lds
    v_mfma_f32_16x16x32_bf16 v[48:51], v[108:111], v[76:79], v[48:51]
    ds_write_b128 v12, v[16:19] offset:0
    s_waitcnt lgkmcnt(3)
    v_mfma_f32_16x16x32_bf16 v[36:39], v[112:115], v[56:59], v[36:39]
    s_waitcnt vmcnt(6)
    v_mov_b32 v8, 86
    ds_write_b32 v10, v8
    v_mfma_f32_16x16x32_bf16 v[40:43], v[116:119], v[56:59], v[40:43]
    ds_read_b128 v[72:75], v14 offset:49152
    s_add_u32 m0, s69, 32768
    v_mfma_f32_16x16x32_bf16 v[52:55], v[208:211], v[56:59], v[52:55]
    ds_read_b128 v[76:79], v15 offset:49152
    s_add_u32 s68, s68, 2048
    v_mfma_f32_16x16x32_bf16 v[44:47], v[112:115], v[60:63], v[44:47]
    buffer_load_dwordx4 v1, s[4:7], s68 offen offset:0 sc1 lds
    buffer_load_dwordx4 v1, s[4:7], s68 offen offset:1024 sc1 lds
    v_mfma_f32_16x16x32_bf16 v[48:51], v[116:119], v[60:63], v[48:51]
    ds_write_b128 v12, v[20:23] offset:1024
    s_waitcnt lgkmcnt(5)
    v_mfma_f32_16x16x32_bf16 v[36:39], v[120:123], v[64:67], v[36:39]
    v_add_u32 v14, 4294909952, v14
    v_add_u32 v15, 4294909952, v15
    s_waitcnt vmcnt(6)
    v_mfma_f32_16x16x32_bf16 v[40:43], v[124:127], v[64:67], v[40:43]
    ds_read_b128 v[56:59], v14 offset:0
    s_add_u32 m0, s69, 40960
    v_mfma_f32_16x16x32_bf16 v[52:55], v[212:215], v[64:67], v[52:55]
    ds_read_b128 v[60:63], v15 offset:0
    s_add_u32 s68, s68, 2048
    v_mfma_f32_16x16x32_bf16 v[44:47], v[120:123], v[68:71], v[44:47]
    buffer_load_dwordx4 v1, s[4:7], s68 offen offset:0 sc1 lds
    buffer_load_dwordx4 v1, s[4:7], s68 offen offset:1024 sc1 lds
    v_mfma_f32_16x16x32_bf16 v[48:51], v[124:127], v[68:71], v[48:51]
    ds_write_b128 v12, v[24:27] offset:2048
    s_waitcnt lgkmcnt(4)
    v_mfma_f32_16x16x32_bf16 v[36:39], v[128:131], v[72:75], v[36:39]
    s_waitcnt vmcnt(6)
    v_mov_b32 v8, 88
    ds_write_b32 v10, v8
    v_mfma_f32_16x16x32_bf16 v[40:43], v[132:135], v[72:75], v[40:43]
    ds_read_b128 v[64:67], v14 offset:8192
    s_add_u32 m0, s69, 49152
    v_mfma_f32_16x16x32_bf16 v[52:55], v[216:219], v[72:75], v[52:55]
    ds_read_b128 v[68:71], v15 offset:8192
    s_add_u32 s68, s68, s75
    v_mfma_f32_16x16x32_bf16 v[44:47], v[128:131], v[76:79], v[44:47]
    buffer_load_dwordx4 v1, s[4:7], s68 offen offset:0 sc1 lds
    buffer_load_dwordx4 v1, s[4:7], s68 offen offset:1024 sc1 lds
    v_mfma_f32_16x16x32_bf16 v[48:51], v[132:135], v[76:79], v[48:51]
    ds_write_b128 v12, v[28:31] offset:3072
    s_waitcnt lgkmcnt(5)
    v_mfma_f32_16x16x32_bf16 v[36:39], v[136:139], v[56:59], v[36:39]
    s_waitcnt vmcnt(6)
    v_mfma_f32_16x16x32_bf16 v[40:43], v[140:143], v[56:59], v[40:43]
    ds_read_b128 v[72:75], v14 offset:16384
    v_mfma_f32_16x16x32_bf16 v[52:55], v[220:223], v[56:59], v[52:55]
    ds_read_b128 v[76:79], v15 offset:16384
    v_mfma_f32_16x16x32_bf16 v[44:47], v[136:139], v[60:63], v[44:47]
    v_mfma_f32_16x16x32_bf16 v[48:51], v[140:143], v[60:63], v[48:51]
    ds_write_b128 v12, v[32:35] offset:4096
    s_waitcnt lgkmcnt(4)
    v_mfma_f32_16x16x32_bf16 v[36:39], v[144:147], v[64:67], v[36:39]
    s_waitcnt vmcnt(4)
    v_mov_b32 v8, 90
    ds_write_b32 v10, v8
    v_mfma_f32_16x16x32_bf16 v[40:43], v[148:151], v[64:67], v[40:43]
    ds_read_b128 v[56:59], v14 offset:24576
    v_mfma_f32_16x16x32_bf16 v[52:55], v[224:227], v[64:67], v[52:55]
    ds_read_b128 v[60:63], v15 offset:24576
    v_mfma_f32_16x16x32_bf16 v[44:47], v[144:147], v[68:71], v[44:47]
    v_mfma_f32_16x16x32_bf16 v[48:51], v[148:151], v[68:71], v[48:51]
    s_waitcnt lgkmcnt(4)
    v_mfma_f32_16x16x32_bf16 v[36:39], v[152:155], v[72:75], v[36:39]
    s_waitcnt vmcnt(2)
    v_mfma_f32_16x16x32_bf16 v[40:43], v[156:159], v[72:75], v[40:43]
    ds_read_b128 v[64:67], v14 offset:32768
    v_subrev_u32 v12, 57344, v12
    v_mfma_f32_16x16x32_bf16 v[52:55], v[228:231], v[72:75], v[52:55]
    ds_read_b128 v[68:71], v15 offset:32768
    v_and_b32 v83, 15, v0
    v_mfma_f32_16x16x32_bf16 v[44:47], v[152:155], v[76:79], v[44:47]
    v_mul_u32_u24 v83, 1280, v83
    v_lshl_add_u32 v82, v13, 4, v83
    v_mfma_f32_16x16x32_bf16 v[48:51], v[156:159], v[76:79], v[48:51]
    v_lshl_add_u32 v83, v13, 3, v83
    s_waitcnt lgkmcnt(2)
    v_mfma_f32_16x16x32_bf16 v[36:39], v[160:163], v[56:59], v[36:39]
    s_waitcnt vmcnt(0)
    v_mov_b32 v8, 92
    ds_write_b32 v10, v8
    v_mfma_f32_16x16x32_bf16 v[40:43], v[164:167], v[56:59], v[40:43]
    ds_read_b128 v[72:75], v14 offset:40960
    v_add_u32 v82, s65, v82
    v_mfma_f32_16x16x32_bf16 v[52:55], v[232:235], v[56:59], v[52:55]
    ds_read_b128 v[76:79], v15 offset:40960
    s_lshl_b32 s60, s65, 1
    v_mfma_f32_16x16x32_bf16 v[44:47], v[160:163], v[60:63], v[44:47]
    s_add_u32 s60, s60, 158720
    v_lshl_add_u32 v80, v13, 5, s60
    v_mfma_f32_16x16x32_bf16 v[48:51], v[164:167], v[60:63], v[48:51]
    v_lshlrev_b32 v81, 4, v13
    s_waitcnt lgkmcnt(3)
    v_mfma_f32_16x16x32_bf16 v[36:39], v[168:171], v[64:67], v[36:39]
    v_mfma_f32_16x16x32_bf16 v[40:43], v[172:175], v[64:67], v[40:43]
    ds_read_b128 v[56:59], v14 offset:49152
    v_add_u32 v81, 158976, v81
    v_mfma_f32_16x16x32_bf16 v[52:55], v[236:239], v[64:67], v[52:55]
    ds_read_b128 v[60:63], v15 offset:49152
    v_add_u32 v84, s78, v1
    v_mfma_f32_16x16x32_bf16 v[44:47], v[168:171], v[68:71], v[44:47]
    v_add_u32 v85, s79, v1
    v_lshlrev_b32 v92, 16, v2
    v_mfma_f32_16x16x32_bf16 v[48:51], v[172:175], v[68:71], v[48:51]
    v_and_b32 v93, 0xffff0000, v2
    s_waitcnt lgkmcnt(2)
    v_mfma_f32_16x16x32_bf16 v[36:39], v[176:179], v[72:75], v[36:39]
    v_lshlrev_b32 v94, 16, v3
    v_and_b32 v95, 0xffff0000, v3
    v_mfma_f32_16x16x32_bf16 v[40:43], v[180:183], v[72:75], v[40:43]
    v_lshlrev_b32 v96, 16, v4
    v_mfma_f32_16x16x32_bf16 v[52:55], v[240:243], v[72:75], v[52:55]
    v_and_b32 v97, 0xffff0000, v4
    v_mfma_f32_16x16x32_bf16 v[44:47], v[176:179], v[76:79], v[44:47]
    v_lshlrev_b32 v98, 16, v5
    v_and_b32 v99, 0xffff0000, v5
    v_mfma_f32_16x16x32_bf16 v[48:51], v[180:183], v[76:79], v[48:51]
    v_lshlrev_b32 v100, 16, v6
    ds_read_b32 v9, v11
    s_waitcnt lgkmcnt(1)
    v_mfma_f32_16x16x32_bf16 v[36:39], v[184:187], v[56:59], v[36:39]
    v_and_b32 v101, 0xffff0000, v6
    v_lshlrev_b32 v102, 16, v7
    v_mfma_f32_16x16x32_bf16 v[40:43], v[188:191], v[56:59], v[40:43]
    v_and_b32 v103, 0xffff0000, v7
    v_mfma_f32_16x16x32_bf16 v[52:55], v[244:247], v[56:59], v[52:55]
    v_mov_b32 v8, 94
    v_mfma_f32_16x16x32_bf16 v[44:47], v[184:187], v[60:63], v[44:47]
    ds_write_b32 v10, v8
    v_mfma_f32_16x16x32_bf16 v[48:51], v[188:191], v[60:63], v[48:51]
    s_waitcnt lgkmcnt(1)
    v_cmp_gt_u32 vcc, 94, v9
    s_nop 0
    s_and_b32 vcc_lo, vcc_lo, 0xff
    s_cbranch_scc1 L_ck_295
L_cko_296:
    ds_write_b128 v12, v[36:39] offset:0
    ds_write_b128 v12, v[40:43] offset:1024
    ds_write_b128 v12, v[44:47] offset:2048
    ds_write_b128 v12, v[48:51] offset:3072
    ds_write_b128 v12, v[52:55] offset:4096
    v_mov_b32 v8, 95
    ds_write_b32 v10, v8
    s_setprio 0
    s_waitcnt lgkmcnt(0)
    ds_read_b128 v[16:19], v84 offset:0
    ds_read_b128 v[20:23], v84 offset:1024
    ds_read_b128 v[24:27], v85 offset:0
    ds_read_b128 v[28:31], v84 offset:10240
    ds_read_b128 v[32:35], v84 offset:11264
    ds_read_b128 v[36:39], v85 offset:10240
    ds_read_b128 v[40:43], v84 offset:20480
    ds_read_b128 v[44:47], v84 offset:21504
    ds_read_b128 v[48:51], v85 offset:20480
    ds_read_b128 v[52:55], v84 offset:30720
    ds_read_b128 v[56:59], v84 offset:31744
    ds_read_b128 v[60:63], v85 offset:30720
    s_waitcnt lgkmcnt(6)
    v_add_f32 v16, v16, v28
    v_add_f32 v17, v17, v29
    v_add_f32 v18, v18, v30
    v_add_f32 v19, v19, v31
    v_add_f32 v20, v20, v32
    v_add_f32 v21, v21, v33
    v_add_f32 v22, v22, v34
    v_add_f32 v23, v23, v35
    v_add_f32 v24, v24, v36
    v_add_f32 v25, v25, v37
    v_add_f32 v26, v26, v38
    v_add_f32 v27, v27, v39
    ds_read_b128 v[28:31], v80 offset:640
    ds_read_b128 v[32:35], v80 offset:656
    ds_read_b128 v[36:39], v81 offset:640
    s_waitcnt lgkmcnt(3)
    v_add_f32 v40, v40, v52
    v_add_f32 v41, v41, v53
    v_add_f32 v42, v42, v54
    v_add_f32 v43, v43, v55
    v_add_f32 v44, v44, v56
    v_add_f32 v45, v45, v57
    v_add_f32 v46, v46, v58
    v_add_f32 v47, v47, v59
    v_add_f32 v48, v48, v60
    v_add_f32 v49, v49, v61
    v_add_f32 v50, v50, v62
    v_add_f32 v51, v51, v63
    v_add_f32 v16, v16, v40
    v_add_f32 v17, v17, v41
    v_add_f32 v18, v18, v42
    v_add_f32 v19, v19, v43
    v_add_f32 v20, v20, v44
    v_add_f32 v21, v21, v45
    v_add_f32 v22, v22, v46
    v_add_f32 v23, v23, v47
    v_add_f32 v24, v24, v48
    v_add_f32 v25, v25, v49
    v_add_f32 v26, v26, v50
    v_add_f32 v27, v27, v51
    s_waitcnt lgkmcnt(0)
    v_fma_f32 v16, v16, v28, v92
    v_fma_f32 v17, v17, v29, v93
    v_fma_f32 v18, v18, v30, v94
    v_fma_f32 v19, v19, v31, v95
    v_fma_f32 v20, v20, v32, v96
    v_fma_f32 v21, v21, v33, v97
    v_fma_f32 v22, v22, v34, v98
    v_fma_f32 v23, v23, v35, v99
    v_fma_f32 v24, v24, v36, v100
    v_fma_f32 v25, v25, v37, v101
    v_fma_f32 v26, v26, v38, v102
    v_fma_f32 v27, v27, v39, v103
    v_cvt_pk_bf16_f32 v40, v16, v17
    v_cvt_pk_bf16_f32 v41, v18, v19
    v_cvt_pk_bf16_f32 v42, v20, v21
    v_cvt_pk_bf16_f32 v43, v22, v23
    v_cvt_pk_bf16_f32 v44, v24, v25
    v_cvt_pk_bf16_f32 v45, v26, v27
    buffer_store_dwordx4 v[40:43], v82, s[24:27], s64 offen sc1
    s_cmp_ge_u32 s84, 2
    s_cbranch_scc1 L_noex_297
    buffer_store_dwordx2 v[44:45], v83, s[24:27], s64 offen offset:128 sc1
L_noex_297:
    s_branch L_f2fin_281
L_ck_288:
L_gs_298:
    ds_read_b32 v9, v11
    s_sub_i32 s66, s66, 1
    s_cmp_lt_i32 s66, 0
    s_waitcnt lgkmcnt(0)
    s_cbranch_scc1 L_gsd_299
    v_cmp_gt_u32 vcc, 68, v9
    s_nop 0
    s_and_b32 vcc_lo, vcc_lo, s62
    s_cbranch_scc1 L_gs_298
L_gsd_299:
    s_branch L_cko_289
L_ck_291:
L_gs_300:
    ds_read_b32 v9, v11
    s_sub_i32 s66, s66, 1
    s_cmp_lt_i32 s66, 0
    s_waitcnt lgkmcnt(0)
    s_cbranch_scc1 L_gsd_301
    v_cmp_gt_u32 vcc, 74, v9
    s_nop 0
    s_and_b32 vcc_lo, vcc_lo, s77
    s_cbranch_scc1 L_gs_300
L_gsd_301:
    s_branch L_cko_292
L_ck_293:
L_gs_302:
    ds_read_b32 v9, v11
    s_sub_i32 s66, s66, 1
    s_cmp_lt_i32 s66, 0
    s_waitcnt lgkmcnt(0)
    s_cbranch_scc1 L_gsd_303
    v_cmp_gt_u32 vcc, 78, v9
    s_nop 0
    s_and_b32 vcc_lo, vcc_lo, s77
    s_cbranch_scc1 L_gs_302
L_gsd_303:
    s_branch L_cko_294
L_ck_295:
L_gs_304:
    ds_read_b32 v9, v11
    s_sub_i32 s66, s66, 1
    s_cmp_lt_i32 s66, 0
    s_waitcnt lgkmcnt(0)
    s_cbranch_scc1 L_gsd_305
    v_cmp_gt_u32 vcc, 94, v9
    s_nop 0
    s_and_b32 vcc_lo, vcc_lo, 0xff
    s_cbranch_scc1 L_gs_304
L_gsd_305:
    s_branch L_cko_296
L_f2f_280:
    s_setprio 2
    s_cmp_eq_u32 s87, 7
    s_cbranch_scc1 L_np3_306_i
    buffer_load_dwordx4 v[96:99], v1, s[4:7], s71 offen offset:2048 sc1
    buffer_load_dwordx4 v[100:103], v1, s[4:7], s72 offen offset:2048 sc1
    buffer_load_dwordx4 v[104:107], v1, s[4:7], s71 offen offset:3072 sc1
    buffer_load_dwordx4 v[108:111], v1, s[4:7], s72 offen offset:3072 sc1
    s_waitcnt vmcnt(4)
    v_mov_b32 v8, 60
    ds_write_b32 v10, v8
    s_add_u32 s71, s71, 4096
    buffer_load_dwordx4 v[112:115], v1, s[4:7], s71 offen offset:0 sc1
    s_add_u32 s72, s72, 4096
    buffer_load_dwordx4 v[116:119], v1, s[4:7], s72 offen offset:0 sc1
    buffer_load_dwordx4 v[120:123], v1, s[4:7], s71 offen offset:1024 sc1
    buffer_load_dwordx4 v[124:127], v1, s[4:7], s72 offen offset:1024 sc1
    s_branch L_np3_306
L_np3_306_i:
    s_waitcnt vmcnt(0)
    v_mov_b32 v8, 60
    ds_write_b32 v10, v8
    s_cmp_lg_u32 s31, 3
    s_cbranch_scc1 L_np3_306
    s_lshl_b32 s65, s56, 3
    s_add_u32 s65, s65, 256
L_gs_307:
    ds_read_b32 v9, v11
    s_sub_i32 s66, s66, 1
    s_cmp_lt_i32 s66, 0
    s_waitcnt lgkmcnt(0)
    s_cbranch_scc1 L_gsd_308
    v_cmp_gt_u32 vcc, 60, v9
    s_nop 0
    s_and_b32 vcc_lo, vcc_lo, 0xff
    s_cbranch_scc1 L_gs_307
L_gsd_308:
    s_lshl_b32 s60, s65, 7
    s_lshl_b32 s61, s57, 2
    s_add_u32 s60, s60, s61
    s_add_u32 s60, s60, 294912
    v_lshlrev_b32 v8, 7, v0
    v_mov_b32 v9, s30
    s_mov_b32 exec_lo, 255
    s_mov_b32 exec_hi, 0
    buffer_store_dword v9, v8, s[4:7], s60 offen sc1
    s_mov_b64 exec, -1
L_np3_306:
    s_setprio 1
    s_lshr_b32 s60, s84, 1
    s_and_b32 s61, s84, 1
    s_xor_b32 s62, s60, s61
    s_lshl_b32 s62, s62, 11
    s_mul_i32 s78, s60, 5120
    s_add_u32 s78, s78, s62
    s_mul_i32 s79, s61, 5120
    s_add_u32 s79, s79, 4096
    s_xor_b32 s62, s85, 1
    s_lshl_b32 s64, s56, 1
    s_add_u32 s64, s64, s62
    s_lshl_b32 s64, s64, 1
    s_and_b32 s65, s84, 1
    s_add_u32 s64, s64, s65
    s_lshl_b32 s64, s64, 4
    s_lshr_b32 s65, s84, 1
    s_lshl_b32 s65, s65, 6
    s_mul_i32 s64, s64, 1280
    s_mul_i32 s60, s57, 160
    s_add_u32 s64, s64, s60
    s_mul_i32 s60, s85, 57344
    s_add_u32 s60, s60, 57344
    s_add_u32 s78, s78, s60
    s_add_u32 s79, s79, s60
L_gs_309:
    ds_read_b32 v9, v11
    s_sub_i32 s66, s66, 1
    s_cmp_lt_i32 s66, 0
    s_waitcnt lgkmcnt(0)
    s_cbranch_scc1 L_gsd_310
    v_cmp_gt_u32 vcc, 68, v9
    s_nop 0
    s_and_b32 vcc_lo, vcc_lo, s77
    s_cbranch_scc1 L_gs_309
L_gsd_310:
    ds_read_b128 v[56:59], v14 offset:0
    ds_read_b128 v[60:63], v15 offset:0
    ds_read_b128 v[64:67], v14 offset:8192
    ds_read_b128 v[68:71], v15 offset:8192
    s_waitcnt lgkmcnt(2)
    v_mfma_f32_16x16x32_bf16 v[16:19], v[80:83], v[56:59], 0
    v_mfma_f32_16x16x32_bf16 v[20:23], v[84:87], v[56:59], 0
    ds_read_b128 v[72:75], v14 offset:16384
    v_mfma_f32_16x16x32_bf16 v[32:35], v[192:195], v[56:59], 0
    ds_read_b128 v[76:79], v15 offset:16384
    v_mfma_f32_16x16x32_bf16 v[24:27], v[80:83], v[60:63], 0
    v_mfma_f32_16x16x32_bf16 v[28:31], v[84:87], v[60:63], 0
    s_cmp_lg_u32 s31, 3
    s_cbranch_scc1 L_o3_311
    s_buffer_load_dwordx8 s[32:39], s[4:7], s63 glc
L_o3_311:
    ds_read_b32 v9, v11
    s_waitcnt lgkmcnt(3)
    v_mfma_f32_16x16x32_bf16 v[16:19], v[88:91], v[64:67], v[16:19]
    ds_read_b128 v[56:59], v14 offset:24576
    s_cmp_eq_u32 s87, 7
    s_cbranch_scc1 L_lw_312
    buffer_load_dwordx4 v[128:131], v1, s[4:7], s71 offen offset:2048 sc1
    buffer_load_dwordx4 v[132:135], v1, s[4:7], s72 offen offset:2048 sc1
L_lw_312:
    v_mfma_f32_16x16x32_bf16 v[20:23], v[92:95], v[64:67], v[20:23]
    ds_read_b128 v[60:63], v15 offset:24576
    v_mfma_f32_16x16x32_bf16 v[32:35], v[196:199], v[64:67], v[32:35]
    v_mfma_f32_16x16x32_bf16 v[24:27], v[88:91], v[68:71], v[24:27]
    v_mfma_f32_16x16x32_bf16 v[28:31], v[92:95], v[68:71], v[28:31]
    s_waitcnt vmcnt(8)
    s_waitcnt lgkmcnt(3)
    v_mfma_f32_16x16x32_bf16 v[16:19], v[96:99], v[72:75], v[16:19]
    s_waitcnt lgkmcnt(2)
    v_cmp_gt_u32 vcc, 70, v9
    s_nop 0
    s_and_b32 vcc_lo, vcc_lo, s77
    s_cbranch_scc1 L_ck_313
L_cko_314:
    v_mfma_f32_16x16x32_bf16 v[20:23], v[100:103], v[72:75], v[20:23]
    ds_read_b128 v[64:67], v14 offset:32768
    s_cmp_eq_u32 s87, 7
    s_cbranch_scc1 L_lw_315
    buffer_load_dwordx4 v[136:139], v1, s[4:7], s71 offen offset:3072 sc1
    buffer_load_dwordx4 v[140:143], v1, s[4:7], s72 offen offset:3072 sc1
L_lw_315:
    v_mfma_f32_16x16x32_bf16 v[32:35], v[200:203], v[72:75], v[32:35]
    ds_read_b128 v[68:71], v15 offset:32768
    v_mfma_f32_16x16x32_bf16 v[24:27], v[96:99], v[76:79], v[24:27]
    v_mfma_f32_16x16x32_bf16 v[28:31], v[100:103], v[76:79], v[28:31]
    s_waitcnt vmcnt(8)
    ds_read_b32 v9, v11
    s_waitcnt lgkmcnt(3)
    v_mfma_f32_16x16x32_bf16 v[16:19], v[104:107], v[56:59], v[16:19]
    ds_read_b128 v[72:75], v14 offset:40960
    s_cmp_eq_u32 s87, 7
    s_cbranch_scc1 L_lw_316
    s_add_u32 s71, s71, 4096
    buffer_load_dwordx4 v[144:147], v1, s[4:7], s71 offen offset:0 sc1
    s_add_u32 s72, s72, 4096
    buffer_load_dwordx4 v[148:151], v1, s[4:7], s72 offen offset:0 sc1
L_lw_316:
    v_mfma_f32_16x16x32_bf16 v[20:23], v[108:111], v[56:59], v[20:23]
    ds_read_b128 v[76:79], v15 offset:40960
    v_mfma_f32_16x16x32_bf16 v[32:35], v[204:207], v[56:59], v[32:35]
    v_mfma_f32_16x16x32_bf16 v[24:27], v[104:107], v[60:63], v[24:27]
    v_mfma_f32_16x16x32_bf16 v[28:31], v[108:111], v[60:63], v[28:31]
    s_cmp_lg_u32 s31, 3
    s_cbranch_scc1 L_o3_317
    s_waitcnt lgkmcnt(0)
    s_cmp_lg_u64 s[32:33], s[28:29]
    s_cbranch_scc1 L_o3_317_s
    s_cmp_lg_u64 s[34:35], s[28:29]
    s_cbranch_scc1 L_o3_317_s
    s_cmp_lg_u64 s[36:37], s[28:29]
    s_cbranch_scc1 L_o3_317_s
    s_cmp_lg_u64 s[38:39], s[28:29]
    s_cbranch_scc1 L_o3_317_s
L_o3_317:
    v_mov_b32 v8, 68
    ds_write_b32 v10, v8
    s_waitcnt vmcnt(8)
    s_waitcnt lgkmcnt(4)
    v_mfma_f32_16x16x32_bf16 v[16:19], v[112:115], v[64:67], v[16:19]
    s_waitcnt lgkmcnt(3)
    v_cmp_gt_u32 vcc, 72, v9
    s_nop 0
    s_and_b32 vcc_lo, vcc_lo, s77
    s_cbranch_scc1 L_ck_318
L_cko_319:
    v_mfma_f32_16x16x32_bf16 v[20:23], v[116:119], v[64:67], v[20:23]
    ds_read_b128 v[56:59], v14 offset:49152
    s_cmp_eq_u32 s87, 7
    s_cbranch_scc1 L_lw_320
    buffer_load_dwordx4 v[152:155], v1, s[4:7], s71 offen offset:1024 sc1
    buffer_load_dwordx4 v[156:159], v1, s[4:7], s72 offen offset:1024 sc1
L_lw_320:
    v_mfma_f32_16x16x32_bf16 v[32:35], v[208:211], v[64:67], v[32:35]
    ds_read_b128 v[60:63], v15 offset:49152
    v_mfma_f32_16x16x32_bf16 v[24:27], v[112:115], v[68:71], v[24:27]
    v_mfma_f32_16x16x32_bf16 v[28:31], v[116:119], v[68:71], v[28:31]
    s_waitcnt vmcnt(8)
    ds_read_b32 v9, v11
    s_waitcnt lgkmcnt(4)
    v_mfma_f32_16x16x32_bf16 v[16:19], v[120:123], v[72:75], v[16:19]
    v_add_u32 v14, 4294909952, v14
    v_add_u32 v15, 4294909952, v15
    v_mfma_f32_16x16x32_bf16 v[20:23], v[124:127], v[72:75], v[20:23]
    ds_read_b128 v[64:67], v14 offset:0
    s_cmp_eq_u32 s87, 7
    s_cbranch_scc1 L_lw_321
    buffer_load_dwordx4 v[160:163], v1, s[4:7], s71 offen offset:2048 sc1
    buffer_load_dwordx4 v[164:167], v1, s[4:7], s72 offen offset:2048 sc1
L_lw_321:
    v_mfma_f32_16x16x32_bf16 v[32:35], v[212:215], v[72:75], v[32:35]
    ds_read_b128 v[68:71], v15 offset:0
    v_mfma_f32_16x16x32_bf16 v[24:27], v[120:123], v[76:79], v[24:27]
    v_mfma_f32_16x16x32_bf16 v[28:31], v[124:127], v[76:79], v[28:31]
    s_waitcnt vmcnt(8)
    s_waitcnt lgkmcnt(3)
    v_mfma_f32_16x16x32_bf16 v[16:19], v[128:131], v[56:59], v[16:19]
    s_waitcnt lgkmcnt(2)
    v_cmp_gt_u32 vcc, 74, v9
    s_nop 0
    s_and_b32 vcc_lo, vcc_lo, s77
    s_cbranch_scc1 L_ck_322
L_cko_323:
    v_mfma_f32_16x16x32_bf16 v[20:23], v[132:135], v[56:59], v[20:23]
    ds_read_b128 v[72:75], v14 offset:8192
    s_cmp_eq_u32 s87, 7
    s_cbranch_scc1 L_lw_324
    buffer_load_dwordx4 v[168:171], v1, s[4:7], s71 offen offset:3072 sc1
    buffer_load_dwordx4 v[172:175], v1, s[4:7], s72 offen offset:3072 sc1
L_lw_324:
    v_mfma_f32_16x16x32_bf16 v[32:35], v[216:219], v[56:59], v[32:35]
    ds_read_b128 v[76:79], v15 offset:8192
    v_mfma_f32_16x16x32_bf16 v[24:27], v[128:131], v[60:63], v[24:27]
    v_mfma_f32_16x16x32_bf16 v[28:31], v[132:135], v[60:63], v[28:31]
    s_waitcnt vmcnt(8)
    ds_read_b32 v9, v11
    s_waitcnt lgkmcnt(3)
    v_mfma_f32_16x16x32_bf16 v[16:19], v[136:139], v[64:67], v[16:19]
    ds_read_b128 v[56:59], v14 offset:16384
    s_cmp_eq_u32 s87, 7
    s_cbranch_scc1 L_lw_325
    s_add_u32 s71, s71, 4096
    buffer_load_dwordx4 v[176:179], v1, s[4:7], s71 offen offset:0 sc1
    s_add_u32 s72, s72, 4096
    buffer_load_dwordx4 v[180:183], v1, s[4:7], s72 offen offset:0 sc1
L_lw_325:
    v_mfma_f32_16x16x32_bf16 v[20:23], v[140:143], v[64:67], v[20:23]
    ds_read_b128 v[60:63], v15 offset:16384
    v_mfma_f32_16x16x32_bf16 v[32:35], v[220:223], v[64:67], v[32:35]
    v_mfma_f32_16x16x32_bf16 v[24:27], v[136:139], v[68:71], v[24:27]
    v_mfma_f32_16x16x32_bf16 v[28:31], v[140:143], v[68:71], v[28:31]
    s_waitcnt vmcnt(8)
    s_waitcnt lgkmcnt(3)
    v_mfma_f32_16x16x32_bf16 v[16:19], v[144:147], v[72:75], v[16:19]
    s_waitcnt lgkmcnt(2)
    v_cmp_gt_u32 vcc, 76, v9
    s_nop 0
    s_and_b32 vcc_lo, vcc_lo, s77
    s_cbranch_scc1 L_ck_326
L_cko_327:
    v_mfma_f32_16x16x32_bf16 v[20:23], v[148:151], v[72:75], v[20:23]
    ds_read_b128 v[64:67], v14 offset:24576
    s_cmp_eq_u32 s87, 7
    s_cbranch_scc1 L_lw_328
    buffer_load_dwordx4 v[184:187], v1, s[4:7], s71 offen offset:1024 sc1
    buffer_load_dwordx4 v[188:191], v1, s[4:7], s72 offen offset:1024 sc1
L_lw_328:
    v_mfma_f32_16x16x32_bf16 v[32:35], v[224:227], v[72:75], v[32:35]
    ds_read_b128 v[68:71], v15 offset:24576
    v_mfma_f32_16x16x32_bf16 v[24:27], v[144:147], v[76:79], v[24:27]
    v_mfma_f32_16x16x32_bf16 v[28:31], v[148:151], v[76:79], v[28:31]
    s_waitcnt vmcnt(8)
    ds_read_b32 v9, v11
    s_waitcnt lgkmcnt(3)
    v_mfma_f32_16x16x32_bf16 v[16:19], v[152:155], v[56:59], v[16:19]
    ds_read_b128 v[72:75], v14 offset:32768
    v_mfma_f32_16x16x32_bf16 v[20:23], v[156:159], v[56:59], v[20:23]
    ds_read_b128 v[76:79], v15 offset:32768
    v_mfma_f32_16x16x32_bf16 v[32:35], v[228:231], v[56:59], v[32:35]
    v_mfma_f32_16x16x32_bf16 v[24:27], v[152:155], v[60:63], v[24:27]
    v_mfma_f32_16x16x32_bf16 v[28:31], v[156:159], v[60:63], v[28:31]
    v_mov_b32 v8, 74
    ds_write_b32 v10, v8
    s_waitcnt vmcnt(6)
    s_waitcnt lgkmcnt(4)
    v_mfma_f32_16x16x32_bf16 v[16:19], v[160:163], v[64:67], v[16:19]
    s_waitcnt lgkmcnt(3)
    v_cmp_gt_u32 vcc, 78, v9
    s_nop 0
    s_and_b32 vcc_lo, vcc_lo, s77
    s_cbranch_scc1 L_ck_329
L_cko_330:
    v_mfma_f32_16x16x32_bf16 v[20:23], v[164:167], v[64:67], v[20:23]
    ds_read_b128 v[56:59], v14 offset:40960
    v_mfma_f32_16x16x32_bf16 v[32:35], v[232:235], v[64:67], v[32:35]
    ds_read_b128 v[60:63], v15 offset:40960
    v_mfma_f32_16x16x32_bf16 v[24:27], v[160:163], v[68:71], v[24:27]
    v_mfma_f32_16x16x32_bf16 v[28:31], v[164:167], v[68:71], v[28:31]
    s_waitcnt vmcnt(2)
    ds_read_b32 v9, v11
    s_waitcnt lgkmcnt(4)
    v_mfma_f32_16x16x32_bf16 v[16:19], v[168:171], v[72:75], v[16:19]
    ds_read_b128 v[64:67], v14 offset:49152
    v_mfma_f32_16x16x32_bf16 v[20:23], v[172:175], v[72:75], v[20:23]
    ds_read_b128 v[68:71], v15 offset:49152
    v_mfma_f32_16x16x32_bf16 v[32:35], v[236:239], v[72:75], v[32:35]
    v_mfma_f32_16x16x32_bf16 v[24:27], v[168:171], v[76:79], v[24:27]
    v_mfma_f32_16x16x32_bf16 v[28:31], v[172:175], v[76:79], v[28:31]
    s_waitcnt vmcnt(0)
    s_cmp_lt_u32 s84, 2
    s_cbranch_scc1 L_z13_331
    v_mov_b32 v184, 0
    v_mov_b32 v185, 0
    v_mov_b32 v186, 0
    v_mov_b32 v187, 0
    v_mov_b32 v188, 0
    v_mov_b32 v189, 0
    v_mov_b32 v190, 0
    v_mov_b32 v191, 0
    v_mov_b32 v244, 0
    v_mov_b32 v245, 0
    v_mov_b32 v246, 0
    v_mov_b32 v247, 0
L_z13_331:
    s_waitcnt lgkmcnt(3)
    v_mfma_f32_16x16x32_bf16 v[16:19], v[176:179], v[56:59], v[16:19]
    v_add_u32 v14, 57344, v14
    v_add_u32 v15, 57344, v15
    s_waitcnt lgkmcnt(2)
    v_cmp_gt_u32 vcc, 80, v9
    s_nop 0
    s_and_b32 vcc_lo, vcc_lo, s77
    s_cbranch_scc1 L_ck_332
L_cko_333:
    v_mfma_f32_16x16x32_bf16 v[20:23], v[180:183], v[56:59], v[20:23]
    ds_read_b128 v[72:75], v14 offset:0
    v_mfma_f32_16x16x32_bf16 v[32:35], v[240:243], v[56:59], v[32:35]
    ds_read_b128 v[76:79], v15 offset:0
    v_mfma_f32_16x16x32_bf16 v[24:27], v[176:179], v[60:63], v[24:27]
    v_mfma_f32_16x16x32_bf16 v[28:31], v[180:183], v[60:63], v[28:31]
    ds_read_b32 v9, v11
    s_waitcnt lgkmcnt(3)
    v_mfma_f32_16x16x32_bf16 v[16:19], v[184:187], v[64:67], v[16:19]
    ds_read_b128 v[56:59], v14 offset:8192
    v_mfma_f32_16x16x32_bf16 v[20:23], v[188:191], v[64:67], v[20:23]
    ds_read_b128 v[60:63], v15 offset:8192
    v_mfma_f32_16x16x32_bf16 v[32:35], v[244:247], v[64:67], v[32:35]
    v_mfma_f32_16x16x32_bf16 v[24:27], v[184:187], v[68:71], v[24:27]
    v_mfma_f32_16x16x32_bf16 v[28:31], v[188:191], v[68:71], v[28:31]
    v_mov_b32 v8, 78
    ds_write_b32 v10, v8
    s_setprio 0
    s_waitcnt lgkmcnt(4)
    v_mfma_f32_16x16x32_bf16 v[36:39], v[80:83], v[72:75], 0
    s_waitcnt lgkmcnt(3)
    v_cmp_gt_u32 vcc, 82, v9
    s_nop 0
    s_and_b32 vcc_lo, vcc_lo, s77
    s_cbranch_scc1 L_ck_334
L_cko_335:
    v_mfma_f32_16x16x32_bf16 v[40:43], v[84:87], v[72:75], 0
    ds_read_b128 v[64:67], v14 offset:16384
    v_mfma_f32_16x16x32_bf16 v[52:55], v[192:195], v[72:75], 0
    ds_read_b128 v[68:71], v15 offset:16384
    v_mfma_f32_16x16x32_bf16 v[44:47], v[80:83], v[76:79], 0
    v_mfma_f32_16x16x32_bf16 v[48:51], v[84:87], v[76:79], 0
    ds_write_b128 v12, v[16:19] offset:0
    ds_read_b32 v9, v11
    s_waitcnt lgkmcnt(5)
    v_mfma_f32_16x16x32_bf16 v[36:39], v[88:91], v[56:59], v[36:39]
    ds_read_b128 v[72:75], v14 offset:24576
    v_mfma_f32_16x16x32_bf16 v[40:43], v[92:95], v[56:59], v[40:43]
    ds_read_b128 v[76:79], v15 offset:24576
    v_mfma_f32_16x16x32_bf16 v[52:55], v[196:199], v[56:59], v[52:55]
    v_mfma_f32_16x16x32_bf16 v[44:47], v[88:91], v[60:63], v[44:47]
    v_mfma_f32_16x16x32_bf16 v[48:51], v[92:95], v[60:63], v[48:51]
    ds_write_b128 v12, v[20:23] offset:1024
    s_waitcnt lgkmcnt(5)
    v_mfma_f32_16x16x32_bf16 v[36:39], v[96:99], v[64:67], v[36:39]
    s_waitcnt lgkmcnt(3)
    v_cmp_gt_u32 vcc, 84, v9
    s_nop 0
    s_and_b32 vcc_lo, vcc_lo, s77
    s_cbranch_scc1 L_ck_336
L_cko_337:
    v_mfma_f32_16x16x32_bf16 v[40:43], v[100:103], v[64:67], v[40:43]
    ds_read_b128 v[56:59], v14 offset:32768
    v_mfma_f32_16x16x32_bf16 v[52:55], v[200:203], v[64:67], v[52:55]
    ds_read_b128 v[60:63], v15 offset:32768
    v_mfma_f32_16x16x32_bf16 v[44:47], v[96:99], v[68:71], v[44:47]
    v_mfma_f32_16x16x32_bf16 v[48:51], v[100:103], v[68:71], v[48:51]
    ds_write_b128 v12, v[24:27] offset:2048
    ds_read_b32 v9, v11
    s_waitcnt lgkmcnt(5)
    v_mfma_f32_16x16x32_bf16 v[36:39], v[104:107], v[72:75], v[36:39]
    ds_read_b128 v[64:67], v14 offset:40960
    v_mfma_f32_16x16x32_bf16 v[40:43], v[108:111], v[72:75], v[40:43]
    ds_read_b128 v[68:71], v15 offset:40960
    v_mfma_f32_16x16x32_bf16 v[52:55], v[204:207], v[72:75], v[52:55]
    v_mfma_f32_16x16x32_bf16 v[44:47], v[104:107], v[76:79], v[44:47]
    v_mfma_f32_16x16x32_bf16 v[48:51], v[108:111], v[76:79], v[48:51]
    ds_write_b128 v12, v[28:31] offset:3072
    s_waitcnt lgkmcnt(5)
    v_mfma_f32_16x16x32_bf16 v[36:39], v[112:115], v[56:59], v[36:39]
    s_waitcnt lgkmcnt(3)
    v_cmp_gt_u32 vcc, 86, v9
    s_nop 0
    s_and_b32 vcc_lo, vcc_lo, s77
    s_cbranch_scc1 L_ck_338
L_cko_339:
    v_mfma_f32_16x16x32_bf16 v[40:43], v[116:119], v[56:59], v[40:43]
    ds_read_b128 v[72:75], v14 offset:49152
    v_mfma_f32_16x16x32_bf16 v[52:55], v[208:211], v[56:59], v[52:55]
    ds_read_b128 v[76:79], v15 offset:49152
    v_mfma_f32_16x16x32_bf16 v[44:47], v[112:115], v[60:63], v[44:47]
    v_mfma_f32_16x16x32_bf16 v[48:51], v[116:119], v[60:63], v[48:51]
    ds_write_b128 v12, v[32:35] offset:4096
    ds_read_b32 v9, v11
    s_waitcnt lgkmcnt(5)
    v_mfma_f32_16x16x32_bf16 v[36:39], v[120:123], v[64:67], v[36:39]
    v_add_u32 v14, 4294909952, v14
    v_add_u32 v15, 4294909952, v15
    v_mfma_f32_16x16x32_bf16 v[40:43], v[124:127], v[64:67], v[40:43]
    ds_read_b128 v[56:59], v14 offset:0
    v_mfma_f32_16x16x32_bf16 v[52:55], v[212:215], v[64:67], v[52:55]
    ds_read_b128 v[60:63], v15 offset:0
    v_mfma_f32_16x16x32_bf16 v[44:47], v[120:123], v[68:71], v[44:47]
    v_mfma_f32_16x16x32_bf16 v[48:51], v[124:127], v[68:71], v[48:51]
    s_waitcnt lgkmcnt(4)
    v_mfma_f32_16x16x32_bf16 v[36:39], v[128:131], v[72:75], v[36:39]
    s_waitcnt lgkmcnt(2)
    v_cmp_gt_u32 vcc, 88, v9
    s_nop 0
    s_and_b32 vcc_lo, vcc_lo, s77
    s_cbranch_scc1 L_ck_340
L_cko_341:
    v_mfma_f32_16x16x32_bf16 v[40:43], v[132:135], v[72:75], v[40:43]
    ds_read_b128 v[64:67], v14 offset:8192
    v_mov_b32 v8, 94
    v_mfma_f32_16x16x32_bf16 v[52:55], v[216:219], v[72:75], v[52:55]
    ds_read_b128 v[68:71], v15 offset:8192
    ds_write_b32 v10, v8
    v_mfma_f32_16x16x32_bf16 v[44:47], v[128:131], v[76:79], v[44:47]
    v_mfma_f32_16x16x32_bf16 v[48:51], v[132:135], v[76:79], v[48:51]
    ds_read_b32 v9, v11
    s_waitcnt lgkmcnt(4)
    v_mfma_f32_16x16x32_bf16 v[36:39], v[136:139], v[56:59], v[36:39]
    ds_read_b128 v[72:75], v14 offset:16384
    v_mfma_f32_16x16x32_bf16 v[40:43], v[140:143], v[56:59], v[40:43]
    ds_read_b128 v[76:79], v15 offset:16384
    v_mfma_f32_16x16x32_bf16 v[52:55], v[220:223], v[56:59], v[52:55]
    v_mfma_f32_16x16x32_bf16 v[44:47], v[136:139], v[60:63], v[44:47]
    v_mfma_f32_16x16x32_bf16 v[48:51], v[140:143], v[60:63], v[48:51]
    s_waitcnt lgkmcnt(4)
    v_mfma_f32_16x16x32_bf16 v[36:39], v[144:147], v[64:67], v[36:39]
    s_waitcnt lgkmcnt(2)
    v_cmp_gt_u32 vcc, 90, v9
    s_nop 0
    s_and_b32 vcc_lo, vcc_lo, s77
    s_cbranch_scc1 L_ck_342
L_cko_343:
    v_mfma_f32_16x16x32_bf16 v[40:43], v[148:151], v[64:67], v[40:43]
    ds_read_b128 v[56:59], v14 offset:24576
    v_subrev_u32 v12, 57344, v12
    v_mfma_f32_16x16x32_bf16 v[52:55], v[224:227], v[64:67], v[52:55]
    ds_read_b128 v[60:63], v15 offset:24576
    v_and_b32 v83, 15, v0
    v_mfma_f32_16x16x32_bf16 v[44:47], v[144:147], v[68:71], v[44:47]
    v_mul_u32_u24 v83, 1280, v83
    v_lshl_add_u32 v82, v13, 4, v83
    v_mfma_f32_16x16x32_bf16 v[48:51], v[148:151], v[68:71], v[48:51]
    v_lshl_add_u32 v83, v13, 3, v83
    ds_read_b32 v9, v11
    s_waitcnt lgkmcnt(3)
    v_mfma_f32_16x16x32_bf16 v[36:39], v[152:155], v[72:75], v[36:39]
    ds_read_b128 v[64:67], v14 offset:32768
    v_add_u32 v82, s65, v82
    s_lshl_b32 s60, s65, 1
    v_mfma_f32_16x16x32_bf16 v[40:43], v[156:159], v[72:75], v[40:43]
    ds_read_b128 v[68:71], v15 offset:32768
    s_add_u32 s60, s60, 158720
    v_mfma_f32_16x16x32_bf16 v[52:55], v[228:231], v[72:75], v[52:55]
    v_lshl_add_u32 v80, v13, 5, s60
    v_mfma_f32_16x16x32_bf16 v[44:47], v[152:155], v[76:79], v[44:47]
    v_lshlrev_b32 v81, 4, v13
    v_add_u32 v81, 158976, v81
    v_mfma_f32_16x16x32_bf16 v[48:51], v[156:159], v[76:79], v[48:51]
    v_add_u32 v84, s78, v1
    s_waitcnt lgkmcnt(3)
    v_mfma_f32_16x16x32_bf16 v[36:39], v[160:163], v[56:59], v[36:39]
    s_waitcnt lgkmcnt(2)
    v_cmp_gt_u32 vcc, 92, v9
    s_nop 0
    s_and_b32 vcc_lo, vcc_lo, s77
    s_cbranch_scc1 L_ck_344
L_cko_345:
    v_mfma_f32_16x16x32_bf16 v[40:43], v[164:167], v[56:59], v[40:43]
    ds_read_b128 v[72:75], v14 offset:40960
    v_add_u32 v85, s79, v1
    v_mfma_f32_16x16x32_bf16 v[52:55], v[232:235], v[56:59], v[52:55]
    ds_read_b128 v[76:79], v15 offset:40960
    v_lshlrev_b32 v92, 16, v2
    v_mfma_f32_16x16x32_bf16 v[44:47], v[160:163], v[60:63], v[44:47]
    v_and_b32 v93, 0xffff0000, v2
    v_lshlrev_b32 v94, 16, v3
    v_mfma_f32_16x16x32_bf16 v[48:51], v[164:167], v[60:63], v[48:51]
    v_and_b32 v95, 0xffff0000, v3
    s_waitcnt lgkmcnt(2)
    v_mfma_f32_16x16x32_bf16 v[36:39], v[168:171], v[64:67], v[36:39]
    ds_read_b128 v[56:59], v14 offset:49152
    v_lshlrev_b32 v96, 16, v4
    v_and_b32 v97, 0xffff0000, v4
    v_mfma_f32_16x16x32_bf16 v[40:43], v[172:175], v[64:67], v[40:43]
    ds_read_b128 v[60:63], v15 offset:49152
    v_lshlrev_b32 v98, 16, v5
    v_mfma_f32_16x16x32_bf16 v[52:55], v[236:239], v[64:67], v[52:55]
    v_and_b32 v99, 0xffff0000, v5
    v_mfma_f32_16x16x32_bf16 v[44:47], v[168:171], v[68:71], v[44:47]
    v_lshlrev_b32 v100, 16, v6
    v_and_b32 v101, 0xffff0000, v6
    v_mfma_f32_16x16x32_bf16 v[48:51], v[172:175], v[68:71], v[48:51]
    v_lshlrev_b32 v102, 16, v7
    s_waitcnt lgkmcnt(2)
    v_mfma_f32_16x16x32_bf16 v[36:39], v[176:179], v[72:75], v[36:39]
    v_and_b32 v103, 0xffff0000, v7
    v_mfma_f32_16x16x32_bf16 v[40:43], v[180:183], v[72:75], v[40:43]
    v_mfma_f32_16x16x32_bf16 v[52:55], v[240:243], v[72:75], v[52:55]
    v_mfma_f32_16x16x32_bf16 v[44:47], v[176:179], v[76:79], v[44:47]
    v_mfma_f32_16x16x32_bf16 v[48:51], v[180:183], v[76:79], v[48:51]
    ds_read_b32 v9, v11
    s_waitcnt lgkmcnt(1)
    v_mfma_f32_16x16x32_bf16 v[36:39], v[184:187], v[56:59], v[36:39]
    v_mfma_f32_16x16x32_bf16 v[40:43], v[188:191], v[56:59], v[40:43]
    v_mfma_f32_16x16x32_bf16 v[52:55], v[244:247], v[56:59], v[52:55]
    v_mfma_f32_16x16x32_bf16 v[44:47], v[184:187], v[60:63], v[44:47]
    v_mfma_f32_16x16x32_bf16 v[48:51], v[188:191], v[60:63], v[48:51]
    s_setprio 2
    s_waitcnt lgkmcnt(0)
    v_cmp_gt_u32 vcc, 94, v9
    s_nop 0
    s_and_b32 vcc_lo, vcc_lo, 0xff
    s_cbranch_scc1 L_ck_346
L_cko_347:
    ds_write_b128 v12, v[36:39] offset:0
    ds_write_b128 v12, v[40:43] offset:1024
    ds_write_b128 v12, v[44:47] offset:2048
    ds_write_b128 v12, v[48:51] offset:3072
    ds_write_b128 v12, v[52:55] offset:4096
    v_mov_b32 v8, 95
    ds_write_b32 v10, v8
L_gs_348:
    ds_read_b32 v9, v11
    s_sub_i32 s66, s66, 1
    s_cmp_lt_i32 s66, 0
    s_waitcnt lgkmcnt(0)
    s_cbranch_scc1 L_gsd_349
    v_cmp_gt_u32 vcc, 95, v9
    s_nop 0
    s_and_b32 vcc_lo, vcc_lo, 0xff
    s_cbranch_scc1 L_gs_348
L_gsd_349:
    ds_read_b128 v[16:19], v84 offset:0
    ds_read_b128 v[20:23], v84 offset:1024
    ds_read_b128 v[24:27], v85 offset:0
    ds_read_b128 v[28:31], v84 offset:10240
    ds_read_b128 v[32:35], v84 offset:11264
    ds_read_b128 v[36:39], v85 offset:10240
    ds_read_b128 v[40:43], v84 offset:20480
    ds_read_b128 v[44:47], v84 offset:21504
    ds_read_b128 v[48:51], v85 offset:20480
    ds_read_b128 v[52:55], v84 offset:30720
    ds_read_b128 v[56:59], v84 offset:31744
    ds_read_b128 v[60:63], v85 offset:30720
    s_waitcnt lgkmcnt(6)
    v_add_f32 v16, v16, v28
    v_add_f32 v17, v17, v29
    v_add_f32 v18, v18, v30
    v_add_f32 v19, v19, v31
    v_add_f32 v20, v20, v32
    v_add_f32 v21, v21, v33
    v_add_f32 v22, v22, v34
    v_add_f32 v23, v23, v35
    v_add_f32 v24, v24, v36
    v_add_f32 v25, v25, v37
    v_add_f32 v26, v26, v38
    v_add_f32 v27, v27, v39
    ds_read_b128 v[28:31], v80 offset:640
    ds_read_b128 v[32:35], v80 offset:656
    ds_read_b128 v[36:39], v81 offset:640
    s_waitcnt lgkmcnt(3)
    v_add_f32 v40, v40, v52
    v_add_f32 v41, v41, v53
    v_add_f32 v42, v42, v54
    v_add_f32 v43, v43, v55
    v_add_f32 v44, v44, v56
    v_add_f32 v45, v45, v57
    v_add_f32 v46, v46, v58
    v_add_f32 v47, v47, v59
    v_add_f32 v48, v48, v60
    v_add_f32 v49, v49, v61
    v_add_f32 v50, v50, v62
    v_add_f32 v51, v51, v63
    v_add_f32 v16, v16, v40
    v_add_f32 v17, v17, v41
    v_add_f32 v18, v18, v42
    v_add_f32 v19, v19, v43
    v_add_f32 v20, v20, v44
    v_add_f32 v21, v21, v45
    v_add_f32 v22, v22, v46
    v_add_f32 v23, v23, v47
    v_add_f32 v24, v24, v48
    v_add_f32 v25, v25, v49
    v_add_f32 v26, v26, v50
    v_add_f32 v27, v27, v51
    s_waitcnt lgkmcnt(0)
    v_fma_f32 v16, v16, v28, v92
    v_fma_f32 v17, v17, v29, v93
    v_fma_f32 v18, v18, v30, v94
    v_fma_f32 v19, v19, v31, v95
    v_fma_f32 v20, v20, v32, v96
    v_fma_f32 v21, v21, v33, v97
    v_fma_f32 v22, v22, v34, v98
    v_fma_f32 v23, v23, v35, v99
    v_fma_f32 v24, v24, v36, v100
    v_fma_f32 v25, v25, v37, v101
    v_fma_f32 v26, v26, v38, v102
    v_fma_f32 v27, v27, v39, v103
    v_cvt_pk_bf16_f32 v40, v16, v17
    v_cvt_pk_bf16_f32 v41, v18, v19
    v_cvt_pk_bf16_f32 v42, v20, v21
    v_cvt_pk_bf16_f32 v43, v22, v23
    v_cvt_pk_bf16_f32 v44, v24, v25
    v_cvt_pk_bf16_f32 v45, v26, v27
    buffer_store_dwordx4 v[40:43], v82, s[24:27], s64 offen sc1
    s_cmp_ge_u32 s84, 2
    s_cbranch_scc1 L_noex_350
    buffer_store_dwordx2 v[44:45], v83, s[24:27], s64 offen offset:128 sc1
L_noex_350:
    s_branch L_f2fin_281
L_ck_313:
L_gs_351:
    ds_read_b32 v9, v11
    s_sub_i32 s66, s66, 1
    s_cmp_lt_i32 s66, 0
    s_waitcnt lgkmcnt(0)
    s_cbranch_scc1 L_gsd_352
    v_cmp_gt_u32 vcc, 70, v9
    s_nop 0
    s_and_b32 vcc_lo, vcc_lo, s77
    s_cbranch_scc1 L_gs_351
L_gsd_352:
    s_branch L_cko_314
L_o3_317_s:
L_sp_353:
    s_buffer_load_dwordx8 s[32:39], s[4:7], s63 glc
    s_sub_i32 s66, s66, 4
    s_cmp_lt_i32 s66, 0
    s_waitcnt lgkmcnt(0)
    s_cbranch_scc1 L_spd_354
    s_cmp_lg_u64 s[32:33], s[28:29]
    s_cbranch_scc1 L_sp_353
    s_cmp_lg_u64 s[34:35], s[28:29]
    s_cbranch_scc1 L_sp_353
    s_cmp_lg_u64 s[36:37], s[28:29]
    s_cbranch_scc1 L_sp_353
    s_cmp_lg_u64 s[38:39], s[28:29]
    s_cbranch_scc1 L_sp_353
L_spd_354:
    s_branch L_o3_317
L_ck_318:
L_gs_355:
    ds_read_b32 v9, v11
    s_sub_i32 s66, s66, 1
    s_cmp_lt_i32 s66, 0
    s_waitcnt lgkmcnt(0)
    s_cbranch_scc1 L_gsd_356
    v_cmp_gt_u32 vcc, 72, v9
    s_nop 0
    s_and_b32 vcc_lo, vcc_lo, s77
    s_cbranch_scc1 L_gs_355
L_gsd_356:
    s_branch L_cko_319
L_ck_322:
L_gs_357:
    ds_read_b32 v9, v11
    s_sub_i32 s66, s66, 1
    s_cmp_lt_i32 s66, 0
    s_waitcnt lgkmcnt(0)
    s_cbranch_scc1 L_gsd_358
    v_cmp_gt_u32 vcc, 74, v9
    s_nop 0
    s_and_b32 vcc_lo, vcc_lo, s77
    s_cbranch_scc1 L_gs_357
L_gsd_358:
    s_branch L_cko_323
L_ck_326:
L_gs_359:
    ds_read_b32 v9, v11
    s_sub_i32 s66, s66, 1
    s_cmp_lt_i32 s66, 0
    s_waitcnt lgkmcnt(0)
    s_cbranch_scc1 L_gsd_360
    v_cmp_gt_u32 vcc, 76, v9
    s_nop 0
    s_and_b32 vcc_lo, vcc_lo, s77
    s_cbranch_scc1 L_gs_359
L_gsd_360:
    s_branch L_cko_327
L_ck_329:
L_gs_361:
    ds_read_b32 v9, v11
    s_sub_i32 s66, s66, 1
    s_cmp_lt_i32 s66, 0
    s_waitcnt lgkmcnt(0)
    s_cbranch_scc1 L_gsd_362
    v_cmp_gt_u32 vcc, 78, v9
    s_nop 0
    s_and_b32 vcc_lo, vcc_lo, s77
    s_cbranch_scc1 L_gs_361
L_gsd_362:
    s_branch L_cko_330
L_ck_332:
L_gs_363:
    ds_read_b32 v9, v11
    s_sub_i32 s66, s66, 1
    s_cmp_lt_i32 s66, 0
    s_waitcnt lgkmcnt(0)
    s_cbranch_scc1 L_gsd_364
    v_cmp_gt_u32 vcc, 80, v9
    s_nop 0
    s_and_b32 vcc_lo, vcc_lo, s77
    s_cbranch_scc1 L_gs_363
L_gsd_364:
    s_branch L_cko_333
L_ck_334:
L_gs_365:
    ds_read_b32 v9, v11
    s_sub_i32 s66, s66, 1
    s_cmp_lt_i32 s66, 0
    s_waitcnt lgkmcnt(0)
    s_cbranch_scc1 L_gsd_366
    v_cmp_gt_u32 vcc, 82, v9
    s_nop 0
    s_and_b32 vcc_lo, vcc_lo, s77
    s_cbranch_scc1 L_gs_365
L_gsd_366:
    s_branch L_cko_335
L_ck_336:
L_gs_367:
    ds_read_b32 v9, v11
    s_sub_i32 s66, s66, 1
    s_cmp_lt_i32 s66, 0
    s_waitcnt lgkmcnt(0)
    s_cbranch_scc1 L_gsd_368
    v_cmp_gt_u32 vcc, 84, v9
    s_nop 0
    s_and_b32 vcc_lo, vcc_lo, s77
    s_cbranch_scc1 L_gs_367
L_gsd_368:
    s_branch L_cko_337
L_ck_338:
L_gs_369:
    ds_read_b32 v9, v11
    s_sub_i32 s66, s66, 1
    s_cmp_lt_i32 s66, 0
    s_waitcnt lgkmcnt(0)
    s_cbranch_scc1 L_gsd_370
    v_cmp_gt_u32 vcc, 86, v9
    s_nop 0
    s_and_b32 vcc_lo, vcc_lo, s77
    s_cbranch_scc1 L_gs_369
L_gsd_370:
    s_branch L_cko_339
L_ck_340:
L_gs_371:
    ds_read_b32 v9, v11
    s_sub_i32 s66, s66, 1
    s_cmp_lt_i32 s66, 0
    s_waitcnt lgkmcnt(0)
    s_cbranch_scc1 L_gsd_372
    v_cmp_gt_u32 vcc, 88, v9
    s_nop 0
    s_and_b32 vcc_lo, vcc_lo, s77
    s_cbranch_scc1 L_gs_371
L_gsd_372:
    s_branch L_cko_341
L_ck_342:
L_gs_373:
    ds_read_b32 v9, v11
    s_sub_i32 s66, s66, 1
    s_cmp_lt_i32 s66, 0
    s_waitcnt lgkmcnt(0)
    s_cbranch_scc1 L_gsd_374
    v_cmp_gt_u32 vcc, 90, v9
    s_nop 0
    s_and_b32 vcc_lo, vcc_lo, s77
    s_cbranch_scc1 L_gs_373
L_gsd_374:
    s_branch L_cko_343
L_ck_344:
L_gs_375:
    ds_read_b32 v9, v11
    s_sub_i32 s66, s66, 1
    s_cmp_lt_i32 s66, 0
    s_waitcnt lgkmcnt(0)
    s_cbranch_scc1 L_gsd_376
    v_cmp_gt_u32 vcc, 92, v9
    s_nop 0
    s_and_b32 vcc_lo, vcc_lo, s77
    s_cbranch_scc1 L_gs_375
L_gsd_376:
    s_branch L_cko_345
L_ck_346:
L_gs_377:
    ds_read_b32 v9, v11
    s_sub_i32 s66, s66, 1
    s_cmp_lt_i32 s66, 0
    s_waitcnt lgkmcnt(0)
    s_cbranch_scc1 L_gsd_378
    v_cmp_gt_u32 vcc, 94, v9
    s_nop 0
    s_and_b32 vcc_lo, vcc_lo, 0xff
    s_cbranch_scc1 L_gs_377
L_gsd_378:
    s_branch L_cko_347
L_f2fin_281:
    s_or_b32 s60, s58, s31
    s_cbranch_scc1 L_exit
    s_mov_b32 s60, 360448
    s_mov_b64 exec, 1
    v_mov_b32 v8, s30
    buffer_store_dword v8, off, s[4:7], s60 sc1
    s_mov_b64 exec, -1
L_exit:
    s_endpgm
L_setup:
    s_and_b32 s84, s31, 3
    s_lshr_b32 s85, s31, 2
    s_lshr_b32 s60, s54, 1
    s_mul_i32 s79, s60, 5
    s_and_b32 s61, s54, 1
    s_mul_i32 s78, s61, 3
    s_add_u32 s78, s78, s79
    s_add_u32 s79, s79, 2
    s_mul_i32 s78, s78, 32768
    s_mul_i32 s79, s79, 32768
    s_and_b32 s75, s31, 1
    s_mul_i32 s86, s57, 7
    s_min_u32 s86, s86, 48
    s_cmp_ge_u32 s57, 6
    s_cselect_b32 s60, 2, 3
    s_sub_u32 s87, s60, 1
    s_min_u32 s87, s87, s31
    s_bitcmp1_b32 s56, 0
    s_cselect_b32 s61, 0, s60
    s_cselect_b32 s62, 4, 0
    s_cmp_eq_u32 s85, 1
    s_cmov_b32 s87, s84
    s_cmov_b32 s62, s61
    s_cmov_b32 s60, 8
    s_add_u32 s86, s86, s87
    s_add_u32 s86, s86, s62
    s_cmp_ge_u32 s31, s60
    s_cmov_b32 s87, 7
    s_mov_b32 s76, 0xfffff
    s_mov_b32 s77, 0xfffff
    s_mul_i32 s80, s75, 11264
    s_add_u32 s80, s80, 67072
    s_bitcmp1_b32 s31, 1
    s_cbranch_scc1 L_av_380
    s_mov_b32 s74, 2048
    s_lshl_b32 s60, s75, 13
    s_add_u32 s60, s60, 7340032
    s_add_u32 s68, s60, s78
    s_add_u32 s69, s68, 32768
    s_add_u32 s70, s60, s79
    s_mov_b32 s71, s80
    s_add_u32 s73, s80, 4096
    s_branch L_ad_381
L_av_380:
    s_mov_b32 s74, 5120
    s_mul_i32 s60, s54, 81920
    s_mul_i32 s61, s75, 20480
    s_add_u32 s60, s60, s61
    s_add_u32 s68, s60, 11010048
    s_add_u32 s69, s68, 2048
    s_add_u32 s70, s68, 3072
    s_add_u32 s71, s80, 6144
    s_add_u32 s73, s80, 9216
L_ad_381:
    s_add_u32 s72, s71, 2048
    s_lshl_b32 s60, s85, 14
    s_lshl_b32 s61, s55, 11
    s_add_u32 s60, s60, s61
    s_and_b32 s61, s31, 2
    s_lshl_b32 s61, s61, 9
    s_add_u32 s60, s60, s61
    s_add_u32 s60, s60, 4718592
    s_add_u32 s78, s78, s60
    s_add_u32 s79, s79, s60
    s_and_b32 s61, s54, 1
    s_lshl_b32 s61, s61, 3
    s_add_u32 s79, s79, s61
    s_mul_i32 s60, s54, 20
    s_add_u32 s61, s60, 19
    s_xor_b32 s60, s60, s61
    s_cmp_ge_u32 s60, 128
    s_cselect_b32 s81, 63, 47
    s_mul_i32 s82, s54, 384
    s_lshl_b32 s60, s85, 15
    s_add_u32 s82, s82, s60
    s_add_u32 s82, s82, 65536
    s_lshl_b32 s60, s55, 3
    s_add_u32 s83, s82, s60
    s_add_u32 s82, s82, 128
    s_cmp_ge_u32 s58, 108
    s_cselect_b32 s51, 1, 0
    s_cmp_ge_u32 s58, 140
    s_cmov_b32 s51, 2
    s_cmp_lg_u32 s51, 0
    s_cbranch_scc1 L_kn_383
    s_sub_u32 s60, s58, 0
    s_mul_i32 s63, s60, 2428
    s_lshr_b32 s63, s63, 16
    s_mul_i32 s61, s63, 27
    s_sub_u32 s62, s60, s61
    s_mov_b32 s20, s36
    s_mov_b32 s21, s37
    s_mov_b32 s22, 2211840
    s_mov_b32 s23, 0x20000
    s_mul_i32 s60, s63, 552960
    s_mul_i32 s61, s62, 128
    s_add_u32 s47, s60, s61
    s_mul_i32 s0, s84, 1024
    s_mov_b32 s50, 4
    s_lshl_b32 s2, s31, 5
    s_lshl_b32 s60, s62, 1
    s_lshr_b32 s61, s31, 1
    s_add_u32 s60, s60, s61
    s_mul_i32 s60, s60, 40960
    s_and_b32 s61, s31, 1
    s_lshl_b32 s61, s61, 10
    s_add_u32 s60, s60, s61
    s_add_u32 s60, s60, 26771456
    s_mul_i32 s61, s63, 2048
    s_add_u32 s46, s60, s61
    s_add_u32 s46, s46, 32768
    s_lshl_b32 s61, s61, 2
    s_add_u32 s42, s60, s61
    s_add_u32 s43, s42, 2048
    s_add_u32 s44, s42, 4096
    s_add_u32 s45, s42, 6144
    s_branch L_ke_382
L_kn_383:
    s_cmp_lg_u32 s51, 1
    s_cbranch_scc1 L_kn_384
    s_sub_u32 s60, s58, 108
    s_mul_i32 s63, s60, 8193
    s_lshr_b32 s63, s63, 16
    s_mul_i32 s61, s63, 8
    s_sub_u32 s62, s60, s61
    s_mov_b32 s20, s32
    s_mov_b32 s21, s33
    s_mov_b32 s22, 819200
    s_mov_b32 s23, 0x20000
    s_mul_i32 s60, s63, 204800
    s_mul_i32 s61, s62, 160
    s_add_u32 s47, s60, s61
    s_mul_i32 s0, s84, 960
    s_mov_b32 s50, 5
    s_lshr_b32 s2, s31, 1
    s_lshl_b32 s2, s2, 6
    s_and_b32 s61, s31, 1
    s_lshl_b32 s61, s61, 3
    s_add_u32 s2, s2, s61
    s_mul_i32 s60, s62, 5
    s_add_u32 s60, s60, s31
    s_mul_i32 s60, s60, 20480
    s_add_u32 s60, s60, 25952256
    s_mul_i32 s61, s63, 1024
    s_add_u32 s46, s60, s61
    s_add_u32 s46, s46, 16384
    s_lshl_b32 s61, s61, 2
    s_add_u32 s42, s60, s61
    s_add_u32 s43, s42, 1024
    s_add_u32 s44, s42, 2048
    s_add_u32 s45, s42, 3072
    s_branch L_ke_382
L_kn_384:
    s_sub_u32 s60, s58, 140
    s_mul_i32 s63, s60, 8193
    s_lshr_b32 s63, s63, 16
    s_mul_i32 s61, s63, 8
    s_sub_u32 s62, s60, s61
    s_mov_b32 s20, s38
    s_mov_b32 s21, s39
    s_mov_b32 s22, 2211840
    s_mov_b32 s23, 0x20000
    s_mul_i32 s60, s63, 163840
    s_mul_i32 s61, s62, 160
    s_add_u32 s47, s60, s61
    s_mul_i32 s0, s84, 960
    s_mov_b32 s50, 5
    s_lshr_b32 s2, s31, 1
    s_lshl_b32 s2, s2, 6
    s_and_b32 s61, s31, 1
    s_lshl_b32 s61, s61, 3
    s_add_u32 s2, s2, s61
    s_mul_i32 s60, s62, 5
    s_add_u32 s60, s60, s31
    s_mul_i32 s60, s60, 55296
    s_add_u32 s60, s60, 28983296
    s_mul_i32 s61, s63, 1024
    s_add_u32 s46, s60, s61
    s_add_u32 s46, s46, 16384
    s_lshl_b32 s61, s61, 2
    s_add_u32 s42, s60, s61
    s_add_u32 s43, s42, 1024
    s_add_u32 s44, s42, 2048
    s_add_u32 s45, s42, 3072
    s_mov_b32 s46, 0
    s_cmp_eq_u32 s63, 13
    s_cmov_b32 s44, 0
    s_cmp_ge_u32 s63, 14
    s_cmov_b32 s50, 0
    s_cmov_b32 s47, 0
L_ke_382:
    s_mul_i32 s60, s67, 160
    s_lshl_b32 s61, s84, 3
    s_add_u32 s60, s60, s61
    s_mul_i32 s60, s60, 7680
    s_lshl_b32 s61, s59, 7
    s_add_u32 s48, s60, s61
    s_mul_i32 s49, s67, 15360
    s_lshl_b32 s61, s59, 8
    s_add_u32 s49, s49, s61
    s_lshl_b32 s61, s84, 6
    s_add_u32 s49, s49, s61
    s_add_u32 s49, s49, 1048576
    s_cmp_lt_u32 s59, 20
    s_cmov_b32 s49, 0
    s_cmp_ge_u32 s67, 4
    s_cmov_b32 s49, 0
    s_setpc_b64 s[40:41]
L_exact:
    s_nop 7
    s_waitcnt vmcnt(0) lgkmcnt(0)
    v_and_b32 v138, 3, v0
    v_and_b32 v139, 4, v0
    v_lshl_or_b32 v138, v139, 2, v138
    v_bfe_u32 v139, v0, 3, 2
    v_lshl_or_b32 v138, v139, 2, v138
    v_lshlrev_b32 v138, 4, v138
    v_lshrrev_b32 v139, 5, v0
    v_mul_u32_u24 v137, 32768, v139
    v_add_u32 v137, v137, v138
    v_mul_u32_u24 v139, 320, v139
    v_and_b32 v140, 31, v0
    v_lshl_add_u32 v139, v140, 4, v139
    v_mov_b32 v140, 0xff800000
    v_mov_b32 v141, 0xff800000
    s_mov_b32 s36, 0
    v_mov_b32 v48, 0
    v_mov_b32 v80, 0
    v_mov_b32 v49, 0
    v_mov_b32 v81, 0
    v_mov_b32 v50, 0
    v_mov_b32 v82, 0
    v_mov_b32 v51, 0
    v_mov_b32 v83, 0
    v_mov_b32 v52, 0
    v_mov_b32 v84, 0
    v_mov_b32 v53, 0
    v_mov_b32 v85, 0
    v_mov_b32 v54, 0
    v_mov_b32 v86, 0
    v_mov_b32 v55, 0
    v_mov_b32 v87, 0
    v_mov_b32 v56, 0
    v_mov_b32 v88, 0
    v_mov_b32 v57, 0
    v_mov_b32 v89, 0
    v_mov_b32 v58, 0
    v_mov_b32 v90, 0
    v_mov_b32 v59, 0
    v_mov_b32 v91, 0
    v_mov_b32 v60, 0
    v_mov_b32 v92, 0
    v_mov_b32 v61, 0
    v_mov_b32 v93, 0
    v_mov_b32 v62, 0
    v_mov_b32 v94, 0
    v_mov_b32 v63, 0
    v_mov_b32 v95, 0
    v_mov_b32 v64, 0
    v_mov_b32 v96, 0
    v_mov_b32 v65, 0
    v_mov_b32 v97, 0
    v_mov_b32 v66, 0
    v_mov_b32 v98, 0
    v_mov_b32 v67, 0
    v_mov_b32 v99, 0
    v_mov_b32 v68, 0
    v_mov_b32 v100, 0
    v_mov_b32 v69, 0
    v_mov_b32 v101, 0
    v_mov_b32 v70, 0
    v_mov_b32 v102, 0
    v_mov_b32 v71, 0
    v_mov_b32 v103, 0
    v_mov_b32 v72, 0
    v_mov_b32 v104, 0
    v_mov_b32 v73, 0
    v_mov_b32 v105, 0
    v_mov_b32 v74, 0
    v_mov_b32 v106, 0
    v_mov_b32 v75, 0
    v_mov_b32 v107, 0
    v_mov_b32 v76, 0
    v_mov_b32 v108, 0
    v_mov_b32 v77, 0
    v_mov_b32 v109, 0
    v_mov_b32 v78, 0
    v_mov_b32 v110, 0
    v_mov_b32 v79, 0
    v_mov_b32 v111, 0
L_xs_386:
    s_lshr_b32 s33, s54, 1
    s_mul_i32 s33, s33, 5
    s_and_b32 s35, s54, 1
    s_mul_i32 s32, s35, 3
    s_add_u32 s32, s32, s33
    s_mul_i32 s32, s32, 32768
    s_add_u32 s32, s32, 7340032
    s_mul_i32 s33, s33, 32768
    s_lshl_b32 s35, s35, 3
    s_add_u32 s33, s33, s35
    s_add_u32 s33, s33, 7405568
    s_mul_i32 s34, s54, 81920
    s_add_u32 s34, s34, 11010048
    s_mov_b32 s35, 64
L_xl_387:
    buffer_load_dwordx2 v[122:123], v138, s[4:7], s33 offen sc1
    buffer_load_dwordx4 v[124:127], v137, s[4:7], s32 offen sc1
    s_mov_b64 exec, s[76:77]
    buffer_load_dwordx4 v[128:131], v139, s[4:7], s34 offen sc1
    buffer_load_dwordx4 v[132:135], v139, s[4:7], s34 offen offset:640 sc1
    s_mov_b64 exec, -1
    s_add_u32 s32, s32, 512
    s_add_u32 s33, s33, 512
    s_add_u32 s34, s34, 1280
    s_waitcnt vmcnt(0)
    v_mfma_f32_32x32x4_2b_bf16 v[16:47], v[122:123], v[120:121], v[48:79] cbsz:1 abid:0
    s_nop 15
    s_nop 1
    v_mfma_f32_32x32x16_bf16 v[16:31], v[124:127], v[112:115], v[16:31]
    v_mfma_f32_32x32x16_bf16 v[32:47], v[124:127], v[116:119], v[32:47]
    s_cmp_eq_u32 s36, 1
    s_cbranch_scc1 L_x2_388
    s_nop 8
    v_max3_f32 v140, v140, v16, v17
    v_max3_f32 v140, v140, v18, v19
    v_max3_f32 v140, v140, v20, v21
    v_max3_f32 v140, v140, v22, v23
    v_max3_f32 v140, v140, v24, v25
    v_max3_f32 v140, v140, v26, v27
    v_max3_f32 v140, v140, v28, v29
    v_max3_f32 v140, v140, v30, v31
    v_max3_f32 v141, v141, v32, v33
    v_max3_f32 v141, v141, v34, v35
    v_max3_f32 v141, v141, v36, v37
    v_max3_f32 v141, v141, v38, v39
    v_max3_f32 v141, v141, v40, v41
    v_max3_f32 v141, v141, v42, v43
    v_max3_f32 v141, v141, v44, v45
    v_max3_f32 v141, v141, v46, v47
    s_branch L_xn_389
L_x2_388:
    s_nop 8
    v_exp_f32 v16, v16
    v_exp_f32 v17, v17
    v_exp_f32 v18, v18
    v_exp_f32 v19, v19
    v_exp_f32 v20, v20
    v_exp_f32 v21, v21
    v_exp_f32 v22, v22
    v_exp_f32 v23, v23
    v_exp_f32 v24, v24
    v_exp_f32 v25, v25
    v_exp_f32 v26, v26
    v_exp_f32 v27, v27
    v_exp_f32 v28, v28
    v_exp_f32 v29, v29
    v_exp_f32 v30, v30
    v_exp_f32 v31, v31
    v_exp_f32 v32, v32
    v_exp_f32 v33, v33
    v_exp_f32 v34, v34
    v_exp_f32 v35, v35
    v_exp_f32 v36, v36
    v_exp_f32 v37, v37
    v_exp_f32 v38, v38
    v_exp_f32 v39, v39
    v_exp_f32 v40, v40
    v_exp_f32 v41, v41
    v_exp_f32 v42, v42
    v_exp_f32 v43, v43
    v_exp_f32 v44, v44
    v_exp_f32 v45, v45
    v_exp_f32 v46, v46
    v_exp_f32 v47, v47
    v_smfmac_f32_32x32x32_bf16 v[80:95], v[128:131], v[16:23], v136
    v_smfmac_f32_32x32x32_bf16 v[80:95], v[132:135], v[24:31], v136
    v_smfmac_f32_32x32x32_bf16 v[96:111], v[128:131], v[32:39], v136
    v_smfmac_f32_32x32x32_bf16 v[96:111], v[132:135], v[40:47], v136
L_xn_389:
    s_sub_u32 s35, s35, 1
    s_cmp_lg_u32 s35, 0
    s_cbranch_scc1 L_xl_387
    s_cmp_eq_u32 s36, 1
    s_cbranch_scc1 L_xf_390
    s_mov_b32 s36, 1
    v_mov_b32 v16, v140
    s_nop 1
    v_permlane32_swap_b32 v140, v16
    v_max_f32 v140, v140, v16
    v_sub_f32 v48, 0, v140
    v_sub_f32 v49, 0, v140
    v_sub_f32 v50, 0, v140
    v_sub_f32 v51, 0, v140
    v_sub_f32 v52, 0, v140
    v_sub_f32 v53, 0, v140
    v_sub_f32 v54, 0, v140
    v_sub_f32 v55, 0, v140
    v_sub_f32 v56, 0, v140
    v_sub_f32 v57, 0, v140
    v_sub_f32 v58, 0, v140
    v_sub_f32 v59, 0, v140
    v_sub_f32 v60, 0, v140
    v_sub_f32 v61, 0, v140
    v_sub_f32 v62, 0, v140
    v_sub_f32 v63, 0, v140
    v_mov_b32 v16, v141
    s_nop 1
    v_permlane32_swap_b32 v141, v16
    v_max_f32 v141, v141, v16
    v_sub_f32 v64, 0, v141
    v_sub_f32 v65, 0, v141
    v_sub_f32 v66, 0, v141
    v_sub_f32 v67, 0, v141
    v_sub_f32 v68, 0, v141
    v_sub_f32 v69, 0, v141
    v_sub_f32 v70, 0, v141
    v_sub_f32 v71, 0, v141
    v_sub_f32 v72, 0, v141
    v_sub_f32 v73, 0, v141
    v_sub_f32 v74, 0, v141
    v_sub_f32 v75, 0, v141
    v_sub_f32 v76, 0, v141
    v_sub_f32 v77, 0, v141
    v_sub_f32 v78, 0, v141
    v_sub_f32 v79, 0, v141
    s_branch L_xs_386
L_xf_390:
    s_nop 15
    s_cmp_eq_u32 s75, 0
    s_cbranch_scc1 L_xd_391
    v_mov_b32 v80, v96
    v_mov_b32 v81, v97
    v_mov_b32 v82, v98
    v_mov_b32 v83, v99
    v_mov_b32 v84, v100
    v_mov_b32 v85, v101
    v_mov_b32 v86, v102
    v_mov_b32 v87, v103
    v_mov_b32 v88, v104
    v_mov_b32 v89, v105
    v_mov_b32 v90, v106
    v_mov_b32 v91, v107
    v_mov_b32 v92, v108
L_xd_391:
    s_nop 3
    s_setpc_b64 s[40:41]
L_code_end:
.section .rodata,"a"
.p2align 6
.amdhsa_kernel adaLN_cond__mha_block__dense_activation_relu__prompt_kernel
  .amdhsa_next_free_vgpr 256
  .amdhsa_next_free_sgpr 102
  .amdhsa_accum_offset 256
  .amdhsa_group_segment_fixed_size 0
  .amdhsa_kernarg_size 88
  .amdhsa_user_sgpr_count 2
  .amdhsa_user_sgpr_kernarg_segment_ptr 1
  .amdhsa_system_sgpr_workgroup_id_x 1
.end_amdhsa_kernel
```
